```python
import torch

def _softmax(x, axis=-1):
    return torch.softmax(x, dim=axis)
def _gelu(x):
    return torch.nn.functional.gelu(x, approximate="tanh")
def _silu(x):
    return torch.nn.functional.silu(x)
def _sigmoid(x):
    return torch.sigmoid(x)
def _layernorm(x, axis=-1, eps=1e-5):
    m = x.mean(dim=axis, keepdim=True)
    v = x.var(dim=axis, keepdim=True, unbiased=False)
    return (x - m) / torch.sqrt(v + eps)
def _scatter_add(tgt, idx, src, axis=0):
    return tgt.clone().index_add_(axis, idx, src)
def _segment_sum(src, seg, n):
    out = torch.zeros((n,) + src.shape[1:], dtype=src.dtype)
    return out.index_add_(0, seg, src)
def _pad(x, pw):
    flat = tuple(v for pair in reversed(pw) for v in pair)
    return torch.nn.functional.pad(x, flat)

kernel_name = 'recurrent_scan__spectral_gfnet__dense_activation_silu__prompt'

def setup_inputs():

    _w = (lambda a: (lambda t: t.to(torch.bfloat16) if t.is_floating_point() else t)(torch.as_tensor(a)))
    def _A_setup():
        B, S, D = 1, 2048, 1024
        Df = D // 2 + 1
        return {
            "x": _w((lambda *s: torch.randn(*s, dtype=torch.bfloat16) * 0.05)(B, S, D)),
            "w_r": _w((lambda *s: torch.randn(*s, dtype=torch.bfloat16) * 3.2)(S, Df) * 0.02),
            "w_i": _w((lambda *s: torch.randn(*s, dtype=torch.bfloat16) * 3.2)(S, Df) * 0.02),
        }
    _A_in = _A_setup()

    def _B_setup():
        B, S, D, F = 1, 2048, 1024, 3584
        return {
            "x": _w((lambda *s: torch.randn(*s, dtype=torch.bfloat16) * 0.05)(B, S, D)),
            "w1": _w((lambda *s: torch.randn(*s, dtype=torch.bfloat16) * 3.2)(D, F) * (D ** -0.5)),
            "w2": _w((lambda *s: torch.randn(*s, dtype=torch.bfloat16) * 0.4)(F, D) * (F ** -0.5)),
        }
    _B_in = _B_setup()

    return {
        "A_x": _A_in["x"],
        "A_w_r": _A_in["w_r"],
        "A_w_i": _A_in["w_i"],
        "B_x": _B_in["x"],
        "B_w1": _B_in["w1"],
        "B_w2": _B_in["w2"],
    }

def reference(A_x, A_w_r, A_w_i, B_x, B_w1, B_w2):
    def _A_ref(x, w_r, w_i):
        B, S, D = x.shape
        X = (lambda x, axes=(-2,-1): torch.fft.rfft2(x.float(), dim=axes))(x, axes=(-2, -1))
        W = w_r + 1j * w_i
        X = X * W
        y = (lambda x, s, axes=(-2,-1): torch.fft.irfft2(x, s=s, dim=axes).to(torch.bfloat16))(X, (S, D), axes=(-2, -1))
        return y

    def _B_ref(x, w1, w2):
        h = torch.einsum("bsd,df->bsf", x, w1)
        h = _silu(h)
        out = torch.einsum("bsf,fd->bsd", h, w2)
        return out

    x = A_x
    xn = _layernorm(x, axis=-1)
    s = _A_ref(xn, A_w_r, A_w_i)
    g = _silu(_B_ref(xn, B_w1, B_w2))
    return x + s * g
```

```asm
; @launch kernel=recurrent_scan__spectral_gfnet__dense_activation_silu__prompt_kernel grid=(256,1,1) block=(512,1,1) lds=163840
.amdgcn_target "amdgcn-amd-amdhsa--gfx950"
.text
.globl recurrent_scan__spectral_gfnet__dense_activation_silu__prompt_kernel
.p2align 8
.type recurrent_scan__spectral_gfnet__dense_activation_silu__prompt_kernel,@function
recurrent_scan__spectral_gfnet__dense_activation_silu__prompt_kernel:
    s_cmp_ge_u32 s2, 256
    s_cbranch_scc1 L_end_k
    s_load_dwordx2 s[80:81], s[0:1], 0
    s_load_dwordx2 s[82:83], s[0:1], 32
    s_load_dwordx2 s[84:85], s[0:1], 64
    s_load_dwordx2 s[86:87], s[0:1], 56
    s_load_dwordx2 s[88:89], s[0:1], 40
    v_lshrrev_b32 v1, 6, v0
    v_and_b32 v0, 63, v0
    v_readfirstlane_b32 s20, v1
    v_mov_b32 v240, 0
    v_mov_b32 v241, 0
    v_mov_b32 v242, 0
    v_mov_b32 v243, 0
    v_mov_b32 v244, 0
    v_mov_b32 v245, 0
    v_mov_b32 v246, 0
    v_mov_b32 v247, 0
    v_mov_b32 v248, 0
    v_mov_b32 v249, 0
    v_mov_b32 v250, 0
    v_mov_b32 v251, 0
    s_and_b32 s21, s2, 7
    s_lshr_b32 s22, s2, 3
    s_and_b32 s76, s21, 3
    s_lshl_b32 s76, s76, 2
    s_and_b32 s24, s22, 3
    s_add_u32 s76, s76, s24
    s_lshr_b32 s77, s21, 2
    s_mul_i32 s77, s77, 7
    s_lshr_b32 s25, s22, 2
    s_add_u32 s77, s77, s25
    s_cmp_ge_u32 s2, 224
    s_cbranch_scc1 L_col_role
    s_cmp_ge_u32 s2, 128
    s_cbranch_scc1 L_wp_role
    s_and_b32 s21, s2, 7
    s_lshr_b32 s22, s2, 3
    s_lshr_b32 s23, s22, 1
    s_and_b32 s24, s22, 1
    s_lshl_b32 s25, s21, 1
    s_add_u32 s24, s24, s25
    s_lshl_b32 s25, s23, 2
    s_and_b32 s26, s20, 3
    s_add_u32 s25, s25, s26
    s_lshl_b32 s25, s25, 6
    s_lshl_b32 s26, s24, 2
    s_add_u32 s25, s25, s26
    s_lshr_b32 s26, s20, 2
    s_add_u32 s25, s25, s26
    s_lshl_b32 s26, s25, 11
    s_add_u32 s27, s26, 4096
    s_lshr_b32 s28, s24, 3
    s_lshl_b32 s28, s28, 2
    s_lshr_b32 s29, s23, 1
    s_add_u32 s28, s28, s29
    s_lshl_b32 s28, s28, 6
    s_and_b32 s29, s23, 1
    s_lshl_b32 s29, s29, 5
    s_add_u32 s28, s28, s29
    s_and_b32 s29, s24, 7
    s_lshl_b32 s29, s29, 2
    s_add_u32 s28, s28, s29
    s_lshl_b32 s28, s28, 4
    v_lshlrev_b32 v1, 5, v0
    s_waitcnt lgkmcnt(0)
    s_mov_b32 s4, s80
    s_and_b32 s5, s81, 0xffff
    s_mov_b32 s6, 0x400000
    s_mov_b32 s7, 0x20000
    buffer_load_dwordx4 v[8:11], v1, s[4:7], s26 offen
    buffer_load_dwordx4 v[12:15], v1, s[4:7], s26 offen offset:16
    buffer_load_dwordx4 v[16:19], v1, s[4:7], s27 offen
    buffer_load_dwordx4 v[20:23], v1, s[4:7], s27 offen offset:16
    s_cmp_lt_u32 s20, 4
    s_cbranch_scc1 L_noearly_rf
    s_sub_u32 s64, s20, 4
    s_mul_i32 s65, s76, 262144
    s_mul_i32 s66, s77, 512
    s_mul_i32 s40, s64, 32
    s_add_u32 s40, s40, 0
    v_lshrrev_b32 v236, 3, v0
    v_add_u32 v236, s40, v236
    v_lshrrev_b32 v237, 1, v236
    v_xor_b32 v237, v237, v0
    v_and_b32 v237, 7, v237
    v_lshlrev_b32 v237, 4, v237
    s_mov_b32 s41, 2048
    v_mul_lo_u32 v236, v236, s41
    v_add3_u32 v240, v236, v237, s65
    s_mul_i32 s40, s64, 32
    s_add_u32 s40, s40, 8
    v_lshrrev_b32 v236, 3, v0
    v_add_u32 v236, s40, v236
    v_lshrrev_b32 v237, 1, v236
    v_xor_b32 v237, v237, v0
    v_and_b32 v237, 7, v237
    v_lshlrev_b32 v237, 4, v237
    s_mov_b32 s41, 2048
    v_mul_lo_u32 v236, v236, s41
    v_add3_u32 v241, v236, v237, s65
    s_mul_i32 s40, s64, 32
    s_add_u32 s40, s40, 16
    v_lshrrev_b32 v236, 3, v0
    v_add_u32 v236, s40, v236
    v_lshrrev_b32 v237, 1, v236
    v_xor_b32 v237, v237, v0
    v_and_b32 v237, 7, v237
    v_lshlrev_b32 v237, 4, v237
    s_mov_b32 s41, 2048
    v_mul_lo_u32 v236, v236, s41
    v_add3_u32 v242, v236, v237, s65
    s_mul_i32 s40, s64, 32
    s_add_u32 s40, s40, 24
    v_lshrrev_b32 v236, 3, v0
    v_add_u32 v236, s40, v236
    v_lshrrev_b32 v237, 1, v236
    v_xor_b32 v237, v237, v0
    v_and_b32 v237, 7, v237
    v_lshlrev_b32 v237, 4, v237
    s_mov_b32 s41, 2048
    v_mul_lo_u32 v236, v236, s41
    v_add3_u32 v243, v236, v237, s65
    s_mul_i32 s40, s64, 16
    s_add_u32 s40, s40, 0
    v_lshrrev_b32 v236, 5, v0
    v_add_u32 v236, s40, v236
    v_and_b32 v237, 3, v236
    v_lshrrev_b32 v239, 1, v236
    v_and_b32 v239, 4, v239
    v_or_b32 v237, v237, v239
    v_lshlrev_b32 v237, 1, v237
    v_and_b32 v238, 31, v0
    v_xor_b32 v237, v237, v238
    v_lshlrev_b32 v237, 4, v237
    s_mov_b32 s41, 7168
    v_mul_lo_u32 v236, v236, s41
    v_add3_u32 v244, v236, v237, s66
    s_mul_i32 s40, s64, 16
    s_add_u32 s40, s40, 2
    v_lshrrev_b32 v236, 5, v0
    v_add_u32 v236, s40, v236
    v_and_b32 v237, 3, v236
    v_lshrrev_b32 v239, 1, v236
    v_and_b32 v239, 4, v239
    v_or_b32 v237, v237, v239
    v_lshlrev_b32 v237, 1, v237
    v_and_b32 v238, 31, v0
    v_xor_b32 v237, v237, v238
    v_lshlrev_b32 v237, 4, v237
    s_mov_b32 s41, 7168
    v_mul_lo_u32 v236, v236, s41
    v_add3_u32 v245, v236, v237, s66
    s_mul_i32 s40, s64, 16
    s_add_u32 s40, s40, 4
    v_lshrrev_b32 v236, 5, v0
    v_add_u32 v236, s40, v236
    v_and_b32 v237, 3, v236
    v_lshrrev_b32 v239, 1, v236
    v_and_b32 v239, 4, v239
    v_or_b32 v237, v237, v239
    v_lshlrev_b32 v237, 1, v237
    v_and_b32 v238, 31, v0
    v_xor_b32 v237, v237, v238
    v_lshlrev_b32 v237, 4, v237
    s_mov_b32 s41, 7168
    v_mul_lo_u32 v236, v236, s41
    v_add3_u32 v246, v236, v237, s66
    s_mul_i32 s40, s64, 16
    s_add_u32 s40, s40, 6
    v_lshrrev_b32 v236, 5, v0
    v_add_u32 v236, s40, v236
    v_and_b32 v237, 3, v236
    v_lshrrev_b32 v239, 1, v236
    v_and_b32 v239, 4, v239
    v_or_b32 v237, v237, v239
    v_lshlrev_b32 v237, 1, v237
    v_and_b32 v238, 31, v0
    v_xor_b32 v237, v237, v238
    v_lshlrev_b32 v237, 4, v237
    s_mov_b32 s41, 7168
    v_mul_lo_u32 v236, v236, s41
    v_add3_u32 v247, v236, v237, s66
    s_mul_i32 s40, s64, 16
    s_add_u32 s40, s40, 8
    v_lshrrev_b32 v236, 5, v0
    v_add_u32 v236, s40, v236
    v_and_b32 v237, 3, v236
    v_lshrrev_b32 v239, 1, v236
    v_and_b32 v239, 4, v239
    v_or_b32 v237, v237, v239
    v_lshlrev_b32 v237, 1, v237
    v_and_b32 v238, 31, v0
    v_xor_b32 v237, v237, v238
    v_lshlrev_b32 v237, 4, v237
    s_mov_b32 s41, 7168
    v_mul_lo_u32 v236, v236, s41
    v_add3_u32 v248, v236, v237, s66
    s_mul_i32 s40, s64, 16
    s_add_u32 s40, s40, 10
    v_lshrrev_b32 v236, 5, v0
    v_add_u32 v236, s40, v236
    v_and_b32 v237, 3, v236
    v_lshrrev_b32 v239, 1, v236
    v_and_b32 v239, 4, v239
    v_or_b32 v237, v237, v239
    v_lshlrev_b32 v237, 1, v237
    v_and_b32 v238, 31, v0
    v_xor_b32 v237, v237, v238
    v_lshlrev_b32 v237, 4, v237
    s_mov_b32 s41, 7168
    v_mul_lo_u32 v236, v236, s41
    v_add3_u32 v249, v236, v237, s66
    s_mul_i32 s40, s64, 16
    s_add_u32 s40, s40, 12
    v_lshrrev_b32 v236, 5, v0
    v_add_u32 v236, s40, v236
    v_and_b32 v237, 3, v236
    v_lshrrev_b32 v239, 1, v236
    v_and_b32 v239, 4, v239
    v_or_b32 v237, v237, v239
    v_lshlrev_b32 v237, 1, v237
    v_and_b32 v238, 31, v0
    v_xor_b32 v237, v237, v238
    v_lshlrev_b32 v237, 4, v237
    s_mov_b32 s41, 7168
    v_mul_lo_u32 v236, v236, s41
    v_add3_u32 v250, v236, v237, s66
    s_mul_i32 s40, s64, 16
    s_add_u32 s40, s40, 14
    v_lshrrev_b32 v236, 5, v0
    v_add_u32 v236, s40, v236
    v_and_b32 v237, 3, v236
    v_lshrrev_b32 v239, 1, v236
    v_and_b32 v239, 4, v239
    v_or_b32 v237, v237, v239
    v_lshlrev_b32 v237, 1, v237
    v_and_b32 v238, 31, v0
    v_xor_b32 v237, v237, v238
    v_lshlrev_b32 v237, 4, v237
    s_mov_b32 s41, 7168
    v_mul_lo_u32 v236, v236, s41
    v_add3_u32 v251, v236, v237, s66
L_noearly_rf:
    s_sub_u32 s64, s20, 4
    s_mov_b32 s68, s80
    s_and_b32 s69, s81, 0xffff
    s_mov_b32 s70, 0x400000
    s_mov_b32 s71, 0x20000
    s_mov_b32 s72, s82
    s_and_b32 s73, s83, 0xffff
    s_mov_b32 s74, 0x700000
    s_mov_b32 s75, 0x20000
    s_mul_i32 s78, s64, 4096
    s_mul_i32 s79, s64, 8192
    s_add_u32 s79, s79, 16384
    s_mov_b32 s67, 0
    s_add_u32 s12, s84, 0x1200000
    s_addc_u32 s13, s85, 0
    s_and_b32 s13, s13, 0xffff
    s_mov_b32 s14, 0x426300
    s_mov_b32 s15, 0x20000
    v_and_b32 v7, 31, v0
    v_cvt_f32_u32 v7, v7
    v_mul_f32 v2, 0x3d000000, v7
    v_mul_f32 v3, 0x3a800000, v7
    v_lshrrev_b32 v4, 5, v0
    v_cvt_f32_u32 v4, v4
    v_and_b32 v5, 31, v0
    v_lshrrev_b32 v5, 1, v5
    v_cvt_f32_u32 v5, v5
    v_mul_f32 v5, 0x3d000000, v5
    v_and_b32 v6, 1, v0
    v_cvt_f32_u32 v6, v6
    v_mul_f32 v6, 0x3e800000, v6
    s_lshr_b32 s40, s20, 2
    s_lshl_b32 s40, s40, 4
    s_and_b32 s41, s20, 3
    s_lshl_b32 s41, s41, 1
    s_add_u32 s40, s40, s41
    v_cvt_f32_u32 v93, s40
    v_fma_f32 v93, v4, 4.0, v93
    v_fma_f32 v93, v4, 4.0, v93
    v_mul_f32 v88, v93, v2
    v_fract_f32 v88, v88
    v_sin_f32 v91, v88
    v_cos_f32 v89, v88
    v_add_f32 v88, 0x3f800000, v93
    v_mul_f32 v88, v88, v2
    v_fract_f32 v88, v88
    v_sin_f32 v92, v88
    v_cos_f32 v90, v88
    s_nop 0
    v_cvt_pk_bf16_f32 v96, v89, v90
    v_cvt_pk_bf16_f32 v97, -v91, -v92
    s_lshr_b32 s40, s20, 1
    s_lshl_b32 s40, s40, 3
    s_and_b32 s41, s20, 1
    s_lshl_b32 s41, s41, 1
    s_add_u32 s40, s40, s41
    v_cvt_f32_u32 v93, s40
    v_fma_f32 v93, v4, 4.0, v93
    v_mul_f32 v88, v93, v3
    v_fract_f32 v88, v88
    v_sin_f32 v100, v88
    v_cos_f32 v98, v88
    v_add_f32 v88, 0x3f800000, v93
    v_mul_f32 v88, v88, v3
    v_fract_f32 v88, v88
    v_sin_f32 v101, v88
    v_cos_f32 v99, v88
    v_fma_f32 v88, v93, v5, v6
    v_fract_f32 v88, v88
    v_sin_f32 v90, v88
    v_cos_f32 v89, v88
    s_nop 0
    v_cvt_pk_bf16_f32 v102, v89, v90
    v_add_f32 v88, 0x3f800000, v93
    v_fma_f32 v88, v88, v5, v6
    v_fract_f32 v88, v88
    v_sin_f32 v90, v88
    v_cos_f32 v89, v88
    s_nop 0
    v_cvt_pk_bf16_f32 v103, v89, v90
    v_lshlrev_b32 v94, 4, v0
    v_add_u32 v94, 49152, v94
    s_lshr_b32 s40, s20, 2
    s_lshl_b32 s40, s40, 10
    s_and_b32 s41, s20, 3
    s_lshl_b32 s41, s41, 2
    s_add_u32 s40, s40, s41
    v_add_u32 v88, s40, v94
    ds_write_b32 v88, v96
    ds_write_b32 v88, v97 offset:2048
    s_lshr_b32 s40, s20, 1
    s_lshl_b32 s40, s40, 10
    s_and_b32 s41, s20, 1
    s_lshl_b32 s41, s41, 3
    s_add_u32 s40, s40, s41
    v_add_u32 v89, s40, v94
    ds_write_b64 v89, v[98:99] offset:4096
    ds_write_b64 v89, v[100:101] offset:8192
    ds_write_b64 v89, v[102:103] offset:12288
    s_waitcnt lgkmcnt(0)
    s_barrier
    ds_read_b128 v[24:27], v94 offset:0
    ds_read_b128 v[28:31], v94 offset:1024
    ds_read_b128 v[32:35], v94 offset:2048
    ds_read_b128 v[36:39], v94 offset:3072
    ds_read_b128 v[40:43], v94 offset:4096
    ds_read_b128 v[44:47], v94 offset:5120
    ds_read_b128 v[48:51], v94 offset:6144
    ds_read_b128 v[52:55], v94 offset:7168
    ds_read_b128 v[56:59], v94 offset:8192
    ds_read_b128 v[60:63], v94 offset:9216
    ds_read_b128 v[64:67], v94 offset:10240
    ds_read_b128 v[68:71], v94 offset:11264
    ds_read_b128 v[72:75], v94 offset:12288
    ds_read_b128 v[76:79], v94 offset:13312
    ds_read_b128 v[80:83], v94 offset:14336
    ds_read_b128 v[84:87], v94 offset:15360
    s_lshl_b32 s30, s20, 12
    s_add_u32 s30, s30, 98304
    v_add_u32 v2, s30, v1
    v_lshrrev_b32 v5, 5, v0
    v_lshlrev_b32 v5, 3, v5
    v_lshrrev_b32 v6, 2, v0
    v_and_b32 v6, 3, v6
    v_add_u32 v5, v5, v6
    v_lshlrev_b32 v5, 6, v5
    v_lshrrev_b32 v6, 4, v0
    v_and_b32 v6, 1, v6
    v_lshl_add_u32 v5, v6, 5, v5
    v_and_b32 v6, 3, v0
    v_lshl_add_u32 v5, v6, 3, v5
    v_add_u32 v3, s30, v5
    v_and_b32 v5, 31, v0
    v_lshrrev_b32 v6, 5, v0
    v_lshl_add_u32 v5, v6, 6, v5
    v_lshrrev_b32 v6, 3, v5
    v_mul_u32_u24 v5, 72, v5
    v_lshl_add_u32 v5, v6, 3, v5
    s_lshl_b32 s31, s20, 2
    s_add_u32 s31, s31, 98304
    v_add_u32 v4, s31, v5
    v_mov_b32 v5, s31
    s_waitcnt vmcnt(0)
    s_cmp_lt_u32 s20, 4
    s_cbranch_scc1 L_noissue_rf
    s_lshl_b32 s62, s76, 7
    s_mul_i32 s63, s76, 458752
    s_add_u32 m0, s78, 0
    s_nop 0
    buffer_load_dwordx4 v240, s[68:71], s62 offen lds
    s_add_u32 m0, s78, 1024
    s_nop 0
    buffer_load_dwordx4 v241, s[68:71], s62 offen lds
    s_add_u32 m0, s78, 2048
    s_nop 0
    buffer_load_dwordx4 v242, s[68:71], s62 offen lds
    s_add_u32 m0, s78, 3072
    s_nop 0
    buffer_load_dwordx4 v243, s[68:71], s62 offen lds
    s_add_u32 m0, s79, 0
    s_nop 0
    buffer_load_dwordx4 v244, s[72:75], s63 offen lds
    s_add_u32 m0, s79, 1024
    s_nop 0
    buffer_load_dwordx4 v245, s[72:75], s63 offen lds
    s_add_u32 m0, s79, 2048
    s_nop 0
    buffer_load_dwordx4 v246, s[72:75], s63 offen lds
    s_add_u32 m0, s79, 3072
    s_nop 0
    buffer_load_dwordx4 v247, s[72:75], s63 offen lds
    s_add_u32 m0, s79, 4096
    s_nop 0
    buffer_load_dwordx4 v248, s[72:75], s63 offen lds
    s_add_u32 m0, s79, 5120
    s_nop 0
    buffer_load_dwordx4 v249, s[72:75], s63 offen lds
    s_add_u32 m0, s79, 6144
    s_nop 0
    buffer_load_dwordx4 v250, s[72:75], s63 offen lds
    s_add_u32 m0, s79, 7168
    s_nop 0
    buffer_load_dwordx4 v251, s[72:75], s63 offen lds
L_noissue_rf:
    v_lshlrev_b32 v104, 16, v8
    v_and_b32 v105, 0xffff0000, v8
    v_lshlrev_b32 v106, 16, v9
    v_and_b32 v107, 0xffff0000, v9
    v_lshlrev_b32 v108, 16, v10
    v_and_b32 v109, 0xffff0000, v10
    v_lshlrev_b32 v110, 16, v11
    v_and_b32 v111, 0xffff0000, v11
    v_lshlrev_b32 v112, 16, v12
    v_and_b32 v113, 0xffff0000, v12
    v_lshlrev_b32 v114, 16, v13
    v_and_b32 v115, 0xffff0000, v13
    v_lshlrev_b32 v116, 16, v14
    v_and_b32 v117, 0xffff0000, v14
    v_lshlrev_b32 v118, 16, v15
    v_and_b32 v119, 0xffff0000, v15
    v_lshlrev_b32 v120, 16, v16
    v_and_b32 v121, 0xffff0000, v16
    v_lshlrev_b32 v122, 16, v17
    v_and_b32 v123, 0xffff0000, v17
    v_lshlrev_b32 v124, 16, v18
    v_and_b32 v125, 0xffff0000, v18
    v_lshlrev_b32 v126, 16, v19
    v_and_b32 v127, 0xffff0000, v19
    v_lshlrev_b32 v128, 16, v20
    v_and_b32 v129, 0xffff0000, v20
    v_lshlrev_b32 v130, 16, v21
    v_and_b32 v131, 0xffff0000, v21
    v_lshlrev_b32 v132, 16, v22
    v_and_b32 v133, 0xffff0000, v22
    v_lshlrev_b32 v134, 16, v23
    v_and_b32 v135, 0xffff0000, v23
    v_pk_add_f32 v[136:137], v[104:105], v[106:107]
    v_pk_add_f32 v[140:141], v[120:121], v[122:123]
    v_pk_add_f32 v[136:137], v[136:137], v[108:109]
    v_pk_add_f32 v[140:141], v[140:141], v[124:125]
    v_pk_add_f32 v[136:137], v[136:137], v[110:111]
    v_pk_add_f32 v[140:141], v[140:141], v[126:127]
    v_pk_add_f32 v[136:137], v[136:137], v[112:113]
    v_pk_add_f32 v[140:141], v[140:141], v[128:129]
    v_pk_add_f32 v[136:137], v[136:137], v[114:115]
    v_pk_add_f32 v[140:141], v[140:141], v[130:131]
    v_pk_add_f32 v[136:137], v[136:137], v[116:117]
    v_pk_add_f32 v[140:141], v[140:141], v[132:133]
    v_pk_add_f32 v[136:137], v[136:137], v[118:119]
    v_pk_add_f32 v[140:141], v[140:141], v[134:135]
    v_add_f32 v136, v136, v137
    v_add_f32 v140, v140, v141
    s_nop 0
    v_add_f32_dpp v136, v136, v136 row_ror:8 row_mask:0xf bank_mask:0xf
    v_add_f32_dpp v140, v140, v140 row_ror:8 row_mask:0xf bank_mask:0xf
    s_nop 0
    v_add_f32_dpp v136, v136, v136 row_ror:4 row_mask:0xf bank_mask:0xf
    v_add_f32_dpp v140, v140, v140 row_ror:4 row_mask:0xf bank_mask:0xf
    s_nop 0
    v_add_f32_dpp v136, v136, v136 row_ror:2 row_mask:0xf bank_mask:0xf
    v_add_f32_dpp v140, v140, v140 row_ror:2 row_mask:0xf bank_mask:0xf
    s_nop 0
    v_add_f32_dpp v136, v136, v136 row_ror:1 row_mask:0xf bank_mask:0xf
    v_add_f32_dpp v140, v140, v140 row_ror:1 row_mask:0xf bank_mask:0xf
    v_mov_b32 v138, v136
    v_mov_b32 v142, v140
    s_nop 0
    v_permlane16_swap_b32 v136, v138
    v_permlane16_swap_b32 v140, v142
    v_add_f32 v136, v136, v138
    v_add_f32 v140, v140, v142
    v_mov_b32 v138, v136
    v_mov_b32 v142, v140
    s_nop 0
    v_permlane32_swap_b32 v136, v138
    v_permlane32_swap_b32 v140, v142
    v_add_f32 v136, v136, v138
    v_add_f32 v140, v140, v142
    v_mul_f32 v144, 0xba800000, v136
    v_mov_b32 v145, v144
    v_mul_f32 v146, 0xba800000, v140
    v_mov_b32 v147, v146
    v_pk_add_f32 v[88:89], v[104:105], v[144:145]
    v_pk_mul_f32 v[136:137], v[88:89], v[88:89]
    v_pk_add_f32 v[88:89], v[106:107], v[144:145]
    v_pk_fma_f32 v[136:137], v[88:89], v[88:89], v[136:137]
    v_pk_add_f32 v[88:89], v[108:109], v[144:145]
    v_pk_fma_f32 v[136:137], v[88:89], v[88:89], v[136:137]
    v_pk_add_f32 v[88:89], v[110:111], v[144:145]
    v_pk_fma_f32 v[136:137], v[88:89], v[88:89], v[136:137]
    v_pk_add_f32 v[88:89], v[112:113], v[144:145]
    v_pk_fma_f32 v[136:137], v[88:89], v[88:89], v[136:137]
    v_pk_add_f32 v[88:89], v[114:115], v[144:145]
    v_pk_fma_f32 v[136:137], v[88:89], v[88:89], v[136:137]
    v_pk_add_f32 v[88:89], v[116:117], v[144:145]
    v_pk_fma_f32 v[136:137], v[88:89], v[88:89], v[136:137]
    v_pk_add_f32 v[88:89], v[118:119], v[144:145]
    v_pk_fma_f32 v[136:137], v[88:89], v[88:89], v[136:137]
    v_pk_add_f32 v[90:91], v[120:121], v[146:147]
    v_pk_mul_f32 v[140:141], v[90:91], v[90:91]
    v_pk_add_f32 v[90:91], v[122:123], v[146:147]
    v_pk_fma_f32 v[140:141], v[90:91], v[90:91], v[140:141]
    v_pk_add_f32 v[90:91], v[124:125], v[146:147]
    v_pk_fma_f32 v[140:141], v[90:91], v[90:91], v[140:141]
    v_pk_add_f32 v[90:91], v[126:127], v[146:147]
    v_pk_fma_f32 v[140:141], v[90:91], v[90:91], v[140:141]
    v_pk_add_f32 v[90:91], v[128:129], v[146:147]
    v_pk_fma_f32 v[140:141], v[90:91], v[90:91], v[140:141]
    v_pk_add_f32 v[90:91], v[130:131], v[146:147]
    v_pk_fma_f32 v[140:141], v[90:91], v[90:91], v[140:141]
    v_pk_add_f32 v[90:91], v[132:133], v[146:147]
    v_pk_fma_f32 v[140:141], v[90:91], v[90:91], v[140:141]
    v_pk_add_f32 v[90:91], v[134:135], v[146:147]
    v_pk_fma_f32 v[140:141], v[90:91], v[90:91], v[140:141]
    v_add_f32 v136, v136, v137
    v_add_f32 v140, v140, v141
    s_nop 0
    v_add_f32_dpp v136, v136, v136 row_ror:8 row_mask:0xf bank_mask:0xf
    v_add_f32_dpp v140, v140, v140 row_ror:8 row_mask:0xf bank_mask:0xf
    s_nop 0
    v_add_f32_dpp v136, v136, v136 row_ror:4 row_mask:0xf bank_mask:0xf
    v_add_f32_dpp v140, v140, v140 row_ror:4 row_mask:0xf bank_mask:0xf
    s_nop 0
    v_add_f32_dpp v136, v136, v136 row_ror:2 row_mask:0xf bank_mask:0xf
    v_add_f32_dpp v140, v140, v140 row_ror:2 row_mask:0xf bank_mask:0xf
    s_nop 0
    v_add_f32_dpp v136, v136, v136 row_ror:1 row_mask:0xf bank_mask:0xf
    v_add_f32_dpp v140, v140, v140 row_ror:1 row_mask:0xf bank_mask:0xf
    v_mov_b32 v138, v136
    v_mov_b32 v142, v140
    s_nop 0
    v_permlane16_swap_b32 v136, v138
    v_permlane16_swap_b32 v140, v142
    v_add_f32 v136, v136, v138
    v_add_f32 v140, v140, v142
    v_mov_b32 v138, v136
    v_mov_b32 v142, v140
    s_nop 0
    v_permlane32_swap_b32 v136, v138
    v_permlane32_swap_b32 v140, v142
    v_add_f32 v136, v136, v138
    v_add_f32 v140, v140, v142
    v_mul_f32 v136, 0x3a800000, v136
    v_cvt_pk_bf16_f32 v136, v136, v136
    v_lshlrev_b32 v136, 16, v136
    v_add_f32 v136, 0x3727c5ac, v136
    v_cvt_pk_bf16_f32 v136, v136, v136
    v_lshlrev_b32 v136, 16, v136
    v_sqrt_f32 v136, v136
    s_nop 0
    v_cvt_pk_bf16_f32 v136, v136, v136
    v_lshlrev_b32 v136, 16, v136
    v_rcp_f32 v136, v136
    s_nop 0
    v_mov_b32 v137, v136
    v_cvt_pk_bf16_f32 v144, v144, v144
    v_lshlrev_b32 v144, 16, v144
    v_mov_b32 v145, v144
    v_mul_f32 v148, 0xbfb8aa3b, v136
    v_mul_f32 v149, v148, v144
    v_mul_f32 v140, 0x3a800000, v140
    v_cvt_pk_bf16_f32 v140, v140, v140
    v_lshlrev_b32 v140, 16, v140
    v_add_f32 v140, 0x3727c5ac, v140
    v_cvt_pk_bf16_f32 v140, v140, v140
    v_lshlrev_b32 v140, 16, v140
    v_sqrt_f32 v140, v140
    s_nop 0
    v_cvt_pk_bf16_f32 v140, v140, v140
    v_lshlrev_b32 v140, 16, v140
    v_rcp_f32 v140, v140
    s_nop 0
    v_mov_b32 v141, v140
    v_cvt_pk_bf16_f32 v146, v146, v146
    v_lshlrev_b32 v146, 16, v146
    v_mov_b32 v147, v146
    v_mul_f32 v150, 0xbfb8aa3b, v140
    v_mul_f32 v151, v150, v146
    s_mov_b64 exec, 1
    ds_write_b32 v5, v148 offset:37448
    ds_write_b32 v5, v149 offset:37520
    ds_write_b32 v5, v150 offset:37480
    ds_write_b32 v5, v151 offset:37552
    s_mov_b64 exec, -1
    v_pk_add_f32 v[88:89], v[104:105], v[144:145]
    v_pk_mul_f32 v[88:89], v[88:89], v[136:137]
    v_cvt_pk_bf16_f32 v8, v88, v89
    v_pk_add_f32 v[90:91], v[106:107], v[144:145]
    v_pk_mul_f32 v[90:91], v[90:91], v[136:137]
    v_cvt_pk_bf16_f32 v9, v90, v91
    v_pk_add_f32 v[88:89], v[108:109], v[144:145]
    v_pk_mul_f32 v[88:89], v[88:89], v[136:137]
    v_cvt_pk_bf16_f32 v10, v88, v89
    v_pk_add_f32 v[90:91], v[110:111], v[144:145]
    v_pk_mul_f32 v[90:91], v[90:91], v[136:137]
    v_cvt_pk_bf16_f32 v11, v90, v91
    v_pk_add_f32 v[88:89], v[112:113], v[144:145]
    v_pk_mul_f32 v[88:89], v[88:89], v[136:137]
    v_cvt_pk_bf16_f32 v12, v88, v89
    v_pk_add_f32 v[90:91], v[114:115], v[144:145]
    v_pk_mul_f32 v[90:91], v[90:91], v[136:137]
    v_cvt_pk_bf16_f32 v13, v90, v91
    v_pk_add_f32 v[88:89], v[116:117], v[144:145]
    v_pk_mul_f32 v[88:89], v[88:89], v[136:137]
    v_cvt_pk_bf16_f32 v14, v88, v89
    v_pk_add_f32 v[90:91], v[118:119], v[144:145]
    v_pk_mul_f32 v[90:91], v[90:91], v[136:137]
    v_cvt_pk_bf16_f32 v15, v90, v91
    v_pk_add_f32 v[92:93], v[120:121], v[146:147]
    v_pk_mul_f32 v[92:93], v[92:93], v[140:141]
    v_cvt_pk_bf16_f32 v16, v92, v93
    v_pk_add_f32 v[94:95], v[122:123], v[146:147]
    v_pk_mul_f32 v[94:95], v[94:95], v[140:141]
    v_cvt_pk_bf16_f32 v17, v94, v95
    v_pk_add_f32 v[92:93], v[124:125], v[146:147]
    v_pk_mul_f32 v[92:93], v[92:93], v[140:141]
    v_cvt_pk_bf16_f32 v18, v92, v93
    v_pk_add_f32 v[94:95], v[126:127], v[146:147]
    v_pk_mul_f32 v[94:95], v[94:95], v[140:141]
    v_cvt_pk_bf16_f32 v19, v94, v95
    v_pk_add_f32 v[92:93], v[128:129], v[146:147]
    v_pk_mul_f32 v[92:93], v[92:93], v[140:141]
    v_cvt_pk_bf16_f32 v20, v92, v93
    v_pk_add_f32 v[94:95], v[130:131], v[146:147]
    v_pk_mul_f32 v[94:95], v[94:95], v[140:141]
    v_cvt_pk_bf16_f32 v21, v94, v95
    v_pk_add_f32 v[92:93], v[132:133], v[146:147]
    v_pk_mul_f32 v[92:93], v[92:93], v[140:141]
    v_cvt_pk_bf16_f32 v22, v92, v93
    v_pk_add_f32 v[94:95], v[134:135], v[146:147]
    v_pk_mul_f32 v[94:95], v[94:95], v[140:141]
    v_cvt_pk_bf16_f32 v23, v94, v95
    ds_write_b128 v2, v[8:11] offset:0
    ds_write_b128 v2, v[12:15] offset:16
    ds_write_b128 v2, v[16:19] offset:2048
    ds_write_b128 v2, v[20:23] offset:2064
    s_waitcnt lgkmcnt(0)
    ds_read_b64_tr_b16 v[152:153], v3 offset:0
    ds_read_b64_tr_b16 v[154:155], v3 offset:256
    ds_read_b64_tr_b16 v[156:157], v3 offset:1024
    ds_read_b64_tr_b16 v[158:159], v3 offset:1280
    ds_read_b64_tr_b16 v[160:161], v3 offset:2048
    ds_read_b64_tr_b16 v[162:163], v3 offset:2304
    ds_read_b64_tr_b16 v[164:165], v3 offset:3072
    ds_read_b64_tr_b16 v[166:167], v3 offset:3328
    s_waitcnt lgkmcnt(4)
    v_mfma_f32_32x32x16_bf16 v[168:183], v[152:155], v[24:27], 0
    v_mfma_f32_32x32x16_bf16 v[168:183], v[156:159], v[28:31], v[168:183]
    v_mfma_f32_32x32x16_bf16 v[184:199], v[152:155], v[32:35], 0
    v_mfma_f32_32x32x16_bf16 v[184:199], v[156:159], v[36:39], v[184:199]
    s_waitcnt lgkmcnt(0)
    v_mfma_f32_32x32x16_bf16 v[200:215], v[160:163], v[24:27], 0
    v_mfma_f32_32x32x16_bf16 v[200:215], v[164:167], v[28:31], v[200:215]
    v_mfma_f32_32x32x16_bf16 v[216:231], v[160:163], v[32:35], 0
    v_mfma_f32_32x32x16_bf16 v[216:231], v[164:167], v[36:39], v[216:231]
    s_barrier
    s_nop 3
    v_pk_add_f32 v[136:137], v[168:169], v[170:171]
    v_pk_add_f32 v[136:137], v[136:137], v[172:173]
    v_pk_add_f32 v[136:137], v[136:137], v[174:175]
    v_pk_add_f32 v[136:137], v[136:137], v[176:177]
    v_pk_add_f32 v[136:137], v[136:137], v[178:179]
    v_pk_add_f32 v[136:137], v[136:137], v[180:181]
    v_pk_add_f32 v[136:137], v[136:137], v[182:183]
    v_sub_f32 v136, v136, v137
    v_mov_b32 v137, v136
    s_nop 1
    v_permlane32_swap_b32 v136, v137
    v_add_f32 v136, v136, v137
    v_mov_b32 v137, 0
    v_cvt_pk_bf16_f32 v136, v136, v137
    v_pk_mul_f32 v[88:89], v[168:169], v[40:41]
    v_pk_mul_f32 v[90:91], v[184:185], v[40:41]
    v_pk_fma_f32 v[88:89], v[184:185], v[56:57], v[88:89]
    v_pk_fma_f32 v[90:91], v[168:169], v[56:57], v[90:91] neg_lo:[1,0,0] neg_hi:[1,0,0]
    v_cvt_pk_bf16_f32 v104, v88, v90
    v_cvt_pk_bf16_f32 v105, v89, v91
    v_pk_mul_f32 v[92:93], v[170:171], v[42:43]
    v_pk_mul_f32 v[94:95], v[186:187], v[42:43]
    v_pk_fma_f32 v[92:93], v[186:187], v[58:59], v[92:93]
    v_pk_fma_f32 v[94:95], v[170:171], v[58:59], v[94:95] neg_lo:[1,0,0] neg_hi:[1,0,0]
    v_cvt_pk_bf16_f32 v106, v92, v94
    v_cvt_pk_bf16_f32 v107, v93, v95
    v_pk_mul_f32 v[88:89], v[172:173], v[44:45]
    v_pk_mul_f32 v[90:91], v[188:189], v[44:45]
    v_pk_fma_f32 v[88:89], v[188:189], v[60:61], v[88:89]
    v_pk_fma_f32 v[90:91], v[172:173], v[60:61], v[90:91] neg_lo:[1,0,0] neg_hi:[1,0,0]
    v_cvt_pk_bf16_f32 v108, v88, v90
    v_cvt_pk_bf16_f32 v109, v89, v91
    v_pk_mul_f32 v[92:93], v[174:175], v[46:47]
    v_pk_mul_f32 v[94:95], v[190:191], v[46:47]
    v_pk_fma_f32 v[92:93], v[190:191], v[62:63], v[92:93]
    v_pk_fma_f32 v[94:95], v[174:175], v[62:63], v[94:95] neg_lo:[1,0,0] neg_hi:[1,0,0]
    v_cvt_pk_bf16_f32 v110, v92, v94
    v_cvt_pk_bf16_f32 v111, v93, v95
    v_pk_mul_f32 v[88:89], v[176:177], v[48:49]
    v_pk_mul_f32 v[90:91], v[192:193], v[48:49]
    v_pk_fma_f32 v[88:89], v[192:193], v[64:65], v[88:89]
    v_pk_fma_f32 v[90:91], v[176:177], v[64:65], v[90:91] neg_lo:[1,0,0] neg_hi:[1,0,0]
    v_cvt_pk_bf16_f32 v112, v88, v90
    v_cvt_pk_bf16_f32 v113, v89, v91
    v_pk_mul_f32 v[92:93], v[178:179], v[50:51]
    v_pk_mul_f32 v[94:95], v[194:195], v[50:51]
    v_pk_fma_f32 v[92:93], v[194:195], v[66:67], v[92:93]
    v_pk_fma_f32 v[94:95], v[178:179], v[66:67], v[94:95] neg_lo:[1,0,0] neg_hi:[1,0,0]
    v_cvt_pk_bf16_f32 v114, v92, v94
    v_cvt_pk_bf16_f32 v115, v93, v95
    v_pk_mul_f32 v[88:89], v[180:181], v[52:53]
    v_pk_mul_f32 v[90:91], v[196:197], v[52:53]
    v_pk_fma_f32 v[88:89], v[196:197], v[68:69], v[88:89]
    v_pk_fma_f32 v[90:91], v[180:181], v[68:69], v[90:91] neg_lo:[1,0,0] neg_hi:[1,0,0]
    v_cvt_pk_bf16_f32 v116, v88, v90
    v_cvt_pk_bf16_f32 v117, v89, v91
    v_pk_mul_f32 v[92:93], v[182:183], v[54:55]
    v_pk_mul_f32 v[94:95], v[198:199], v[54:55]
    v_pk_fma_f32 v[92:93], v[198:199], v[70:71], v[92:93]
    v_pk_fma_f32 v[94:95], v[182:183], v[70:71], v[94:95] neg_lo:[1,0,0] neg_hi:[1,0,0]
    v_cvt_pk_bf16_f32 v118, v92, v94
    v_cvt_pk_bf16_f32 v119, v93, v95
    v_mfma_f32_32x32x16_bf16 v[168:183], v[72:75], v[104:107], 0
    v_mfma_f32_32x32x16_bf16 v[168:183], v[76:79], v[108:111], v[168:183]
    v_mfma_f32_32x32x16_bf16 v[168:183], v[80:83], v[112:115], v[168:183]
    v_mfma_f32_32x32x16_bf16 v[168:183], v[84:87], v[116:119], v[168:183]
    v_pk_add_f32 v[140:141], v[200:201], v[202:203]
    v_pk_add_f32 v[140:141], v[140:141], v[204:205]
    v_pk_add_f32 v[140:141], v[140:141], v[206:207]
    v_pk_add_f32 v[140:141], v[140:141], v[208:209]
    v_pk_add_f32 v[140:141], v[140:141], v[210:211]
    v_pk_add_f32 v[140:141], v[140:141], v[212:213]
    v_pk_add_f32 v[140:141], v[140:141], v[214:215]
    v_sub_f32 v140, v140, v141
    v_mov_b32 v141, v140
    s_nop 1
    v_permlane32_swap_b32 v140, v141
    v_add_f32 v140, v140, v141
    v_mov_b32 v141, 0
    v_cvt_pk_bf16_f32 v140, v140, v141
    v_pk_mul_f32 v[88:89], v[200:201], v[40:41]
    v_pk_mul_f32 v[90:91], v[216:217], v[40:41]
    v_pk_fma_f32 v[88:89], v[216:217], v[56:57], v[88:89]
    v_pk_fma_f32 v[90:91], v[200:201], v[56:57], v[90:91] neg_lo:[1,0,0] neg_hi:[1,0,0]
    v_cvt_pk_bf16_f32 v120, v88, v90
    v_cvt_pk_bf16_f32 v121, v89, v91
    v_pk_mul_f32 v[92:93], v[202:203], v[42:43]
    v_pk_mul_f32 v[94:95], v[218:219], v[42:43]
    v_pk_fma_f32 v[92:93], v[218:219], v[58:59], v[92:93]
    v_pk_fma_f32 v[94:95], v[202:203], v[58:59], v[94:95] neg_lo:[1,0,0] neg_hi:[1,0,0]
    v_cvt_pk_bf16_f32 v122, v92, v94
    v_cvt_pk_bf16_f32 v123, v93, v95
    v_pk_mul_f32 v[88:89], v[204:205], v[44:45]
    v_pk_mul_f32 v[90:91], v[220:221], v[44:45]
    v_pk_fma_f32 v[88:89], v[220:221], v[60:61], v[88:89]
    v_pk_fma_f32 v[90:91], v[204:205], v[60:61], v[90:91] neg_lo:[1,0,0] neg_hi:[1,0,0]
    v_cvt_pk_bf16_f32 v124, v88, v90
    v_cvt_pk_bf16_f32 v125, v89, v91
    v_pk_mul_f32 v[92:93], v[206:207], v[46:47]
    v_pk_mul_f32 v[94:95], v[222:223], v[46:47]
    v_pk_fma_f32 v[92:93], v[222:223], v[62:63], v[92:93]
    v_pk_fma_f32 v[94:95], v[206:207], v[62:63], v[94:95] neg_lo:[1,0,0] neg_hi:[1,0,0]
    v_cvt_pk_bf16_f32 v126, v92, v94
    v_cvt_pk_bf16_f32 v127, v93, v95
    v_pk_mul_f32 v[88:89], v[208:209], v[48:49]
    v_pk_mul_f32 v[90:91], v[224:225], v[48:49]
    v_pk_fma_f32 v[88:89], v[224:225], v[64:65], v[88:89]
    v_pk_fma_f32 v[90:91], v[208:209], v[64:65], v[90:91] neg_lo:[1,0,0] neg_hi:[1,0,0]
    v_cvt_pk_bf16_f32 v128, v88, v90
    v_cvt_pk_bf16_f32 v129, v89, v91
    v_pk_mul_f32 v[92:93], v[210:211], v[50:51]
    v_pk_mul_f32 v[94:95], v[226:227], v[50:51]
    v_pk_fma_f32 v[92:93], v[226:227], v[66:67], v[92:93]
    v_pk_fma_f32 v[94:95], v[210:211], v[66:67], v[94:95] neg_lo:[1,0,0] neg_hi:[1,0,0]
    v_cvt_pk_bf16_f32 v130, v92, v94
    v_cvt_pk_bf16_f32 v131, v93, v95
    v_pk_mul_f32 v[88:89], v[212:213], v[52:53]
    v_pk_mul_f32 v[90:91], v[228:229], v[52:53]
    v_pk_fma_f32 v[88:89], v[228:229], v[68:69], v[88:89]
    v_pk_fma_f32 v[90:91], v[212:213], v[68:69], v[90:91] neg_lo:[1,0,0] neg_hi:[1,0,0]
    v_cvt_pk_bf16_f32 v132, v88, v90
    v_cvt_pk_bf16_f32 v133, v89, v91
    v_pk_mul_f32 v[92:93], v[214:215], v[54:55]
    v_pk_mul_f32 v[94:95], v[230:231], v[54:55]
    v_pk_fma_f32 v[92:93], v[230:231], v[70:71], v[92:93]
    v_pk_fma_f32 v[94:95], v[214:215], v[70:71], v[94:95] neg_lo:[1,0,0] neg_hi:[1,0,0]
    v_cvt_pk_bf16_f32 v134, v92, v94
    v_cvt_pk_bf16_f32 v135, v93, v95
    v_mfma_f32_32x32x16_bf16 v[200:215], v[72:75], v[120:123], 0
    v_mfma_f32_32x32x16_bf16 v[200:215], v[76:79], v[124:127], v[200:215]
    v_mfma_f32_32x32x16_bf16 v[200:215], v[80:83], v[128:131], v[200:215]
    v_mfma_f32_32x32x16_bf16 v[200:215], v[84:87], v[132:135], v[200:215]
    v_cvt_pk_bf16_f32 v184, v168, v169
    ds_write_b32 v4, v184 offset:0
    v_cvt_pk_bf16_f32 v185, v170, v171
    ds_write_b32 v4, v185 offset:2336
    v_cvt_pk_bf16_f32 v186, v172, v173
    ds_write_b32 v4, v186 offset:9344
    v_cvt_pk_bf16_f32 v187, v174, v175
    ds_write_b32 v4, v187 offset:11680
    v_cvt_pk_bf16_f32 v188, v176, v177
    ds_write_b32 v4, v188 offset:18688
    v_cvt_pk_bf16_f32 v189, v178, v179
    ds_write_b32 v4, v189 offset:21024
    v_cvt_pk_bf16_f32 v190, v180, v181
    ds_write_b32 v4, v190 offset:28032
    v_cvt_pk_bf16_f32 v191, v182, v183
    ds_write_b32 v4, v191 offset:30368
    v_cvt_pk_bf16_f32 v216, v200, v201
    ds_write_b32 v4, v216 offset:32
    v_cvt_pk_bf16_f32 v217, v202, v203
    ds_write_b32 v4, v217 offset:2368
    v_cvt_pk_bf16_f32 v218, v204, v205
    ds_write_b32 v4, v218 offset:9376
    v_cvt_pk_bf16_f32 v219, v206, v207
    ds_write_b32 v4, v219 offset:11712
    v_cvt_pk_bf16_f32 v220, v208, v209
    ds_write_b32 v4, v220 offset:18720
    v_cvt_pk_bf16_f32 v221, v210, v211
    ds_write_b32 v4, v221 offset:21056
    v_cvt_pk_bf16_f32 v222, v212, v213
    ds_write_b32 v4, v222 offset:28064
    v_cvt_pk_bf16_f32 v223, v214, v215
    ds_write_b32 v4, v223 offset:30400
    s_mov_b64 exec, 1
    ds_write_b32 v5, v136 offset:37376
    ds_write_b32 v5, v140 offset:37408
    s_mov_b64 exec, -1
    s_waitcnt lgkmcnt(0)
    s_barrier
    s_branch L_g1_start
L_wp_role:
    s_load_dwordx4 s[16:19], s[0:1], 8
    s_and_b32 s21, s2, 7
    s_lshr_b32 s22, s2, 3
    s_and_b32 s22, s22, 15
    s_and_b32 s24, s21, 3
    s_lshl_b32 s24, s24, 1
    s_and_b32 s25, s22, 1
    s_add_u32 s24, s24, s25
    s_lshr_b32 s23, s21, 2
    s_lshl_b32 s23, s23, 3
    s_lshr_b32 s25, s22, 1
    s_add_u32 s23, s23, s25
    s_lshl_b32 s25, s23, 2
    s_and_b32 s26, s20, 3
    s_add_u32 s25, s25, s26
    s_lshl_b32 s25, s25, 5
    s_lshl_b32 s26, s24, 2
    s_add_u32 s25, s25, s26
    s_lshr_b32 s26, s20, 2
    s_add_u32 s25, s25, s26
    s_mul_i32 s26, s25, 1026
    s_add_u32 s27, s26, 2052
    s_lshr_b32 s28, s23, 1
    s_lshl_b32 s28, s28, 6
    s_and_b32 s29, s23, 1
    s_lshl_b32 s29, s29, 5
    s_add_u32 s28, s28, s29
    s_lshl_b32 s29, s24, 2
    s_add_u32 s28, s28, s29
    s_lshl_b32 s28, s28, 4
    v_lshlrev_b32 v1, 4, v0
    v_mov_b32 v3, 1024
    s_and_b32 s34, s2, 127
    s_waitcnt lgkmcnt(0)
    s_mov_b32 s4, s16
    s_and_b32 s5, s17, 0xffff
    s_mov_b32 s6, 0x201000
    s_mov_b32 s7, 0x20000
    s_mov_b32 s8, s18
    s_and_b32 s9, s19, 0xffff
    s_mov_b32 s10, 0x201000
    s_mov_b32 s11, 0x20000
    v_mov_b32 v2, 0
    buffer_load_dwordx4 v[8:11], v1, s[4:7], s26 offen nt
    buffer_load_dwordx4 v[16:19], v1, s[8:11], s26 offen nt
    buffer_load_ushort v24, v3, s[4:7], s26 offen
    buffer_load_ushort v25, v3, s[8:11], s26 offen
    buffer_load_dwordx4 v[12:15], v1, s[4:7], s27 offen nt
    buffer_load_dwordx4 v[20:23], v1, s[8:11], s27 offen nt
    buffer_load_ushort v26, v3, s[4:7], s27 offen
    buffer_load_ushort v27, v3, s[8:11], s27 offen
    s_mov_b32 s36, s82
    s_and_b32 s37, s83, 0xffff
    s_mov_b32 s38, 0x700000
    s_mov_b32 s39, 0x20000
    s_lshl_b32 s35, s34, 3
    s_add_u32 s35, s35, s20
    s_lshl_b32 s35, s35, 13
    v_lshlrev_b32 v2, 6, v0
    s_cmp_lt_u32 s20, 4
    s_cbranch_scc1 L_noearly_wp
    s_sub_u32 s64, s20, 4
    s_mul_i32 s65, s76, 262144
    s_mul_i32 s66, s77, 512
    s_mul_i32 s40, s64, 32
    s_add_u32 s40, s40, 0
    v_lshrrev_b32 v236, 3, v0
    v_add_u32 v236, s40, v236
    v_lshrrev_b32 v237, 1, v236
    v_xor_b32 v237, v237, v0
    v_and_b32 v237, 7, v237
    v_lshlrev_b32 v237, 4, v237
    s_mov_b32 s41, 2048
    v_mul_lo_u32 v236, v236, s41
    v_add3_u32 v240, v236, v237, s65
    s_mul_i32 s40, s64, 32
    s_add_u32 s40, s40, 8
    v_lshrrev_b32 v236, 3, v0
    v_add_u32 v236, s40, v236
    v_lshrrev_b32 v237, 1, v236
    v_xor_b32 v237, v237, v0
    v_and_b32 v237, 7, v237
    v_lshlrev_b32 v237, 4, v237
    s_mov_b32 s41, 2048
    v_mul_lo_u32 v236, v236, s41
    v_add3_u32 v241, v236, v237, s65
    s_mul_i32 s40, s64, 32
    s_add_u32 s40, s40, 16
    v_lshrrev_b32 v236, 3, v0
    v_add_u32 v236, s40, v236
    v_lshrrev_b32 v237, 1, v236
    v_xor_b32 v237, v237, v0
    v_and_b32 v237, 7, v237
    v_lshlrev_b32 v237, 4, v237
    s_mov_b32 s41, 2048
    v_mul_lo_u32 v236, v236, s41
    v_add3_u32 v242, v236, v237, s65
    s_mul_i32 s40, s64, 32
    s_add_u32 s40, s40, 24
    v_lshrrev_b32 v236, 3, v0
    v_add_u32 v236, s40, v236
    v_lshrrev_b32 v237, 1, v236
    v_xor_b32 v237, v237, v0
    v_and_b32 v237, 7, v237
    v_lshlrev_b32 v237, 4, v237
    s_mov_b32 s41, 2048
    v_mul_lo_u32 v236, v236, s41
    v_add3_u32 v243, v236, v237, s65
    s_mul_i32 s40, s64, 16
    s_add_u32 s40, s40, 0
    v_lshrrev_b32 v236, 5, v0
    v_add_u32 v236, s40, v236
    v_and_b32 v237, 3, v236
    v_lshrrev_b32 v239, 1, v236
    v_and_b32 v239, 4, v239
    v_or_b32 v237, v237, v239
    v_lshlrev_b32 v237, 1, v237
    v_and_b32 v238, 31, v0
    v_xor_b32 v237, v237, v238
    v_lshlrev_b32 v237, 4, v237
    s_mov_b32 s41, 7168
    v_mul_lo_u32 v236, v236, s41
    v_add3_u32 v244, v236, v237, s66
    s_mul_i32 s40, s64, 16
    s_add_u32 s40, s40, 2
    v_lshrrev_b32 v236, 5, v0
    v_add_u32 v236, s40, v236
    v_and_b32 v237, 3, v236
    v_lshrrev_b32 v239, 1, v236
    v_and_b32 v239, 4, v239
    v_or_b32 v237, v237, v239
    v_lshlrev_b32 v237, 1, v237
    v_and_b32 v238, 31, v0
    v_xor_b32 v237, v237, v238
    v_lshlrev_b32 v237, 4, v237
    s_mov_b32 s41, 7168
    v_mul_lo_u32 v236, v236, s41
    v_add3_u32 v245, v236, v237, s66
    s_mul_i32 s40, s64, 16
    s_add_u32 s40, s40, 4
    v_lshrrev_b32 v236, 5, v0
    v_add_u32 v236, s40, v236
    v_and_b32 v237, 3, v236
    v_lshrrev_b32 v239, 1, v236
    v_and_b32 v239, 4, v239
    v_or_b32 v237, v237, v239
    v_lshlrev_b32 v237, 1, v237
    v_and_b32 v238, 31, v0
    v_xor_b32 v237, v237, v238
    v_lshlrev_b32 v237, 4, v237
    s_mov_b32 s41, 7168
    v_mul_lo_u32 v236, v236, s41
    v_add3_u32 v246, v236, v237, s66
    s_mul_i32 s40, s64, 16
    s_add_u32 s40, s40, 6
    v_lshrrev_b32 v236, 5, v0
    v_add_u32 v236, s40, v236
    v_and_b32 v237, 3, v236
    v_lshrrev_b32 v239, 1, v236
    v_and_b32 v239, 4, v239
    v_or_b32 v237, v237, v239
    v_lshlrev_b32 v237, 1, v237
    v_and_b32 v238, 31, v0
    v_xor_b32 v237, v237, v238
    v_lshlrev_b32 v237, 4, v237
    s_mov_b32 s41, 7168
    v_mul_lo_u32 v236, v236, s41
    v_add3_u32 v247, v236, v237, s66
    s_mul_i32 s40, s64, 16
    s_add_u32 s40, s40, 8
    v_lshrrev_b32 v236, 5, v0
    v_add_u32 v236, s40, v236
    v_and_b32 v237, 3, v236
    v_lshrrev_b32 v239, 1, v236
    v_and_b32 v239, 4, v239
    v_or_b32 v237, v237, v239
    v_lshlrev_b32 v237, 1, v237
    v_and_b32 v238, 31, v0
    v_xor_b32 v237, v237, v238
    v_lshlrev_b32 v237, 4, v237
    s_mov_b32 s41, 7168
    v_mul_lo_u32 v236, v236, s41
    v_add3_u32 v248, v236, v237, s66
    s_mul_i32 s40, s64, 16
    s_add_u32 s40, s40, 10
    v_lshrrev_b32 v236, 5, v0
    v_add_u32 v236, s40, v236
    v_and_b32 v237, 3, v236
    v_lshrrev_b32 v239, 1, v236
    v_and_b32 v239, 4, v239
    v_or_b32 v237, v237, v239
    v_lshlrev_b32 v237, 1, v237
    v_and_b32 v238, 31, v0
    v_xor_b32 v237, v237, v238
    v_lshlrev_b32 v237, 4, v237
    s_mov_b32 s41, 7168
    v_mul_lo_u32 v236, v236, s41
    v_add3_u32 v249, v236, v237, s66
    s_mul_i32 s40, s64, 16
    s_add_u32 s40, s40, 12
    v_lshrrev_b32 v236, 5, v0
    v_add_u32 v236, s40, v236
    v_and_b32 v237, 3, v236
    v_lshrrev_b32 v239, 1, v236
    v_and_b32 v239, 4, v239
    v_or_b32 v237, v237, v239
    v_lshlrev_b32 v237, 1, v237
    v_and_b32 v238, 31, v0
    v_xor_b32 v237, v237, v238
    v_lshlrev_b32 v237, 4, v237
    s_mov_b32 s41, 7168
    v_mul_lo_u32 v236, v236, s41
    v_add3_u32 v250, v236, v237, s66
    s_mul_i32 s40, s64, 16
    s_add_u32 s40, s40, 14
    v_lshrrev_b32 v236, 5, v0
    v_add_u32 v236, s40, v236
    v_and_b32 v237, 3, v236
    v_lshrrev_b32 v239, 1, v236
    v_and_b32 v239, 4, v239
    v_or_b32 v237, v237, v239
    v_lshlrev_b32 v237, 1, v237
    v_and_b32 v238, 31, v0
    v_xor_b32 v237, v237, v238
    v_lshlrev_b32 v237, 4, v237
    s_mov_b32 s41, 7168
    v_mul_lo_u32 v236, v236, s41
    v_add3_u32 v251, v236, v237, s66
L_noearly_wp:
    s_sub_u32 s64, s20, 4
    s_mov_b32 s68, s80
    s_and_b32 s69, s81, 0xffff
    s_mov_b32 s70, 0x400000
    s_mov_b32 s71, 0x20000
    s_mov_b32 s72, s82
    s_and_b32 s73, s83, 0xffff
    s_mov_b32 s74, 0x700000
    s_mov_b32 s75, 0x20000
    s_mul_i32 s78, s64, 4096
    s_mul_i32 s79, s64, 8192
    s_add_u32 s79, s79, 16384
    s_mov_b32 s67, 0
    s_add_u32 s12, s84, 0x1680000
    s_addc_u32 s13, s85, 0
    s_and_b32 s13, s13, 0xffff
    s_mov_b32 s14, 0x422100
    s_mov_b32 s15, 0x20000
    v_mul_u32_u24 v4, 584, v0
    s_lshl_b32 s31, s20, 2
    s_add_u32 s31, s31, 98304
    v_add_u32 v4, s31, v4
    s_mov_b32 s29, 0x05040100
    s_mov_b32 s30, 0x07060302
    s_waitcnt vmcnt(0)
    s_cmp_lt_u32 s20, 4
    s_cbranch_scc1 L_noissue_wp
    s_lshl_b32 s62, s76, 7
    s_mul_i32 s63, s76, 458752
    s_add_u32 m0, s78, 0
    s_nop 0
    buffer_load_dwordx4 v240, s[68:71], s62 offen lds
    s_add_u32 m0, s78, 1024
    s_nop 0
    buffer_load_dwordx4 v241, s[68:71], s62 offen lds
    s_add_u32 m0, s78, 2048
    s_nop 0
    buffer_load_dwordx4 v242, s[68:71], s62 offen lds
    s_add_u32 m0, s78, 3072
    s_nop 0
    buffer_load_dwordx4 v243, s[68:71], s62 offen lds
    s_add_u32 m0, s79, 0
    s_nop 0
    buffer_load_dwordx4 v244, s[72:75], s63 offen lds
    s_add_u32 m0, s79, 1024
    s_nop 0
    buffer_load_dwordx4 v245, s[72:75], s63 offen lds
    s_add_u32 m0, s79, 2048
    s_nop 0
    buffer_load_dwordx4 v246, s[72:75], s63 offen lds
    s_add_u32 m0, s79, 3072
    s_nop 0
    buffer_load_dwordx4 v247, s[72:75], s63 offen lds
    s_add_u32 m0, s79, 4096
    s_nop 0
    buffer_load_dwordx4 v248, s[72:75], s63 offen lds
    s_add_u32 m0, s79, 5120
    s_nop 0
    buffer_load_dwordx4 v249, s[72:75], s63 offen lds
    s_add_u32 m0, s79, 6144
    s_nop 0
    buffer_load_dwordx4 v250, s[72:75], s63 offen lds
    s_add_u32 m0, s79, 7168
    s_nop 0
    buffer_load_dwordx4 v251, s[72:75], s63 offen lds
L_noissue_wp:
    v_perm_b32 v44, v16, v8, s29
    v_perm_b32 v45, v16, v8, s30
    v_perm_b32 v46, v17, v9, s29
    v_perm_b32 v47, v17, v9, s30
    v_perm_b32 v48, v18, v10, s29
    v_perm_b32 v49, v18, v10, s30
    v_perm_b32 v50, v19, v11, s29
    v_perm_b32 v51, v19, v11, s30
    ds_write_b32 v4, v44 offset:0
    ds_write_b32 v4, v45 offset:72
    ds_write_b32 v4, v46 offset:144
    ds_write_b32 v4, v47 offset:216
    ds_write_b32 v4, v48 offset:288
    ds_write_b32 v4, v49 offset:360
    ds_write_b32 v4, v50 offset:432
    ds_write_b32 v4, v51 offset:504
    v_perm_b32 v52, v20, v12, s29
    v_perm_b32 v53, v20, v12, s30
    v_perm_b32 v54, v21, v13, s29
    v_perm_b32 v55, v21, v13, s30
    v_perm_b32 v56, v22, v14, s29
    v_perm_b32 v57, v22, v14, s30
    v_perm_b32 v58, v23, v15, s29
    v_perm_b32 v59, v23, v15, s30
    ds_write_b32 v4, v52 offset:32
    ds_write_b32 v4, v53 offset:104
    ds_write_b32 v4, v54 offset:176
    ds_write_b32 v4, v55 offset:248
    ds_write_b32 v4, v56 offset:320
    ds_write_b32 v4, v57 offset:392
    ds_write_b32 v4, v58 offset:464
    ds_write_b32 v4, v59 offset:536
    v_lshl_or_b32 v24, v25, 16, v24
    v_lshl_or_b32 v26, v27, 16, v26
    s_mov_b64 exec, 1
    v_mov_b32 v5, s31
    ds_write_b32 v5, v24 offset:37376
    ds_write_b32 v5, v26 offset:37408
    s_mov_b64 exec, -1
    s_waitcnt lgkmcnt(0)
    s_barrier
L_g1_start:
    s_mov_b32 s23, s76
    s_mov_b32 s24, s77
    s_mul_i32 s26, s23, 262144
    s_mul_i32 s27, s24, 512
    s_mov_b32 s43, 49152
    s_mov_b32 s44, 0xfffe8000
    s_cmp_ge_u32 s20, 4
    s_cbranch_scc1 L_loader_g1
    v_mov_b32 v235, 1
    s_cmp_lg_u32 s20, 0
    s_cbranch_scc1 L_nogate_g1
    s_mov_b32 s92, s86
    s_and_b32 s93, s87, 0xffff
    s_mov_b32 s94, 0x100
    s_mov_b32 s95, 0x20000
    v_mov_b32 v234, 0
    buffer_load_dword v235, v234, s[92:95], 0 offen sc1
L_nogate_g1:
    v_lshrrev_b32 v10, 2, v0
    v_and_b32 v11, 3, v0
    v_mul_u32_u24 v8, 72, v10
    v_lshrrev_b32 v9, 3, v10
    v_lshl_add_u32 v8, v9, 3, v8
    v_lshl_add_u32 v8, v11, 4, v8
    s_mul_i32 s40, s20, 1168
    s_add_u32 s40, s40, 98304
    v_add_u32 v8, s40, v8
    s_lshl_b32 s40, s20, 4
    v_add_u32 v9, s40, v10
    s_mov_b32 s41, 8448
    v_mul_lo_u32 v9, v9, s41
    v_lshl_add_u32 v9, v11, 4, v9
    ds_read_b64 v[12:13], v8 offset:0
    ds_read_b64 v[14:15], v8 offset:8
    ds_read_b64 v[16:17], v8 offset:9344
    ds_read_b64 v[18:19], v8 offset:9352
    ds_read_b64 v[20:21], v8 offset:18688
    ds_read_b64 v[22:23], v8 offset:18696
    ds_read_b64 v[24:25], v8 offset:28032
    ds_read_b64 v[26:27], v8 offset:28040
    s_cmp_lg_u32 s20, 0
    s_cbranch_scc1 L_no5_g1a
    ds_read_b64 v[28:29], v8 offset:37376
    ds_read_b64 v[30:31], v8 offset:37384
    s_add_u32 s41, s28, 4325376
    s_waitcnt lgkmcnt(0)
    buffer_store_dwordx4 v[28:31], v9, s[12:15], s41 offen sc1
L_no5_g1a:
    s_add_u32 s41, s28, 0
    s_waitcnt lgkmcnt(6)
    buffer_store_dwordx4 v[12:15], v9, s[12:15], s41 offen sc1
    s_add_u32 s41, s28, 1081344
    s_waitcnt lgkmcnt(4)
    buffer_store_dwordx4 v[16:19], v9, s[12:15], s41 offen sc1
    s_add_u32 s41, s28, 2162688
    s_waitcnt lgkmcnt(2)
    buffer_store_dwordx4 v[20:23], v9, s[12:15], s41 offen sc1
    s_add_u32 s41, s28, 3244032
    s_waitcnt lgkmcnt(0)
    buffer_store_dwordx4 v[24:27], v9, s[12:15], s41 offen sc1
    s_add_u32 s21, s20, 4
    v_lshrrev_b32 v42, 2, v0
    v_and_b32 v43, 3, v0
    v_mul_u32_u24 v40, 72, v42
    v_lshrrev_b32 v41, 3, v42
    v_lshl_add_u32 v40, v41, 3, v40
    v_lshl_add_u32 v40, v43, 4, v40
    s_mul_i32 s40, s21, 1168
    s_add_u32 s40, s40, 98304
    v_add_u32 v40, s40, v40
    s_lshl_b32 s40, s21, 4
    v_add_u32 v41, s40, v42
    s_mov_b32 s41, 8448
    v_mul_lo_u32 v41, v41, s41
    v_lshl_add_u32 v41, v43, 4, v41
    ds_read_b64 v[44:45], v40 offset:0
    ds_read_b64 v[46:47], v40 offset:8
    ds_read_b64 v[48:49], v40 offset:9344
    ds_read_b64 v[50:51], v40 offset:9352
    ds_read_b64 v[52:53], v40 offset:18688
    ds_read_b64 v[54:55], v40 offset:18696
    ds_read_b64 v[56:57], v40 offset:28032
    ds_read_b64 v[58:59], v40 offset:28040
    s_cmp_lg_u32 s21, 0
    s_cbranch_scc1 L_no5_g1b
    ds_read_b64 v[60:61], v40 offset:37376
    ds_read_b64 v[62:63], v40 offset:37384
    s_add_u32 s41, s28, 4325376
    s_waitcnt lgkmcnt(0)
    buffer_store_dwordx4 v[60:63], v41, s[12:15], s41 offen sc1
L_no5_g1b:
    s_add_u32 s41, s28, 0
    s_waitcnt lgkmcnt(6)
    buffer_store_dwordx4 v[44:47], v41, s[12:15], s41 offen sc1
    s_add_u32 s41, s28, 1081344
    s_waitcnt lgkmcnt(4)
    buffer_store_dwordx4 v[48:51], v41, s[12:15], s41 offen sc1
    s_add_u32 s41, s28, 2162688
    s_waitcnt lgkmcnt(2)
    buffer_store_dwordx4 v[52:55], v41, s[12:15], s41 offen sc1
    s_add_u32 s41, s28, 3244032
    s_waitcnt lgkmcnt(0)
    buffer_store_dwordx4 v[56:59], v41, s[12:15], s41 offen sc1
    s_add_u32 s12, s84, 0x400000
    s_addc_u32 s13, s85, 0
    s_and_b32 s13, s13, 0xffff
    s_mov_b32 s14, 0xe00000
    s_mov_b32 s15, 0x20000
    s_and_b32 s37, s20, 3
    s_lshr_b32 s36, s20, 2
    v_and_b32 v1, 15, v0
    s_mul_i32 s40, s36, 128
    v_add_u32 v1, s40, v1
    v_lshrrev_b32 v2, 1, v1
    v_and_b32 v2, 7, v2
    v_lshrrev_b32 v3, 4, v0
    v_xor_b32 v2, v2, v3
    v_lshlrev_b32 v1, 7, v1
    v_xor_b32 v3, 0, v2
    v_lshl_add_u32 v72, v3, 4, v1
    v_xor_b32 v3, 4, v2
    v_lshl_add_u32 v73, v3, 4, v1
    v_lshrrev_b32 v1, 2, v0
    v_and_b32 v1, 3, v1
    v_lshrrev_b32 v3, 4, v0
    v_lshl_add_u32 v1, v3, 3, v1
    v_and_b32 v2, 3, v1
    v_lshrrev_b32 v4, 1, v1
    v_and_b32 v4, 4, v4
    v_or_b32 v2, v2, v4
    v_lshlrev_b32 v2, 1, v2
    s_mov_b32 s41, 512
    v_mul_lo_u32 v1, v1, s41
    v_and_b32 v3, 1, v0
    v_lshl_add_u32 v1, v3, 3, v1
    v_add_u32 v1, 16384, v1
    v_lshrrev_b32 v3, 1, v0
    v_and_b32 v3, 1, v3
    s_mul_i32 s40, s37, 8
    s_add_u32 s40, s40, 0
    v_add_u32 v4, s40, v3
    v_xor_b32 v4, v4, v2
    v_lshl_add_u32 v74, v4, 4, v1
    s_mul_i32 s40, s37, 8
    s_add_u32 s40, s40, 2
    v_add_u32 v4, s40, v3
    v_xor_b32 v4, v4, v2
    v_lshl_add_u32 v75, v4, 4, v1
    s_mul_i32 s40, s37, 8
    s_add_u32 s40, s40, 4
    v_add_u32 v4, s40, v3
    v_xor_b32 v4, v4, v2
    v_lshl_add_u32 v76, v4, 4, v1
    s_mul_i32 s40, s37, 8
    s_add_u32 s40, s40, 6
    v_add_u32 v4, s40, v3
    v_xor_b32 v4, v4, v2
    v_lshl_add_u32 v77, v4, 4, v1
    v_add_u32 v78, 49152, v72
    v_add_u32 v79, 49152, v73
    v_add_u32 v80, 49152, v74
    v_add_u32 v81, 49152, v75
    v_add_u32 v82, 49152, v76
    v_add_u32 v83, 49152, v77
    v_add_u32 v84, 98304, v72
    v_add_u32 v85, 98304, v73
    v_add_u32 v86, 98304, v74
    v_add_u32 v87, 98304, v75
    v_add_u32 v88, 98304, v76
    v_add_u32 v89, 98304, v77
    v_mov_b32 v92, 0
    v_mov_b32 v93, 0
    v_mov_b32 v94, 0
    v_mov_b32 v95, 0
    v_mov_b32 v96, 0
    v_mov_b32 v97, 0
    v_mov_b32 v98, 0
    v_mov_b32 v99, 0
    v_mov_b32 v100, 0
    v_mov_b32 v101, 0
    v_mov_b32 v102, 0
    v_mov_b32 v103, 0
    v_mov_b32 v104, 0
    v_mov_b32 v105, 0
    v_mov_b32 v106, 0
    v_mov_b32 v107, 0
    v_mov_b32 v108, 0
    v_mov_b32 v109, 0
    v_mov_b32 v110, 0
    v_mov_b32 v111, 0
    v_mov_b32 v112, 0
    v_mov_b32 v113, 0
    v_mov_b32 v114, 0
    v_mov_b32 v115, 0
    v_mov_b32 v116, 0
    v_mov_b32 v117, 0
    v_mov_b32 v118, 0
    v_mov_b32 v119, 0
    v_mov_b32 v120, 0
    v_mov_b32 v121, 0
    v_mov_b32 v122, 0
    v_mov_b32 v123, 0
    v_mov_b32 v124, 0
    v_mov_b32 v125, 0
    v_mov_b32 v126, 0
    v_mov_b32 v127, 0
    v_mov_b32 v128, 0
    v_mov_b32 v129, 0
    v_mov_b32 v130, 0
    v_mov_b32 v131, 0
    v_mov_b32 v132, 0
    v_mov_b32 v133, 0
    v_mov_b32 v134, 0
    v_mov_b32 v135, 0
    v_mov_b32 v136, 0
    v_mov_b32 v137, 0
    v_mov_b32 v138, 0
    v_mov_b32 v139, 0
    v_mov_b32 v140, 0
    v_mov_b32 v141, 0
    v_mov_b32 v142, 0
    v_mov_b32 v143, 0
    v_mov_b32 v144, 0
    v_mov_b32 v145, 0
    v_mov_b32 v146, 0
    v_mov_b32 v147, 0
    v_mov_b32 v148, 0
    v_mov_b32 v149, 0
    v_mov_b32 v150, 0
    v_mov_b32 v151, 0
    v_mov_b32 v152, 0
    v_mov_b32 v153, 0
    v_mov_b32 v154, 0
    v_mov_b32 v155, 0
    v_mov_b32 v156, 0
    v_mov_b32 v157, 0
    v_mov_b32 v158, 0
    v_mov_b32 v159, 0
    v_mov_b32 v160, 0
    v_mov_b32 v161, 0
    v_mov_b32 v162, 0
    v_mov_b32 v163, 0
    v_mov_b32 v164, 0
    v_mov_b32 v165, 0
    v_mov_b32 v166, 0
    v_mov_b32 v167, 0
    v_mov_b32 v168, 0
    v_mov_b32 v169, 0
    v_mov_b32 v170, 0
    v_mov_b32 v171, 0
    v_mov_b32 v172, 0
    v_mov_b32 v173, 0
    v_mov_b32 v174, 0
    v_mov_b32 v175, 0
    v_mov_b32 v176, 0
    v_mov_b32 v177, 0
    v_mov_b32 v178, 0
    v_mov_b32 v179, 0
    v_mov_b32 v180, 0
    v_mov_b32 v181, 0
    v_mov_b32 v182, 0
    v_mov_b32 v183, 0
    v_mov_b32 v184, 0
    v_mov_b32 v185, 0
    v_mov_b32 v186, 0
    v_mov_b32 v187, 0
    v_mov_b32 v188, 0
    v_mov_b32 v189, 0
    v_mov_b32 v190, 0
    v_mov_b32 v191, 0
    v_mov_b32 v192, 0
    v_mov_b32 v193, 0
    v_mov_b32 v194, 0
    v_mov_b32 v195, 0
    v_mov_b32 v196, 0
    v_mov_b32 v197, 0
    v_mov_b32 v198, 0
    v_mov_b32 v199, 0
    v_mov_b32 v200, 0
    v_mov_b32 v201, 0
    v_mov_b32 v202, 0
    v_mov_b32 v203, 0
    v_mov_b32 v204, 0
    v_mov_b32 v205, 0
    v_mov_b32 v206, 0
    v_mov_b32 v207, 0
    v_mov_b32 v208, 0
    v_mov_b32 v209, 0
    v_mov_b32 v210, 0
    v_mov_b32 v211, 0
    v_mov_b32 v212, 0
    v_mov_b32 v213, 0
    v_mov_b32 v214, 0
    v_mov_b32 v215, 0
    v_mov_b32 v216, 0
    v_mov_b32 v217, 0
    v_mov_b32 v218, 0
    v_mov_b32 v219, 0
    s_waitcnt lgkmcnt(0)
    v_mov_b32 v2, 0
    s_waitcnt vmcnt(0)
    v_mov_b32 v3, v235
    v_mov_b32 v220, 0x3f803f80
    v_mov_b32 v221, 0x3f803f80
    v_mov_b32 v222, 0x3f803f80
    v_mov_b32 v223, 0x3f803f80
    v_and_b32 v237, 15, v0
    v_lshrrev_b32 v236, 4, v0
    v_lshlrev_b32 v236, 4, v236
    v_lshl_add_u32 v236, v237, 6, v236
    s_mul_i32 s40, s76, 14336
    s_lshl_b32 s41, s77, 10
    s_add_u32 s40, s40, s41
    s_lshl_b32 s41, s37, 8
    s_add_u32 s40, s40, s41
    v_add_u32 v236, s40, v236
    s_add_u32 s4, s84, 0x2c40000
    s_addc_u32 s5, s85, 0
    s_and_b32 s5, s5, 0xffff
    s_mov_b32 s6, 0x38000
    s_mov_b32 s7, 0x20000
    s_barrier
    ds_read_b64_tr_b16 v[8:9], v74 offset:0
    ds_read_b64_tr_b16 v[10:11], v74 offset:2048
    ds_read_b64_tr_b16 v[12:13], v75 offset:0
    ds_read_b64_tr_b16 v[14:15], v75 offset:2048
    ds_read_b64_tr_b16 v[16:17], v76 offset:0
    ds_read_b64_tr_b16 v[18:19], v76 offset:2048
    ds_read_b64_tr_b16 v[20:21], v77 offset:0
    ds_read_b64_tr_b16 v[22:23], v77 offset:2048
    ds_read_b128 v[40:43], v72 offset:0
    ds_read_b128 v[44:47], v72 offset:2048
    ds_read_b128 v[48:51], v72 offset:4096
    ds_read_b128 v[52:55], v72 offset:6144
    ds_read_b128 v[56:59], v72 offset:8192
    ds_read_b128 v[60:63], v72 offset:10240
    ds_read_b128 v[64:67], v72 offset:12288
    ds_read_b128 v[68:71], v72 offset:14336
    s_cmp_lg_u32 s20, 0
    s_cbranch_scc1 L_nosig_g1
    s_mov_b32 s92, s86
    s_and_b32 s93, s87, 0xffff
    s_mov_b32 s94, 0x100
    s_mov_b32 s95, 0x20000
    s_mov_b32 s42, 0
L_gate_g1:
    v_readfirstlane_b32 s40, v3
    s_cmp_eq_u32 s40, 1
    s_cbranch_scc1 L_gateok_g1
    s_sleep 16
    buffer_load_dword v3, v2, s[92:95], 0 offen sc1
    s_waitcnt vmcnt(0)
    s_add_u32 s42, s42, 1
    s_cmp_lt_u32 s42, 0x8000
    s_cbranch_scc1 L_gate_g1
L_gateok_g1:
    s_add_u32 s96, s84, 0x2c30000
    s_addc_u32 s97, s85, 0
    s_and_b32 s97, s97, 0xffff
    s_mov_b32 s98, 0x3000
    s_mov_b32 s99, 0x20000
    s_lshr_b32 s40, s2, 3
    s_lshl_b32 s40, s40, 7
    s_and_b32 s41, s2, 7
    s_lshl_b32 s41, s41, 2
    s_add_u32 s40, s40, s41
    v_mov_b32 v2, s40
    v_mov_b32 v3, 1
    s_mov_b64 exec, 1
    buffer_store_dword v3, v2, s[96:99], 0 offen sc1
    s_mov_b64 exec, -1
L_nosig_g1:
    s_waitcnt lgkmcnt(0)
    s_waitcnt lgkmcnt(7)
    v_mfma_f32_16x16x32_bf16 v[92:95], v[8:11], v[40:43], v[92:95]
    ds_read_b64_tr_b16 v[24:25], v74 offset:16384
    v_mfma_f32_16x16x32_bf16 v[96:99], v[12:15], v[40:43], v[96:99]
    ds_read_b64_tr_b16 v[26:27], v74 offset:18432
    v_mfma_f32_16x16x32_bf16 v[100:103], v[16:19], v[40:43], v[100:103]
    ds_read_b64_tr_b16 v[28:29], v75 offset:16384
    v_mfma_f32_16x16x32_bf16 v[104:107], v[20:23], v[40:43], v[104:107]
    ds_read_b64_tr_b16 v[30:31], v75 offset:18432
    s_waitcnt lgkmcnt(10)
    v_mfma_f32_16x16x32_bf16 v[108:111], v[8:11], v[44:47], v[108:111]
    ds_read_b64_tr_b16 v[32:33], v76 offset:16384
    v_mfma_f32_16x16x32_bf16 v[112:115], v[12:15], v[44:47], v[112:115]
    ds_read_b64_tr_b16 v[34:35], v76 offset:18432
    v_mfma_f32_16x16x32_bf16 v[116:119], v[16:19], v[44:47], v[116:119]
    ds_read_b64_tr_b16 v[36:37], v77 offset:16384
    v_mfma_f32_16x16x32_bf16 v[120:123], v[20:23], v[44:47], v[120:123]
    ds_read_b64_tr_b16 v[38:39], v77 offset:18432
    s_waitcnt lgkmcnt(13)
    v_mfma_f32_16x16x32_bf16 v[124:127], v[8:11], v[48:51], v[124:127]
    ds_read_b128 v[40:43], v73 offset:0
    v_mfma_f32_16x16x32_bf16 v[128:131], v[12:15], v[48:51], v[128:131]
    ds_read_b128 v[44:47], v73 offset:2048
    v_mfma_f32_16x16x32_bf16 v[132:135], v[16:19], v[48:51], v[132:135]
    v_mfma_f32_16x16x32_bf16 v[136:139], v[20:23], v[48:51], v[136:139]
    ds_read_b128 v[48:51], v73 offset:4096
    s_waitcnt lgkmcnt(15)
    v_mfma_f32_16x16x32_bf16 v[140:143], v[8:11], v[52:55], v[140:143]
    v_mfma_f32_16x16x32_bf16 v[144:147], v[12:15], v[52:55], v[144:147]
    v_mfma_f32_16x16x32_bf16 v[148:151], v[16:19], v[52:55], v[148:151]
    v_mfma_f32_16x16x32_bf16 v[152:155], v[20:23], v[52:55], v[152:155]
    ds_read_b128 v[52:55], v73 offset:6144
    s_waitcnt lgkmcnt(15)
    v_mfma_f32_16x16x32_bf16 v[156:159], v[8:11], v[56:59], v[156:159]
    v_mfma_f32_16x16x32_bf16 v[160:163], v[12:15], v[56:59], v[160:163]
    v_mfma_f32_16x16x32_bf16 v[164:167], v[16:19], v[56:59], v[164:167]
    v_mfma_f32_16x16x32_bf16 v[168:171], v[20:23], v[56:59], v[168:171]
    ds_read_b128 v[56:59], v73 offset:8192
    s_waitcnt lgkmcnt(15)
    v_mfma_f32_16x16x32_bf16 v[172:175], v[8:11], v[60:63], v[172:175]
    v_mfma_f32_16x16x32_bf16 v[176:179], v[12:15], v[60:63], v[176:179]
    v_mfma_f32_16x16x32_bf16 v[180:183], v[16:19], v[60:63], v[180:183]
    v_mfma_f32_16x16x32_bf16 v[184:187], v[20:23], v[60:63], v[184:187]
    ds_read_b128 v[60:63], v73 offset:10240
    s_waitcnt lgkmcnt(15)
    v_mfma_f32_16x16x32_bf16 v[188:191], v[8:11], v[64:67], v[188:191]
    v_mfma_f32_16x16x32_bf16 v[192:195], v[12:15], v[64:67], v[192:195]
    v_mfma_f32_16x16x32_bf16 v[196:199], v[16:19], v[64:67], v[196:199]
    v_mfma_f32_16x16x32_bf16 v[200:203], v[20:23], v[64:67], v[200:203]
    ds_read_b128 v[64:67], v73 offset:12288
    s_waitcnt lgkmcnt(15)
    v_mfma_f32_16x16x32_bf16 v[204:207], v[8:11], v[68:71], v[204:207]
    v_mfma_f32_16x16x32_bf16 v[208:211], v[12:15], v[68:71], v[208:211]
    v_mfma_f32_16x16x32_bf16 v[212:215], v[16:19], v[68:71], v[212:215]
    v_mfma_f32_16x16x32_bf16 v[216:219], v[20:23], v[68:71], v[216:219]
    ds_read_b128 v[68:71], v73 offset:14336
    v_mfma_f32_16x16x32_bf16 v[240:243], v[8:11], v[220:223], 0
    v_mfma_f32_16x16x32_bf16 v[244:247], v[12:15], v[220:223], 0
    v_mfma_f32_16x16x32_bf16 v[248:251], v[16:19], v[220:223], 0
    v_mfma_f32_16x16x32_bf16 v[252:255], v[20:23], v[220:223], 0
    s_waitcnt lgkmcnt(7)
    v_mfma_f32_16x16x32_bf16 v[92:95], v[24:27], v[40:43], v[92:95]
    v_mfma_f32_16x16x32_bf16 v[96:99], v[28:31], v[40:43], v[96:99]
    v_mfma_f32_16x16x32_bf16 v[100:103], v[32:35], v[40:43], v[100:103]
    v_mfma_f32_16x16x32_bf16 v[104:107], v[36:39], v[40:43], v[104:107]
    s_waitcnt lgkmcnt(6)
    v_mfma_f32_16x16x32_bf16 v[108:111], v[24:27], v[44:47], v[108:111]
    v_mfma_f32_16x16x32_bf16 v[112:115], v[28:31], v[44:47], v[112:115]
    v_mfma_f32_16x16x32_bf16 v[116:119], v[32:35], v[44:47], v[116:119]
    v_mfma_f32_16x16x32_bf16 v[120:123], v[36:39], v[44:47], v[120:123]
    s_waitcnt lgkmcnt(5)
    v_mfma_f32_16x16x32_bf16 v[124:127], v[24:27], v[48:51], v[124:127]
    v_mfma_f32_16x16x32_bf16 v[128:131], v[28:31], v[48:51], v[128:131]
    v_mfma_f32_16x16x32_bf16 v[132:135], v[32:35], v[48:51], v[132:135]
    v_mfma_f32_16x16x32_bf16 v[136:139], v[36:39], v[48:51], v[136:139]
    s_waitcnt lgkmcnt(4)
    v_mfma_f32_16x16x32_bf16 v[140:143], v[24:27], v[52:55], v[140:143]
    v_mfma_f32_16x16x32_bf16 v[144:147], v[28:31], v[52:55], v[144:147]
    v_mfma_f32_16x16x32_bf16 v[148:151], v[32:35], v[52:55], v[148:151]
    v_mfma_f32_16x16x32_bf16 v[152:155], v[36:39], v[52:55], v[152:155]
    s_waitcnt lgkmcnt(0)
    s_barrier
    v_mfma_f32_16x16x32_bf16 v[156:159], v[24:27], v[56:59], v[156:159]
    ds_read_b64_tr_b16 v[8:9], v80 offset:0
    ds_read_b64_tr_b16 v[10:11], v80 offset:2048
    v_mfma_f32_16x16x32_bf16 v[160:163], v[28:31], v[56:59], v[160:163]
    ds_read_b64_tr_b16 v[12:13], v81 offset:0
    ds_read_b64_tr_b16 v[14:15], v81 offset:2048
    v_mfma_f32_16x16x32_bf16 v[164:167], v[32:35], v[56:59], v[164:167]
    ds_read_b64_tr_b16 v[16:17], v82 offset:0
    ds_read_b64_tr_b16 v[18:19], v82 offset:2048
    v_mfma_f32_16x16x32_bf16 v[168:171], v[36:39], v[56:59], v[168:171]
    ds_read_b64_tr_b16 v[20:21], v83 offset:0
    ds_read_b64_tr_b16 v[22:23], v83 offset:2048
    v_mfma_f32_16x16x32_bf16 v[172:175], v[24:27], v[60:63], v[172:175]
    ds_read_b128 v[40:43], v78 offset:0
    ds_read_b128 v[44:47], v78 offset:2048
    v_mfma_f32_16x16x32_bf16 v[176:179], v[28:31], v[60:63], v[176:179]
    ds_read_b128 v[48:51], v78 offset:4096
    ds_read_b128 v[52:55], v78 offset:6144
    v_mfma_f32_16x16x32_bf16 v[180:183], v[32:35], v[60:63], v[180:183]
    ds_read_b128 v[56:59], v78 offset:8192
    v_mfma_f32_16x16x32_bf16 v[184:187], v[36:39], v[60:63], v[184:187]
    ds_read_b128 v[60:63], v78 offset:10240
    v_mfma_f32_16x16x32_bf16 v[188:191], v[24:27], v[64:67], v[188:191]
    v_mfma_f32_16x16x32_bf16 v[192:195], v[28:31], v[64:67], v[192:195]
    v_mfma_f32_16x16x32_bf16 v[196:199], v[32:35], v[64:67], v[196:199]
    v_mfma_f32_16x16x32_bf16 v[200:203], v[36:39], v[64:67], v[200:203]
    ds_read_b128 v[64:67], v78 offset:12288
    v_mfma_f32_16x16x32_bf16 v[204:207], v[24:27], v[68:71], v[204:207]
    v_mfma_f32_16x16x32_bf16 v[208:211], v[28:31], v[68:71], v[208:211]
    v_mfma_f32_16x16x32_bf16 v[212:215], v[32:35], v[68:71], v[212:215]
    v_mfma_f32_16x16x32_bf16 v[216:219], v[36:39], v[68:71], v[216:219]
    ds_read_b128 v[68:71], v78 offset:14336
    v_mfma_f32_16x16x32_bf16 v[240:243], v[24:27], v[220:223], v[240:243]
    v_mfma_f32_16x16x32_bf16 v[244:247], v[28:31], v[220:223], v[244:247]
    v_mfma_f32_16x16x32_bf16 v[248:251], v[32:35], v[220:223], v[248:251]
    v_mfma_f32_16x16x32_bf16 v[252:255], v[36:39], v[220:223], v[252:255]
    v_cmp_eq_u32 vcc, 1, v237
    s_nop 4
    v_cndmask_b32 v240, v240, v244, vcc
    v_cndmask_b32 v241, v241, v245, vcc
    v_cndmask_b32 v242, v242, v246, vcc
    v_cndmask_b32 v243, v243, v247, vcc
    v_cmp_eq_u32 vcc, 2, v237
    s_nop 1
    v_cndmask_b32 v240, v240, v248, vcc
    v_cndmask_b32 v241, v241, v249, vcc
    v_cndmask_b32 v242, v242, v250, vcc
    v_cndmask_b32 v243, v243, v251, vcc
    v_cmp_eq_u32 vcc, 3, v237
    s_nop 1
    v_cndmask_b32 v240, v240, v252, vcc
    v_cndmask_b32 v241, v241, v253, vcc
    v_cndmask_b32 v242, v242, v254, vcc
    v_cndmask_b32 v243, v243, v255, vcc
    s_mov_b32 exec_lo, 0x000f000f
    s_mov_b32 exec_hi, 0x000f000f
    buffer_store_dwordx4 v[240:243], v236, s[4:7], 0 offen sc1
    s_mov_b64 exec, -1
    s_mov_b32 s32, 0
L_cons_g1:
    s_waitcnt lgkmcnt(7)
    v_mfma_f32_16x16x32_bf16 v[92:95], v[8:11], v[40:43], v[92:95]
    ds_read_b64_tr_b16 v[24:25], v80 offset:16384
    v_mfma_f32_16x16x32_bf16 v[96:99], v[12:15], v[40:43], v[96:99]
    ds_read_b64_tr_b16 v[26:27], v80 offset:18432
    v_mfma_f32_16x16x32_bf16 v[100:103], v[16:19], v[40:43], v[100:103]
    ds_read_b64_tr_b16 v[28:29], v81 offset:16384
    v_mfma_f32_16x16x32_bf16 v[104:107], v[20:23], v[40:43], v[104:107]
    ds_read_b64_tr_b16 v[30:31], v81 offset:18432
    s_waitcnt lgkmcnt(10)
    v_mfma_f32_16x16x32_bf16 v[108:111], v[8:11], v[44:47], v[108:111]
    ds_read_b64_tr_b16 v[32:33], v82 offset:16384
    v_mfma_f32_16x16x32_bf16 v[112:115], v[12:15], v[44:47], v[112:115]
    ds_read_b64_tr_b16 v[34:35], v82 offset:18432
    v_mfma_f32_16x16x32_bf16 v[116:119], v[16:19], v[44:47], v[116:119]
    ds_read_b64_tr_b16 v[36:37], v83 offset:16384
    v_mfma_f32_16x16x32_bf16 v[120:123], v[20:23], v[44:47], v[120:123]
    ds_read_b64_tr_b16 v[38:39], v83 offset:18432
    s_waitcnt lgkmcnt(13)
    v_mfma_f32_16x16x32_bf16 v[124:127], v[8:11], v[48:51], v[124:127]
    ds_read_b128 v[40:43], v79 offset:0
    v_mfma_f32_16x16x32_bf16 v[128:131], v[12:15], v[48:51], v[128:131]
    ds_read_b128 v[44:47], v79 offset:2048
    v_mfma_f32_16x16x32_bf16 v[132:135], v[16:19], v[48:51], v[132:135]
    v_mfma_f32_16x16x32_bf16 v[136:139], v[20:23], v[48:51], v[136:139]
    ds_read_b128 v[48:51], v79 offset:4096
    s_waitcnt lgkmcnt(15)
    v_mfma_f32_16x16x32_bf16 v[140:143], v[8:11], v[52:55], v[140:143]
    v_mfma_f32_16x16x32_bf16 v[144:147], v[12:15], v[52:55], v[144:147]
    v_mfma_f32_16x16x32_bf16 v[148:151], v[16:19], v[52:55], v[148:151]
    v_mfma_f32_16x16x32_bf16 v[152:155], v[20:23], v[52:55], v[152:155]
    ds_read_b128 v[52:55], v79 offset:6144
    s_waitcnt lgkmcnt(15)
    v_mfma_f32_16x16x32_bf16 v[156:159], v[8:11], v[56:59], v[156:159]
    v_mfma_f32_16x16x32_bf16 v[160:163], v[12:15], v[56:59], v[160:163]
    v_mfma_f32_16x16x32_bf16 v[164:167], v[16:19], v[56:59], v[164:167]
    v_mfma_f32_16x16x32_bf16 v[168:171], v[20:23], v[56:59], v[168:171]
    ds_read_b128 v[56:59], v79 offset:8192
    s_waitcnt lgkmcnt(15)
    v_mfma_f32_16x16x32_bf16 v[172:175], v[8:11], v[60:63], v[172:175]
    v_mfma_f32_16x16x32_bf16 v[176:179], v[12:15], v[60:63], v[176:179]
    v_mfma_f32_16x16x32_bf16 v[180:183], v[16:19], v[60:63], v[180:183]
    v_mfma_f32_16x16x32_bf16 v[184:187], v[20:23], v[60:63], v[184:187]
    ds_read_b128 v[60:63], v79 offset:10240
    s_waitcnt lgkmcnt(15)
    v_mfma_f32_16x16x32_bf16 v[188:191], v[8:11], v[64:67], v[188:191]
    v_mfma_f32_16x16x32_bf16 v[192:195], v[12:15], v[64:67], v[192:195]
    v_mfma_f32_16x16x32_bf16 v[196:199], v[16:19], v[64:67], v[196:199]
    v_mfma_f32_16x16x32_bf16 v[200:203], v[20:23], v[64:67], v[200:203]
    ds_read_b128 v[64:67], v79 offset:12288
    s_waitcnt lgkmcnt(15)
    v_mfma_f32_16x16x32_bf16 v[204:207], v[8:11], v[68:71], v[204:207]
    v_mfma_f32_16x16x32_bf16 v[208:211], v[12:15], v[68:71], v[208:211]
    v_mfma_f32_16x16x32_bf16 v[212:215], v[16:19], v[68:71], v[212:215]
    v_mfma_f32_16x16x32_bf16 v[216:219], v[20:23], v[68:71], v[216:219]
    ds_read_b128 v[68:71], v79 offset:14336
    s_waitcnt lgkmcnt(7)
    v_mfma_f32_16x16x32_bf16 v[92:95], v[24:27], v[40:43], v[92:95]
    v_mfma_f32_16x16x32_bf16 v[96:99], v[28:31], v[40:43], v[96:99]
    v_mfma_f32_16x16x32_bf16 v[100:103], v[32:35], v[40:43], v[100:103]
    v_mfma_f32_16x16x32_bf16 v[104:107], v[36:39], v[40:43], v[104:107]
    s_waitcnt lgkmcnt(6)
    v_mfma_f32_16x16x32_bf16 v[108:111], v[24:27], v[44:47], v[108:111]
    v_mfma_f32_16x16x32_bf16 v[112:115], v[28:31], v[44:47], v[112:115]
    v_mfma_f32_16x16x32_bf16 v[116:119], v[32:35], v[44:47], v[116:119]
    v_mfma_f32_16x16x32_bf16 v[120:123], v[36:39], v[44:47], v[120:123]
    s_waitcnt lgkmcnt(5)
    v_mfma_f32_16x16x32_bf16 v[124:127], v[24:27], v[48:51], v[124:127]
    v_mfma_f32_16x16x32_bf16 v[128:131], v[28:31], v[48:51], v[128:131]
    v_mfma_f32_16x16x32_bf16 v[132:135], v[32:35], v[48:51], v[132:135]
    v_mfma_f32_16x16x32_bf16 v[136:139], v[36:39], v[48:51], v[136:139]
    s_waitcnt lgkmcnt(4)
    v_mfma_f32_16x16x32_bf16 v[140:143], v[24:27], v[52:55], v[140:143]
    v_mfma_f32_16x16x32_bf16 v[144:147], v[28:31], v[52:55], v[144:147]
    v_mfma_f32_16x16x32_bf16 v[148:151], v[32:35], v[52:55], v[148:151]
    v_mfma_f32_16x16x32_bf16 v[152:155], v[36:39], v[52:55], v[152:155]
    s_waitcnt lgkmcnt(0)
    s_cmp_eq_u32 s32, 0
    s_cbranch_scc1 L_oolb1_g1
    s_barrier
L_retb1_g1:
    v_mfma_f32_16x16x32_bf16 v[156:159], v[24:27], v[56:59], v[156:159]
    ds_read_b64_tr_b16 v[8:9], v86 offset:0
    ds_read_b64_tr_b16 v[10:11], v86 offset:2048
    v_mfma_f32_16x16x32_bf16 v[160:163], v[28:31], v[56:59], v[160:163]
    ds_read_b64_tr_b16 v[12:13], v87 offset:0
    ds_read_b64_tr_b16 v[14:15], v87 offset:2048
    v_mfma_f32_16x16x32_bf16 v[164:167], v[32:35], v[56:59], v[164:167]
    ds_read_b64_tr_b16 v[16:17], v88 offset:0
    ds_read_b64_tr_b16 v[18:19], v88 offset:2048
    v_mfma_f32_16x16x32_bf16 v[168:171], v[36:39], v[56:59], v[168:171]
    ds_read_b64_tr_b16 v[20:21], v89 offset:0
    ds_read_b64_tr_b16 v[22:23], v89 offset:2048
    v_mfma_f32_16x16x32_bf16 v[172:175], v[24:27], v[60:63], v[172:175]
    ds_read_b128 v[40:43], v84 offset:0
    ds_read_b128 v[44:47], v84 offset:2048
    v_mfma_f32_16x16x32_bf16 v[176:179], v[28:31], v[60:63], v[176:179]
    ds_read_b128 v[48:51], v84 offset:4096
    ds_read_b128 v[52:55], v84 offset:6144
    v_mfma_f32_16x16x32_bf16 v[180:183], v[32:35], v[60:63], v[180:183]
    ds_read_b128 v[56:59], v84 offset:8192
    v_mfma_f32_16x16x32_bf16 v[184:187], v[36:39], v[60:63], v[184:187]
    ds_read_b128 v[60:63], v84 offset:10240
    v_mfma_f32_16x16x32_bf16 v[188:191], v[24:27], v[64:67], v[188:191]
    v_mfma_f32_16x16x32_bf16 v[192:195], v[28:31], v[64:67], v[192:195]
    v_mfma_f32_16x16x32_bf16 v[196:199], v[32:35], v[64:67], v[196:199]
    v_mfma_f32_16x16x32_bf16 v[200:203], v[36:39], v[64:67], v[200:203]
    ds_read_b128 v[64:67], v84 offset:12288
    v_mfma_f32_16x16x32_bf16 v[204:207], v[24:27], v[68:71], v[204:207]
    v_mfma_f32_16x16x32_bf16 v[208:211], v[28:31], v[68:71], v[208:211]
    v_mfma_f32_16x16x32_bf16 v[212:215], v[32:35], v[68:71], v[212:215]
    v_mfma_f32_16x16x32_bf16 v[216:219], v[36:39], v[68:71], v[216:219]
    ds_read_b128 v[68:71], v84 offset:14336
    s_waitcnt lgkmcnt(7)
    v_mfma_f32_16x16x32_bf16 v[92:95], v[8:11], v[40:43], v[92:95]
    ds_read_b64_tr_b16 v[24:25], v86 offset:16384
    v_mfma_f32_16x16x32_bf16 v[96:99], v[12:15], v[40:43], v[96:99]
    ds_read_b64_tr_b16 v[26:27], v86 offset:18432
    v_mfma_f32_16x16x32_bf16 v[100:103], v[16:19], v[40:43], v[100:103]
    ds_read_b64_tr_b16 v[28:29], v87 offset:16384
    v_mfma_f32_16x16x32_bf16 v[104:107], v[20:23], v[40:43], v[104:107]
    ds_read_b64_tr_b16 v[30:31], v87 offset:18432
    s_waitcnt lgkmcnt(10)
    v_mfma_f32_16x16x32_bf16 v[108:111], v[8:11], v[44:47], v[108:111]
    ds_read_b64_tr_b16 v[32:33], v88 offset:16384
    v_mfma_f32_16x16x32_bf16 v[112:115], v[12:15], v[44:47], v[112:115]
    ds_read_b64_tr_b16 v[34:35], v88 offset:18432
    v_mfma_f32_16x16x32_bf16 v[116:119], v[16:19], v[44:47], v[116:119]
    ds_read_b64_tr_b16 v[36:37], v89 offset:16384
    v_mfma_f32_16x16x32_bf16 v[120:123], v[20:23], v[44:47], v[120:123]
    ds_read_b64_tr_b16 v[38:39], v89 offset:18432
    s_waitcnt lgkmcnt(13)
    v_mfma_f32_16x16x32_bf16 v[124:127], v[8:11], v[48:51], v[124:127]
    ds_read_b128 v[40:43], v85 offset:0
    v_mfma_f32_16x16x32_bf16 v[128:131], v[12:15], v[48:51], v[128:131]
    ds_read_b128 v[44:47], v85 offset:2048
    v_mfma_f32_16x16x32_bf16 v[132:135], v[16:19], v[48:51], v[132:135]
    v_mfma_f32_16x16x32_bf16 v[136:139], v[20:23], v[48:51], v[136:139]
    ds_read_b128 v[48:51], v85 offset:4096
    s_waitcnt lgkmcnt(15)
    v_mfma_f32_16x16x32_bf16 v[140:143], v[8:11], v[52:55], v[140:143]
    v_mfma_f32_16x16x32_bf16 v[144:147], v[12:15], v[52:55], v[144:147]
    v_mfma_f32_16x16x32_bf16 v[148:151], v[16:19], v[52:55], v[148:151]
    v_mfma_f32_16x16x32_bf16 v[152:155], v[20:23], v[52:55], v[152:155]
    ds_read_b128 v[52:55], v85 offset:6144
    s_waitcnt lgkmcnt(15)
    v_mfma_f32_16x16x32_bf16 v[156:159], v[8:11], v[56:59], v[156:159]
    v_mfma_f32_16x16x32_bf16 v[160:163], v[12:15], v[56:59], v[160:163]
    v_mfma_f32_16x16x32_bf16 v[164:167], v[16:19], v[56:59], v[164:167]
    v_mfma_f32_16x16x32_bf16 v[168:171], v[20:23], v[56:59], v[168:171]
    ds_read_b128 v[56:59], v85 offset:8192
    s_waitcnt lgkmcnt(15)
    v_mfma_f32_16x16x32_bf16 v[172:175], v[8:11], v[60:63], v[172:175]
    v_mfma_f32_16x16x32_bf16 v[176:179], v[12:15], v[60:63], v[176:179]
    v_mfma_f32_16x16x32_bf16 v[180:183], v[16:19], v[60:63], v[180:183]
    v_mfma_f32_16x16x32_bf16 v[184:187], v[20:23], v[60:63], v[184:187]
    ds_read_b128 v[60:63], v85 offset:10240
    s_waitcnt lgkmcnt(15)
    v_mfma_f32_16x16x32_bf16 v[188:191], v[8:11], v[64:67], v[188:191]
    v_mfma_f32_16x16x32_bf16 v[192:195], v[12:15], v[64:67], v[192:195]
    v_mfma_f32_16x16x32_bf16 v[196:199], v[16:19], v[64:67], v[196:199]
    v_mfma_f32_16x16x32_bf16 v[200:203], v[20:23], v[64:67], v[200:203]
    ds_read_b128 v[64:67], v85 offset:12288
    s_waitcnt lgkmcnt(15)
    v_mfma_f32_16x16x32_bf16 v[204:207], v[8:11], v[68:71], v[204:207]
    v_mfma_f32_16x16x32_bf16 v[208:211], v[12:15], v[68:71], v[208:211]
    v_mfma_f32_16x16x32_bf16 v[212:215], v[16:19], v[68:71], v[212:215]
    v_mfma_f32_16x16x32_bf16 v[216:219], v[20:23], v[68:71], v[216:219]
    ds_read_b128 v[68:71], v85 offset:14336
    s_waitcnt lgkmcnt(7)
    v_mfma_f32_16x16x32_bf16 v[92:95], v[24:27], v[40:43], v[92:95]
    v_mfma_f32_16x16x32_bf16 v[96:99], v[28:31], v[40:43], v[96:99]
    v_mfma_f32_16x16x32_bf16 v[100:103], v[32:35], v[40:43], v[100:103]
    v_mfma_f32_16x16x32_bf16 v[104:107], v[36:39], v[40:43], v[104:107]
    s_waitcnt lgkmcnt(6)
    v_mfma_f32_16x16x32_bf16 v[108:111], v[24:27], v[44:47], v[108:111]
    v_mfma_f32_16x16x32_bf16 v[112:115], v[28:31], v[44:47], v[112:115]
    v_mfma_f32_16x16x32_bf16 v[116:119], v[32:35], v[44:47], v[116:119]
    v_mfma_f32_16x16x32_bf16 v[120:123], v[36:39], v[44:47], v[120:123]
    s_waitcnt lgkmcnt(5)
    v_mfma_f32_16x16x32_bf16 v[124:127], v[24:27], v[48:51], v[124:127]
    v_mfma_f32_16x16x32_bf16 v[128:131], v[28:31], v[48:51], v[128:131]
    v_mfma_f32_16x16x32_bf16 v[132:135], v[32:35], v[48:51], v[132:135]
    v_mfma_f32_16x16x32_bf16 v[136:139], v[36:39], v[48:51], v[136:139]
    s_waitcnt lgkmcnt(4)
    v_mfma_f32_16x16x32_bf16 v[140:143], v[24:27], v[52:55], v[140:143]
    v_mfma_f32_16x16x32_bf16 v[144:147], v[28:31], v[52:55], v[144:147]
    v_mfma_f32_16x16x32_bf16 v[148:151], v[32:35], v[52:55], v[148:151]
    v_mfma_f32_16x16x32_bf16 v[152:155], v[36:39], v[52:55], v[152:155]
    s_waitcnt lgkmcnt(0)
    s_barrier
    v_mfma_f32_16x16x32_bf16 v[156:159], v[24:27], v[56:59], v[156:159]
    ds_read_b64_tr_b16 v[8:9], v74 offset:0
    ds_read_b64_tr_b16 v[10:11], v74 offset:2048
    v_mfma_f32_16x16x32_bf16 v[160:163], v[28:31], v[56:59], v[160:163]
    ds_read_b64_tr_b16 v[12:13], v75 offset:0
    ds_read_b64_tr_b16 v[14:15], v75 offset:2048
    v_mfma_f32_16x16x32_bf16 v[164:167], v[32:35], v[56:59], v[164:167]
    ds_read_b64_tr_b16 v[16:17], v76 offset:0
    ds_read_b64_tr_b16 v[18:19], v76 offset:2048
    v_mfma_f32_16x16x32_bf16 v[168:171], v[36:39], v[56:59], v[168:171]
    ds_read_b64_tr_b16 v[20:21], v77 offset:0
    ds_read_b64_tr_b16 v[22:23], v77 offset:2048
    v_mfma_f32_16x16x32_bf16 v[172:175], v[24:27], v[60:63], v[172:175]
    ds_read_b128 v[40:43], v72 offset:0
    ds_read_b128 v[44:47], v72 offset:2048
    v_mfma_f32_16x16x32_bf16 v[176:179], v[28:31], v[60:63], v[176:179]
    ds_read_b128 v[48:51], v72 offset:4096
    ds_read_b128 v[52:55], v72 offset:6144
    v_mfma_f32_16x16x32_bf16 v[180:183], v[32:35], v[60:63], v[180:183]
    ds_read_b128 v[56:59], v72 offset:8192
    v_mfma_f32_16x16x32_bf16 v[184:187], v[36:39], v[60:63], v[184:187]
    ds_read_b128 v[60:63], v72 offset:10240
    v_mfma_f32_16x16x32_bf16 v[188:191], v[24:27], v[64:67], v[188:191]
    v_mfma_f32_16x16x32_bf16 v[192:195], v[28:31], v[64:67], v[192:195]
    v_mfma_f32_16x16x32_bf16 v[196:199], v[32:35], v[64:67], v[196:199]
    v_mfma_f32_16x16x32_bf16 v[200:203], v[36:39], v[64:67], v[200:203]
    ds_read_b128 v[64:67], v72 offset:12288
    v_mfma_f32_16x16x32_bf16 v[204:207], v[24:27], v[68:71], v[204:207]
    v_mfma_f32_16x16x32_bf16 v[208:211], v[28:31], v[68:71], v[208:211]
    v_mfma_f32_16x16x32_bf16 v[212:215], v[32:35], v[68:71], v[212:215]
    v_mfma_f32_16x16x32_bf16 v[216:219], v[36:39], v[68:71], v[216:219]
    ds_read_b128 v[68:71], v72 offset:14336
    s_waitcnt lgkmcnt(7)
    v_mfma_f32_16x16x32_bf16 v[92:95], v[8:11], v[40:43], v[92:95]
    ds_read_b64_tr_b16 v[24:25], v74 offset:16384
    v_mfma_f32_16x16x32_bf16 v[96:99], v[12:15], v[40:43], v[96:99]
    ds_read_b64_tr_b16 v[26:27], v74 offset:18432
    v_mfma_f32_16x16x32_bf16 v[100:103], v[16:19], v[40:43], v[100:103]
    ds_read_b64_tr_b16 v[28:29], v75 offset:16384
    v_mfma_f32_16x16x32_bf16 v[104:107], v[20:23], v[40:43], v[104:107]
    ds_read_b64_tr_b16 v[30:31], v75 offset:18432
    s_waitcnt lgkmcnt(10)
    v_mfma_f32_16x16x32_bf16 v[108:111], v[8:11], v[44:47], v[108:111]
    ds_read_b64_tr_b16 v[32:33], v76 offset:16384
    v_mfma_f32_16x16x32_bf16 v[112:115], v[12:15], v[44:47], v[112:115]
    ds_read_b64_tr_b16 v[34:35], v76 offset:18432
    v_mfma_f32_16x16x32_bf16 v[116:119], v[16:19], v[44:47], v[116:119]
    ds_read_b64_tr_b16 v[36:37], v77 offset:16384
    v_mfma_f32_16x16x32_bf16 v[120:123], v[20:23], v[44:47], v[120:123]
    ds_read_b64_tr_b16 v[38:39], v77 offset:18432
    s_waitcnt lgkmcnt(13)
    v_mfma_f32_16x16x32_bf16 v[124:127], v[8:11], v[48:51], v[124:127]
    ds_read_b128 v[40:43], v73 offset:0
    v_mfma_f32_16x16x32_bf16 v[128:131], v[12:15], v[48:51], v[128:131]
    ds_read_b128 v[44:47], v73 offset:2048
    v_mfma_f32_16x16x32_bf16 v[132:135], v[16:19], v[48:51], v[132:135]
    v_mfma_f32_16x16x32_bf16 v[136:139], v[20:23], v[48:51], v[136:139]
    ds_read_b128 v[48:51], v73 offset:4096
    s_waitcnt lgkmcnt(15)
    v_mfma_f32_16x16x32_bf16 v[140:143], v[8:11], v[52:55], v[140:143]
    v_mfma_f32_16x16x32_bf16 v[144:147], v[12:15], v[52:55], v[144:147]
    v_mfma_f32_16x16x32_bf16 v[148:151], v[16:19], v[52:55], v[148:151]
    v_mfma_f32_16x16x32_bf16 v[152:155], v[20:23], v[52:55], v[152:155]
    ds_read_b128 v[52:55], v73 offset:6144
    s_waitcnt lgkmcnt(15)
    v_mfma_f32_16x16x32_bf16 v[156:159], v[8:11], v[56:59], v[156:159]
    v_mfma_f32_16x16x32_bf16 v[160:163], v[12:15], v[56:59], v[160:163]
    v_mfma_f32_16x16x32_bf16 v[164:167], v[16:19], v[56:59], v[164:167]
    v_mfma_f32_16x16x32_bf16 v[168:171], v[20:23], v[56:59], v[168:171]
    ds_read_b128 v[56:59], v73 offset:8192
    s_waitcnt lgkmcnt(15)
    v_mfma_f32_16x16x32_bf16 v[172:175], v[8:11], v[60:63], v[172:175]
    v_mfma_f32_16x16x32_bf16 v[176:179], v[12:15], v[60:63], v[176:179]
    v_mfma_f32_16x16x32_bf16 v[180:183], v[16:19], v[60:63], v[180:183]
    v_mfma_f32_16x16x32_bf16 v[184:187], v[20:23], v[60:63], v[184:187]
    ds_read_b128 v[60:63], v73 offset:10240
    s_waitcnt lgkmcnt(15)
    v_mfma_f32_16x16x32_bf16 v[188:191], v[8:11], v[64:67], v[188:191]
    v_mfma_f32_16x16x32_bf16 v[192:195], v[12:15], v[64:67], v[192:195]
    v_mfma_f32_16x16x32_bf16 v[196:199], v[16:19], v[64:67], v[196:199]
    v_mfma_f32_16x16x32_bf16 v[200:203], v[20:23], v[64:67], v[200:203]
    ds_read_b128 v[64:67], v73 offset:12288
    s_waitcnt lgkmcnt(15)
    v_mfma_f32_16x16x32_bf16 v[204:207], v[8:11], v[68:71], v[204:207]
    v_mfma_f32_16x16x32_bf16 v[208:211], v[12:15], v[68:71], v[208:211]
    v_mfma_f32_16x16x32_bf16 v[212:215], v[16:19], v[68:71], v[212:215]
    v_mfma_f32_16x16x32_bf16 v[216:219], v[20:23], v[68:71], v[216:219]
    ds_read_b128 v[68:71], v73 offset:14336
    s_waitcnt lgkmcnt(7)
    v_mfma_f32_16x16x32_bf16 v[92:95], v[24:27], v[40:43], v[92:95]
    v_mfma_f32_16x16x32_bf16 v[96:99], v[28:31], v[40:43], v[96:99]
    v_mfma_f32_16x16x32_bf16 v[100:103], v[32:35], v[40:43], v[100:103]
    v_mfma_f32_16x16x32_bf16 v[104:107], v[36:39], v[40:43], v[104:107]
    s_waitcnt lgkmcnt(6)
    v_mfma_f32_16x16x32_bf16 v[108:111], v[24:27], v[44:47], v[108:111]
    v_mfma_f32_16x16x32_bf16 v[112:115], v[28:31], v[44:47], v[112:115]
    v_mfma_f32_16x16x32_bf16 v[116:119], v[32:35], v[44:47], v[116:119]
    v_mfma_f32_16x16x32_bf16 v[120:123], v[36:39], v[44:47], v[120:123]
    s_waitcnt lgkmcnt(5)
    v_mfma_f32_16x16x32_bf16 v[124:127], v[24:27], v[48:51], v[124:127]
    v_mfma_f32_16x16x32_bf16 v[128:131], v[28:31], v[48:51], v[128:131]
    v_mfma_f32_16x16x32_bf16 v[132:135], v[32:35], v[48:51], v[132:135]
    v_mfma_f32_16x16x32_bf16 v[136:139], v[36:39], v[48:51], v[136:139]
    s_waitcnt lgkmcnt(4)
    v_mfma_f32_16x16x32_bf16 v[140:143], v[24:27], v[52:55], v[140:143]
    v_mfma_f32_16x16x32_bf16 v[144:147], v[28:31], v[52:55], v[144:147]
    v_mfma_f32_16x16x32_bf16 v[148:151], v[32:35], v[52:55], v[148:151]
    v_mfma_f32_16x16x32_bf16 v[152:155], v[36:39], v[52:55], v[152:155]
    s_waitcnt lgkmcnt(0)
    s_barrier
    v_mfma_f32_16x16x32_bf16 v[156:159], v[24:27], v[56:59], v[156:159]
    ds_read_b64_tr_b16 v[8:9], v80 offset:0
    ds_read_b64_tr_b16 v[10:11], v80 offset:2048
    v_mfma_f32_16x16x32_bf16 v[160:163], v[28:31], v[56:59], v[160:163]
    ds_read_b64_tr_b16 v[12:13], v81 offset:0
    ds_read_b64_tr_b16 v[14:15], v81 offset:2048
    v_mfma_f32_16x16x32_bf16 v[164:167], v[32:35], v[56:59], v[164:167]
    ds_read_b64_tr_b16 v[16:17], v82 offset:0
    ds_read_b64_tr_b16 v[18:19], v82 offset:2048
    v_mfma_f32_16x16x32_bf16 v[168:171], v[36:39], v[56:59], v[168:171]
    ds_read_b64_tr_b16 v[20:21], v83 offset:0
    ds_read_b64_tr_b16 v[22:23], v83 offset:2048
    v_mfma_f32_16x16x32_bf16 v[172:175], v[24:27], v[60:63], v[172:175]
    ds_read_b128 v[40:43], v78 offset:0
    ds_read_b128 v[44:47], v78 offset:2048
    v_mfma_f32_16x16x32_bf16 v[176:179], v[28:31], v[60:63], v[176:179]
    ds_read_b128 v[48:51], v78 offset:4096
    ds_read_b128 v[52:55], v78 offset:6144
    v_mfma_f32_16x16x32_bf16 v[180:183], v[32:35], v[60:63], v[180:183]
    ds_read_b128 v[56:59], v78 offset:8192
    v_mfma_f32_16x16x32_bf16 v[184:187], v[36:39], v[60:63], v[184:187]
    ds_read_b128 v[60:63], v78 offset:10240
    v_mfma_f32_16x16x32_bf16 v[188:191], v[24:27], v[64:67], v[188:191]
    v_mfma_f32_16x16x32_bf16 v[192:195], v[28:31], v[64:67], v[192:195]
    v_mfma_f32_16x16x32_bf16 v[196:199], v[32:35], v[64:67], v[196:199]
    v_mfma_f32_16x16x32_bf16 v[200:203], v[36:39], v[64:67], v[200:203]
    ds_read_b128 v[64:67], v78 offset:12288
    v_mfma_f32_16x16x32_bf16 v[204:207], v[24:27], v[68:71], v[204:207]
    v_mfma_f32_16x16x32_bf16 v[208:211], v[28:31], v[68:71], v[208:211]
    v_mfma_f32_16x16x32_bf16 v[212:215], v[32:35], v[68:71], v[212:215]
    v_mfma_f32_16x16x32_bf16 v[216:219], v[36:39], v[68:71], v[216:219]
    ds_read_b128 v[68:71], v78 offset:14336
    s_add_u32 s32, s32, 1
    s_cmp_lt_u32 s32, 4
    s_cbranch_scc1 L_cons_g1
    s_waitcnt lgkmcnt(7)
    v_mfma_f32_16x16x32_bf16 v[92:95], v[8:11], v[40:43], v[92:95]
    ds_read_b64_tr_b16 v[24:25], v80 offset:16384
    v_mfma_f32_16x16x32_bf16 v[96:99], v[12:15], v[40:43], v[96:99]
    ds_read_b64_tr_b16 v[26:27], v80 offset:18432
    v_mfma_f32_16x16x32_bf16 v[100:103], v[16:19], v[40:43], v[100:103]
    ds_read_b64_tr_b16 v[28:29], v81 offset:16384
    v_mfma_f32_16x16x32_bf16 v[104:107], v[20:23], v[40:43], v[104:107]
    ds_read_b64_tr_b16 v[30:31], v81 offset:18432
    s_waitcnt lgkmcnt(10)
    v_mfma_f32_16x16x32_bf16 v[108:111], v[8:11], v[44:47], v[108:111]
    ds_read_b64_tr_b16 v[32:33], v82 offset:16384
    v_mfma_f32_16x16x32_bf16 v[112:115], v[12:15], v[44:47], v[112:115]
    ds_read_b64_tr_b16 v[34:35], v82 offset:18432
    v_mfma_f32_16x16x32_bf16 v[116:119], v[16:19], v[44:47], v[116:119]
    ds_read_b64_tr_b16 v[36:37], v83 offset:16384
    v_mfma_f32_16x16x32_bf16 v[120:123], v[20:23], v[44:47], v[120:123]
    ds_read_b64_tr_b16 v[38:39], v83 offset:18432
    s_waitcnt lgkmcnt(13)
    v_mfma_f32_16x16x32_bf16 v[124:127], v[8:11], v[48:51], v[124:127]
    ds_read_b128 v[40:43], v79 offset:0
    v_mfma_f32_16x16x32_bf16 v[128:131], v[12:15], v[48:51], v[128:131]
    ds_read_b128 v[44:47], v79 offset:2048
    v_mfma_f32_16x16x32_bf16 v[132:135], v[16:19], v[48:51], v[132:135]
    v_mfma_f32_16x16x32_bf16 v[136:139], v[20:23], v[48:51], v[136:139]
    ds_read_b128 v[48:51], v79 offset:4096
    s_waitcnt lgkmcnt(15)
    v_mfma_f32_16x16x32_bf16 v[140:143], v[8:11], v[52:55], v[140:143]
    v_mfma_f32_16x16x32_bf16 v[144:147], v[12:15], v[52:55], v[144:147]
    v_mfma_f32_16x16x32_bf16 v[148:151], v[16:19], v[52:55], v[148:151]
    v_mfma_f32_16x16x32_bf16 v[152:155], v[20:23], v[52:55], v[152:155]
    ds_read_b128 v[52:55], v79 offset:6144
    s_waitcnt lgkmcnt(15)
    v_mfma_f32_16x16x32_bf16 v[156:159], v[8:11], v[56:59], v[156:159]
    v_mfma_f32_16x16x32_bf16 v[160:163], v[12:15], v[56:59], v[160:163]
    v_mfma_f32_16x16x32_bf16 v[164:167], v[16:19], v[56:59], v[164:167]
    v_mfma_f32_16x16x32_bf16 v[168:171], v[20:23], v[56:59], v[168:171]
    ds_read_b128 v[56:59], v79 offset:8192
    s_waitcnt lgkmcnt(15)
    v_mfma_f32_16x16x32_bf16 v[172:175], v[8:11], v[60:63], v[172:175]
    v_mfma_f32_16x16x32_bf16 v[176:179], v[12:15], v[60:63], v[176:179]
    v_mfma_f32_16x16x32_bf16 v[180:183], v[16:19], v[60:63], v[180:183]
    v_mfma_f32_16x16x32_bf16 v[184:187], v[20:23], v[60:63], v[184:187]
    ds_read_b128 v[60:63], v79 offset:10240
    s_waitcnt lgkmcnt(15)
    v_mfma_f32_16x16x32_bf16 v[188:191], v[8:11], v[64:67], v[188:191]
    v_mfma_f32_16x16x32_bf16 v[192:195], v[12:15], v[64:67], v[192:195]
    v_mfma_f32_16x16x32_bf16 v[196:199], v[16:19], v[64:67], v[196:199]
    v_mfma_f32_16x16x32_bf16 v[200:203], v[20:23], v[64:67], v[200:203]
    ds_read_b128 v[64:67], v79 offset:12288
    s_waitcnt lgkmcnt(15)
    v_mfma_f32_16x16x32_bf16 v[204:207], v[8:11], v[68:71], v[204:207]
    v_mfma_f32_16x16x32_bf16 v[208:211], v[12:15], v[68:71], v[208:211]
    v_mfma_f32_16x16x32_bf16 v[212:215], v[16:19], v[68:71], v[212:215]
    v_mfma_f32_16x16x32_bf16 v[216:219], v[20:23], v[68:71], v[216:219]
    ds_read_b128 v[68:71], v79 offset:14336
    s_waitcnt lgkmcnt(7)
    v_mfma_f32_16x16x32_bf16 v[92:95], v[24:27], v[40:43], v[92:95]
    v_mfma_f32_16x16x32_bf16 v[96:99], v[28:31], v[40:43], v[96:99]
    v_mfma_f32_16x16x32_bf16 v[100:103], v[32:35], v[40:43], v[100:103]
    v_mfma_f32_16x16x32_bf16 v[104:107], v[36:39], v[40:43], v[104:107]
    s_waitcnt lgkmcnt(6)
    v_mfma_f32_16x16x32_bf16 v[108:111], v[24:27], v[44:47], v[108:111]
    v_mfma_f32_16x16x32_bf16 v[112:115], v[28:31], v[44:47], v[112:115]
    v_mfma_f32_16x16x32_bf16 v[116:119], v[32:35], v[44:47], v[116:119]
    v_mfma_f32_16x16x32_bf16 v[120:123], v[36:39], v[44:47], v[120:123]
    s_waitcnt lgkmcnt(5)
    v_mfma_f32_16x16x32_bf16 v[124:127], v[24:27], v[48:51], v[124:127]
    v_mfma_f32_16x16x32_bf16 v[128:131], v[28:31], v[48:51], v[128:131]
    v_mfma_f32_16x16x32_bf16 v[132:135], v[32:35], v[48:51], v[132:135]
    v_mfma_f32_16x16x32_bf16 v[136:139], v[36:39], v[48:51], v[136:139]
    s_waitcnt lgkmcnt(4)
    v_mfma_f32_16x16x32_bf16 v[140:143], v[24:27], v[52:55], v[140:143]
    v_mfma_f32_16x16x32_bf16 v[144:147], v[28:31], v[52:55], v[144:147]
    v_mfma_f32_16x16x32_bf16 v[148:151], v[32:35], v[52:55], v[148:151]
    v_mfma_f32_16x16x32_bf16 v[152:155], v[36:39], v[52:55], v[152:155]
    s_waitcnt lgkmcnt(0)
    s_barrier
    v_mfma_f32_16x16x32_bf16 v[156:159], v[24:27], v[56:59], v[156:159]
    ds_read_b64_tr_b16 v[8:9], v86 offset:0
    ds_read_b64_tr_b16 v[10:11], v86 offset:2048
    v_mfma_f32_16x16x32_bf16 v[160:163], v[28:31], v[56:59], v[160:163]
    ds_read_b64_tr_b16 v[12:13], v87 offset:0
    ds_read_b64_tr_b16 v[14:15], v87 offset:2048
    v_mfma_f32_16x16x32_bf16 v[164:167], v[32:35], v[56:59], v[164:167]
    ds_read_b64_tr_b16 v[16:17], v88 offset:0
    ds_read_b64_tr_b16 v[18:19], v88 offset:2048
    v_mfma_f32_16x16x32_bf16 v[168:171], v[36:39], v[56:59], v[168:171]
    ds_read_b64_tr_b16 v[20:21], v89 offset:0
    ds_read_b64_tr_b16 v[22:23], v89 offset:2048
    v_mfma_f32_16x16x32_bf16 v[172:175], v[24:27], v[60:63], v[172:175]
    ds_read_b128 v[40:43], v84 offset:0
    ds_read_b128 v[44:47], v84 offset:2048
    v_mfma_f32_16x16x32_bf16 v[176:179], v[28:31], v[60:63], v[176:179]
    ds_read_b128 v[48:51], v84 offset:4096
    ds_read_b128 v[52:55], v84 offset:6144
    v_mfma_f32_16x16x32_bf16 v[180:183], v[32:35], v[60:63], v[180:183]
    ds_read_b128 v[56:59], v84 offset:8192
    v_mfma_f32_16x16x32_bf16 v[184:187], v[36:39], v[60:63], v[184:187]
    ds_read_b128 v[60:63], v84 offset:10240
    v_mfma_f32_16x16x32_bf16 v[188:191], v[24:27], v[64:67], v[188:191]
    v_mfma_f32_16x16x32_bf16 v[192:195], v[28:31], v[64:67], v[192:195]
    v_mfma_f32_16x16x32_bf16 v[196:199], v[32:35], v[64:67], v[196:199]
    v_mfma_f32_16x16x32_bf16 v[200:203], v[36:39], v[64:67], v[200:203]
    ds_read_b128 v[64:67], v84 offset:12288
    v_mfma_f32_16x16x32_bf16 v[204:207], v[24:27], v[68:71], v[204:207]
    v_mfma_f32_16x16x32_bf16 v[208:211], v[28:31], v[68:71], v[208:211]
    v_mfma_f32_16x16x32_bf16 v[212:215], v[32:35], v[68:71], v[212:215]
    v_mfma_f32_16x16x32_bf16 v[216:219], v[36:39], v[68:71], v[216:219]
    ds_read_b128 v[68:71], v84 offset:14336
    s_waitcnt lgkmcnt(7)
    v_mfma_f32_16x16x32_bf16 v[92:95], v[8:11], v[40:43], v[92:95]
    ds_read_b64_tr_b16 v[24:25], v86 offset:16384
    v_mfma_f32_16x16x32_bf16 v[96:99], v[12:15], v[40:43], v[96:99]
    ds_read_b64_tr_b16 v[26:27], v86 offset:18432
    v_mfma_f32_16x16x32_bf16 v[100:103], v[16:19], v[40:43], v[100:103]
    ds_read_b64_tr_b16 v[28:29], v87 offset:16384
    v_mfma_f32_16x16x32_bf16 v[104:107], v[20:23], v[40:43], v[104:107]
    ds_read_b64_tr_b16 v[30:31], v87 offset:18432
    s_waitcnt lgkmcnt(10)
    v_mfma_f32_16x16x32_bf16 v[108:111], v[8:11], v[44:47], v[108:111]
    ds_read_b64_tr_b16 v[32:33], v88 offset:16384
    v_mfma_f32_16x16x32_bf16 v[112:115], v[12:15], v[44:47], v[112:115]
    ds_read_b64_tr_b16 v[34:35], v88 offset:18432
    v_mfma_f32_16x16x32_bf16 v[116:119], v[16:19], v[44:47], v[116:119]
    ds_read_b64_tr_b16 v[36:37], v89 offset:16384
    v_mfma_f32_16x16x32_bf16 v[120:123], v[20:23], v[44:47], v[120:123]
    ds_read_b64_tr_b16 v[38:39], v89 offset:18432
    s_waitcnt lgkmcnt(13)
    v_mfma_f32_16x16x32_bf16 v[124:127], v[8:11], v[48:51], v[124:127]
    ds_read_b128 v[40:43], v85 offset:0
    v_mfma_f32_16x16x32_bf16 v[128:131], v[12:15], v[48:51], v[128:131]
    ds_read_b128 v[44:47], v85 offset:2048
    v_mfma_f32_16x16x32_bf16 v[132:135], v[16:19], v[48:51], v[132:135]
    v_mfma_f32_16x16x32_bf16 v[136:139], v[20:23], v[48:51], v[136:139]
    ds_read_b128 v[48:51], v85 offset:4096
    s_waitcnt lgkmcnt(15)
    v_mfma_f32_16x16x32_bf16 v[140:143], v[8:11], v[52:55], v[140:143]
    v_mfma_f32_16x16x32_bf16 v[144:147], v[12:15], v[52:55], v[144:147]
    v_mfma_f32_16x16x32_bf16 v[148:151], v[16:19], v[52:55], v[148:151]
    v_mfma_f32_16x16x32_bf16 v[152:155], v[20:23], v[52:55], v[152:155]
    ds_read_b128 v[52:55], v85 offset:6144
    s_waitcnt lgkmcnt(15)
    v_mfma_f32_16x16x32_bf16 v[156:159], v[8:11], v[56:59], v[156:159]
    v_mfma_f32_16x16x32_bf16 v[160:163], v[12:15], v[56:59], v[160:163]
    v_mfma_f32_16x16x32_bf16 v[164:167], v[16:19], v[56:59], v[164:167]
    v_mfma_f32_16x16x32_bf16 v[168:171], v[20:23], v[56:59], v[168:171]
    ds_read_b128 v[56:59], v85 offset:8192
    s_waitcnt lgkmcnt(15)
    v_mfma_f32_16x16x32_bf16 v[172:175], v[8:11], v[60:63], v[172:175]
    v_mfma_f32_16x16x32_bf16 v[176:179], v[12:15], v[60:63], v[176:179]
    v_mfma_f32_16x16x32_bf16 v[180:183], v[16:19], v[60:63], v[180:183]
    v_mfma_f32_16x16x32_bf16 v[184:187], v[20:23], v[60:63], v[184:187]
    ds_read_b128 v[60:63], v85 offset:10240
    s_waitcnt lgkmcnt(15)
    v_mfma_f32_16x16x32_bf16 v[188:191], v[8:11], v[64:67], v[188:191]
    v_mfma_f32_16x16x32_bf16 v[192:195], v[12:15], v[64:67], v[192:195]
    v_mfma_f32_16x16x32_bf16 v[196:199], v[16:19], v[64:67], v[196:199]
    v_mfma_f32_16x16x32_bf16 v[200:203], v[20:23], v[64:67], v[200:203]
    ds_read_b128 v[64:67], v85 offset:12288
    s_waitcnt lgkmcnt(15)
    v_mfma_f32_16x16x32_bf16 v[204:207], v[8:11], v[68:71], v[204:207]
    v_mfma_f32_16x16x32_bf16 v[208:211], v[12:15], v[68:71], v[208:211]
    v_mfma_f32_16x16x32_bf16 v[212:215], v[16:19], v[68:71], v[212:215]
    v_mfma_f32_16x16x32_bf16 v[216:219], v[20:23], v[68:71], v[216:219]
    ds_read_b128 v[68:71], v85 offset:14336
    s_waitcnt lgkmcnt(7)
    v_mfma_f32_16x16x32_bf16 v[92:95], v[24:27], v[40:43], v[92:95]
    v_mfma_f32_16x16x32_bf16 v[96:99], v[28:31], v[40:43], v[96:99]
    v_mfma_f32_16x16x32_bf16 v[100:103], v[32:35], v[40:43], v[100:103]
    v_mfma_f32_16x16x32_bf16 v[104:107], v[36:39], v[40:43], v[104:107]
    s_waitcnt lgkmcnt(6)
    v_mfma_f32_16x16x32_bf16 v[108:111], v[24:27], v[44:47], v[108:111]
    v_mfma_f32_16x16x32_bf16 v[112:115], v[28:31], v[44:47], v[112:115]
    v_mfma_f32_16x16x32_bf16 v[116:119], v[32:35], v[44:47], v[116:119]
    v_mfma_f32_16x16x32_bf16 v[120:123], v[36:39], v[44:47], v[120:123]
    s_waitcnt lgkmcnt(5)
    v_mfma_f32_16x16x32_bf16 v[124:127], v[24:27], v[48:51], v[124:127]
    v_mfma_f32_16x16x32_bf16 v[128:131], v[28:31], v[48:51], v[128:131]
    v_mfma_f32_16x16x32_bf16 v[132:135], v[32:35], v[48:51], v[132:135]
    v_mfma_f32_16x16x32_bf16 v[136:139], v[36:39], v[48:51], v[136:139]
    s_waitcnt lgkmcnt(4)
    v_mfma_f32_16x16x32_bf16 v[140:143], v[24:27], v[52:55], v[140:143]
    v_mfma_f32_16x16x32_bf16 v[144:147], v[28:31], v[52:55], v[144:147]
    v_mfma_f32_16x16x32_bf16 v[148:151], v[32:35], v[52:55], v[148:151]
    v_mfma_f32_16x16x32_bf16 v[152:155], v[36:39], v[52:55], v[152:155]
    s_waitcnt lgkmcnt(0)
    s_barrier
    v_mfma_f32_16x16x32_bf16 v[156:159], v[24:27], v[56:59], v[156:159]
    ds_read_b64_tr_b16 v[8:9], v74 offset:0
    ds_read_b64_tr_b16 v[10:11], v74 offset:2048
    v_mfma_f32_16x16x32_bf16 v[160:163], v[28:31], v[56:59], v[160:163]
    ds_read_b64_tr_b16 v[12:13], v75 offset:0
    ds_read_b64_tr_b16 v[14:15], v75 offset:2048
    v_mfma_f32_16x16x32_bf16 v[164:167], v[32:35], v[56:59], v[164:167]
    ds_read_b64_tr_b16 v[16:17], v76 offset:0
    ds_read_b64_tr_b16 v[18:19], v76 offset:2048
    v_mfma_f32_16x16x32_bf16 v[168:171], v[36:39], v[56:59], v[168:171]
    ds_read_b64_tr_b16 v[20:21], v77 offset:0
    ds_read_b64_tr_b16 v[22:23], v77 offset:2048
    v_mfma_f32_16x16x32_bf16 v[172:175], v[24:27], v[60:63], v[172:175]
    ds_read_b128 v[40:43], v72 offset:0
    ds_read_b128 v[44:47], v72 offset:2048
    v_mfma_f32_16x16x32_bf16 v[176:179], v[28:31], v[60:63], v[176:179]
    ds_read_b128 v[48:51], v72 offset:4096
    ds_read_b128 v[52:55], v72 offset:6144
    v_mfma_f32_16x16x32_bf16 v[180:183], v[32:35], v[60:63], v[180:183]
    ds_read_b128 v[56:59], v72 offset:8192
    v_mfma_f32_16x16x32_bf16 v[184:187], v[36:39], v[60:63], v[184:187]
    ds_read_b128 v[60:63], v72 offset:10240
    v_mfma_f32_16x16x32_bf16 v[188:191], v[24:27], v[64:67], v[188:191]
    v_mfma_f32_16x16x32_bf16 v[192:195], v[28:31], v[64:67], v[192:195]
    v_mfma_f32_16x16x32_bf16 v[196:199], v[32:35], v[64:67], v[196:199]
    v_mfma_f32_16x16x32_bf16 v[200:203], v[36:39], v[64:67], v[200:203]
    ds_read_b128 v[64:67], v72 offset:12288
    v_mfma_f32_16x16x32_bf16 v[204:207], v[24:27], v[68:71], v[204:207]
    v_mfma_f32_16x16x32_bf16 v[208:211], v[28:31], v[68:71], v[208:211]
    v_mfma_f32_16x16x32_bf16 v[212:215], v[32:35], v[68:71], v[212:215]
    v_mfma_f32_16x16x32_bf16 v[216:219], v[36:39], v[68:71], v[216:219]
    ds_read_b128 v[68:71], v72 offset:14336
    s_waitcnt lgkmcnt(7)
    v_mfma_f32_16x16x32_bf16 v[92:95], v[8:11], v[40:43], v[92:95]
    ds_read_b64_tr_b16 v[24:25], v74 offset:16384
    v_mfma_f32_16x16x32_bf16 v[96:99], v[12:15], v[40:43], v[96:99]
    ds_read_b64_tr_b16 v[26:27], v74 offset:18432
    v_mfma_f32_16x16x32_bf16 v[100:103], v[16:19], v[40:43], v[100:103]
    ds_read_b64_tr_b16 v[28:29], v75 offset:16384
    v_mfma_f32_16x16x32_bf16 v[104:107], v[20:23], v[40:43], v[104:107]
    ds_read_b64_tr_b16 v[30:31], v75 offset:18432
    s_waitcnt lgkmcnt(10)
    v_mfma_f32_16x16x32_bf16 v[108:111], v[8:11], v[44:47], v[108:111]
    ds_read_b64_tr_b16 v[32:33], v76 offset:16384
    v_mfma_f32_16x16x32_bf16 v[112:115], v[12:15], v[44:47], v[112:115]
    ds_read_b64_tr_b16 v[34:35], v76 offset:18432
    v_mfma_f32_16x16x32_bf16 v[116:119], v[16:19], v[44:47], v[116:119]
    ds_read_b64_tr_b16 v[36:37], v77 offset:16384
    v_mfma_f32_16x16x32_bf16 v[120:123], v[20:23], v[44:47], v[120:123]
    ds_read_b64_tr_b16 v[38:39], v77 offset:18432
    s_waitcnt lgkmcnt(13)
    v_mfma_f32_16x16x32_bf16 v[124:127], v[8:11], v[48:51], v[124:127]
    ds_read_b128 v[40:43], v73 offset:0
    v_mfma_f32_16x16x32_bf16 v[128:131], v[12:15], v[48:51], v[128:131]
    ds_read_b128 v[44:47], v73 offset:2048
    v_mfma_f32_16x16x32_bf16 v[132:135], v[16:19], v[48:51], v[132:135]
    v_mfma_f32_16x16x32_bf16 v[136:139], v[20:23], v[48:51], v[136:139]
    ds_read_b128 v[48:51], v73 offset:4096
    s_waitcnt lgkmcnt(15)
    v_mfma_f32_16x16x32_bf16 v[140:143], v[8:11], v[52:55], v[140:143]
    v_mfma_f32_16x16x32_bf16 v[144:147], v[12:15], v[52:55], v[144:147]
    v_mfma_f32_16x16x32_bf16 v[148:151], v[16:19], v[52:55], v[148:151]
    v_mfma_f32_16x16x32_bf16 v[152:155], v[20:23], v[52:55], v[152:155]
    ds_read_b128 v[52:55], v73 offset:6144
    s_waitcnt lgkmcnt(15)
    v_mfma_f32_16x16x32_bf16 v[156:159], v[8:11], v[56:59], v[156:159]
    v_mfma_f32_16x16x32_bf16 v[160:163], v[12:15], v[56:59], v[160:163]
    v_mfma_f32_16x16x32_bf16 v[164:167], v[16:19], v[56:59], v[164:167]
    v_mfma_f32_16x16x32_bf16 v[168:171], v[20:23], v[56:59], v[168:171]
    ds_read_b128 v[56:59], v73 offset:8192
    s_waitcnt lgkmcnt(15)
    v_mfma_f32_16x16x32_bf16 v[172:175], v[8:11], v[60:63], v[172:175]
    v_mfma_f32_16x16x32_bf16 v[176:179], v[12:15], v[60:63], v[176:179]
    v_mfma_f32_16x16x32_bf16 v[180:183], v[16:19], v[60:63], v[180:183]
    v_mfma_f32_16x16x32_bf16 v[184:187], v[20:23], v[60:63], v[184:187]
    ds_read_b128 v[60:63], v73 offset:10240
    s_waitcnt lgkmcnt(15)
    v_mfma_f32_16x16x32_bf16 v[188:191], v[8:11], v[64:67], v[188:191]
    v_mfma_f32_16x16x32_bf16 v[192:195], v[12:15], v[64:67], v[192:195]
    v_mfma_f32_16x16x32_bf16 v[196:199], v[16:19], v[64:67], v[196:199]
    v_mfma_f32_16x16x32_bf16 v[200:203], v[20:23], v[64:67], v[200:203]
    ds_read_b128 v[64:67], v73 offset:12288
    s_waitcnt lgkmcnt(15)
    v_mfma_f32_16x16x32_bf16 v[204:207], v[8:11], v[68:71], v[204:207]
    v_mfma_f32_16x16x32_bf16 v[208:211], v[12:15], v[68:71], v[208:211]
    v_mfma_f32_16x16x32_bf16 v[212:215], v[16:19], v[68:71], v[212:215]
    v_mfma_f32_16x16x32_bf16 v[216:219], v[20:23], v[68:71], v[216:219]
    ds_read_b128 v[68:71], v73 offset:14336
    s_waitcnt lgkmcnt(7)
    v_mfma_f32_16x16x32_bf16 v[92:95], v[24:27], v[40:43], v[92:95]
    v_mfma_f32_16x16x32_bf16 v[96:99], v[28:31], v[40:43], v[96:99]
    v_mfma_f32_16x16x32_bf16 v[100:103], v[32:35], v[40:43], v[100:103]
    v_mfma_f32_16x16x32_bf16 v[104:107], v[36:39], v[40:43], v[104:107]
    s_waitcnt lgkmcnt(6)
    v_mfma_f32_16x16x32_bf16 v[108:111], v[24:27], v[44:47], v[108:111]
    v_mfma_f32_16x16x32_bf16 v[112:115], v[28:31], v[44:47], v[112:115]
    v_mfma_f32_16x16x32_bf16 v[116:119], v[32:35], v[44:47], v[116:119]
    v_mfma_f32_16x16x32_bf16 v[120:123], v[36:39], v[44:47], v[120:123]
    s_waitcnt lgkmcnt(5)
    v_mfma_f32_16x16x32_bf16 v[124:127], v[24:27], v[48:51], v[124:127]
    v_mfma_f32_16x16x32_bf16 v[128:131], v[28:31], v[48:51], v[128:131]
    v_mfma_f32_16x16x32_bf16 v[132:135], v[32:35], v[48:51], v[132:135]
    v_mfma_f32_16x16x32_bf16 v[136:139], v[36:39], v[48:51], v[136:139]
    s_waitcnt lgkmcnt(4)
    v_mfma_f32_16x16x32_bf16 v[140:143], v[24:27], v[52:55], v[140:143]
    v_mfma_f32_16x16x32_bf16 v[144:147], v[28:31], v[52:55], v[144:147]
    v_mfma_f32_16x16x32_bf16 v[148:151], v[32:35], v[52:55], v[148:151]
    v_mfma_f32_16x16x32_bf16 v[152:155], v[36:39], v[52:55], v[152:155]
    s_waitcnt lgkmcnt(3)
    v_mfma_f32_16x16x32_bf16 v[156:159], v[24:27], v[56:59], v[156:159]
    v_mfma_f32_16x16x32_bf16 v[160:163], v[28:31], v[56:59], v[160:163]
    v_mfma_f32_16x16x32_bf16 v[164:167], v[32:35], v[56:59], v[164:167]
    v_mfma_f32_16x16x32_bf16 v[168:171], v[36:39], v[56:59], v[168:171]
    s_waitcnt lgkmcnt(2)
    v_mfma_f32_16x16x32_bf16 v[172:175], v[24:27], v[60:63], v[172:175]
    v_mfma_f32_16x16x32_bf16 v[176:179], v[28:31], v[60:63], v[176:179]
    v_mfma_f32_16x16x32_bf16 v[180:183], v[32:35], v[60:63], v[180:183]
    v_mfma_f32_16x16x32_bf16 v[184:187], v[36:39], v[60:63], v[184:187]
    s_waitcnt lgkmcnt(1)
    v_mfma_f32_16x16x32_bf16 v[188:191], v[24:27], v[64:67], v[188:191]
    v_mfma_f32_16x16x32_bf16 v[192:195], v[28:31], v[64:67], v[192:195]
    v_mfma_f32_16x16x32_bf16 v[196:199], v[32:35], v[64:67], v[196:199]
    v_mfma_f32_16x16x32_bf16 v[200:203], v[36:39], v[64:67], v[200:203]
    s_waitcnt lgkmcnt(0)
    v_mfma_f32_16x16x32_bf16 v[204:207], v[24:27], v[68:71], v[204:207]
    v_mfma_f32_16x16x32_bf16 v[208:211], v[28:31], v[68:71], v[208:211]
    v_mfma_f32_16x16x32_bf16 v[212:215], v[32:35], v[68:71], v[212:215]
    v_mfma_f32_16x16x32_bf16 v[216:219], v[36:39], v[68:71], v[216:219]
    v_and_b32 v2, 15, v0
    v_lshlrev_b32 v6, 3, v2
    v_add_u32 v6, 147456, v6
    ds_read_b64 v[40:41], v6 offset:0
    ds_read_b64 v[42:43], v6 offset:128
    ds_read_b64 v[44:45], v6 offset:256
    ds_read_b64 v[46:47], v6 offset:384
    ds_read_b64 v[48:49], v6 offset:512
    ds_read_b64 v[50:51], v6 offset:640
    ds_read_b64 v[52:53], v6 offset:768
    ds_read_b64 v[54:55], v6 offset:896
    v_lshrrev_b32 v7, 4, v0
    v_lshlrev_b32 v7, 4, v7
    s_mul_i32 s40, s37, 256
    s_add_u32 s40, s40, 148480
    v_add_u32 v7, s40, v7
    ds_read_b128 v[56:59], v7 offset:0
    ds_read_b128 v[60:63], v7 offset:64
    ds_read_b128 v[64:67], v7 offset:128
    ds_read_b128 v[68:71], v7 offset:192
    s_mov_b32 s46, 0xbfb8aa3b
    s_mov_b32 s47, 0xbfb8aa3b
    s_mul_i32 s40, s23, 128
    v_and_b32 v2, 7, v0
    v_add_u32 v2, s40, v2
    s_mov_b32 s41, 7168
    v_mul_lo_u32 v5, v2, s41
    v_lshrrev_b32 v2, 3, v0
    v_and_b32 v2, 1, v2
    v_lshl_add_u32 v5, v2, 6, v5
    v_lshrrev_b32 v2, 4, v0
    v_and_b32 v3, 1, v2
    v_lshl_add_u32 v5, v3, 5, v5
    v_lshrrev_b32 v2, 5, v0
    v_lshl_add_u32 v5, v2, 4, v5
    s_mul_i32 s40, s37, 128
    s_add_u32 s40, s40, s27
    v_add_u32 v5, s40, v5
    s_waitcnt lgkmcnt(0)
    v_pk_mul_f32 v[24:25], v[56:57], v[40:41] op_sel:[0,1] op_sel_hi:[1,1]
    v_pk_mul_f32 v[26:27], v[58:59], v[40:41] op_sel:[0,1] op_sel_hi:[1,1]
    v_pk_fma_f32 v[92:93], v[92:93], v[40:41], v[24:25] op_sel:[0,0,0] op_sel_hi:[1,0,1]
    v_pk_fma_f32 v[94:95], v[94:95], v[40:41], v[26:27] op_sel:[0,0,0] op_sel_hi:[1,0,1]
    v_exp_f32 v24, v92
    v_exp_f32 v25, v93
    v_exp_f32 v26, v94
    v_exp_f32 v27, v95
    v_pk_fma_f32 v[24:25], v[24:25], s[46:47], s[46:47]
    v_pk_fma_f32 v[26:27], v[26:27], s[46:47], s[46:47]
    v_rcp_f32 v24, v24
    v_rcp_f32 v25, v25
    v_rcp_f32 v26, v26
    v_rcp_f32 v27, v27
    v_pk_mul_f32 v[24:25], v[92:93], v[24:25]
    v_pk_mul_f32 v[26:27], v[94:95], v[26:27]
    v_pk_mul_f32 v[28:29], v[60:61], v[40:41] op_sel:[0,1] op_sel_hi:[1,1]
    v_pk_mul_f32 v[30:31], v[62:63], v[40:41] op_sel:[0,1] op_sel_hi:[1,1]
    v_pk_fma_f32 v[96:97], v[96:97], v[40:41], v[28:29] op_sel:[0,0,0] op_sel_hi:[1,0,1]
    v_pk_fma_f32 v[98:99], v[98:99], v[40:41], v[30:31] op_sel:[0,0,0] op_sel_hi:[1,0,1]
    v_exp_f32 v28, v96
    v_exp_f32 v29, v97
    v_exp_f32 v30, v98
    v_exp_f32 v31, v99
    v_pk_fma_f32 v[28:29], v[28:29], s[46:47], s[46:47]
    v_pk_fma_f32 v[30:31], v[30:31], s[46:47], s[46:47]
    v_rcp_f32 v28, v28
    v_rcp_f32 v29, v29
    v_rcp_f32 v30, v30
    v_rcp_f32 v31, v31
    v_pk_mul_f32 v[28:29], v[96:97], v[28:29]
    v_pk_mul_f32 v[30:31], v[98:99], v[30:31]
    v_cvt_pk_bf16_f32 v8, v24, v25
    v_cvt_pk_bf16_f32 v9, v26, v27
    v_cvt_pk_bf16_f32 v10, v28, v29
    v_cvt_pk_bf16_f32 v11, v30, v31
    s_nop 0
    v_permlane16_swap_b32 v8, v10
    v_permlane16_swap_b32 v9, v11
    v_pk_mul_f32 v[32:33], v[64:65], v[40:41] op_sel:[0,1] op_sel_hi:[1,1]
    v_pk_mul_f32 v[34:35], v[66:67], v[40:41] op_sel:[0,1] op_sel_hi:[1,1]
    v_pk_fma_f32 v[100:101], v[100:101], v[40:41], v[32:33] op_sel:[0,0,0] op_sel_hi:[1,0,1]
    v_pk_fma_f32 v[102:103], v[102:103], v[40:41], v[34:35] op_sel:[0,0,0] op_sel_hi:[1,0,1]
    v_exp_f32 v32, v100
    v_exp_f32 v33, v101
    v_exp_f32 v34, v102
    v_exp_f32 v35, v103
    v_pk_fma_f32 v[32:33], v[32:33], s[46:47], s[46:47]
    v_pk_fma_f32 v[34:35], v[34:35], s[46:47], s[46:47]
    v_rcp_f32 v32, v32
    v_rcp_f32 v33, v33
    v_rcp_f32 v34, v34
    v_rcp_f32 v35, v35
    v_pk_mul_f32 v[32:33], v[100:101], v[32:33]
    v_pk_mul_f32 v[34:35], v[102:103], v[34:35]
    v_pk_mul_f32 v[36:37], v[68:69], v[40:41] op_sel:[0,1] op_sel_hi:[1,1]
    v_pk_mul_f32 v[38:39], v[70:71], v[40:41] op_sel:[0,1] op_sel_hi:[1,1]
    v_pk_fma_f32 v[104:105], v[104:105], v[40:41], v[36:37] op_sel:[0,0,0] op_sel_hi:[1,0,1]
    v_pk_fma_f32 v[106:107], v[106:107], v[40:41], v[38:39] op_sel:[0,0,0] op_sel_hi:[1,0,1]
    v_exp_f32 v36, v104
    v_exp_f32 v37, v105
    v_exp_f32 v38, v106
    v_exp_f32 v39, v107
    v_pk_fma_f32 v[36:37], v[36:37], s[46:47], s[46:47]
    v_pk_fma_f32 v[38:39], v[38:39], s[46:47], s[46:47]
    v_rcp_f32 v36, v36
    v_rcp_f32 v37, v37
    v_rcp_f32 v38, v38
    v_rcp_f32 v39, v39
    v_pk_mul_f32 v[36:37], v[104:105], v[36:37]
    v_pk_mul_f32 v[38:39], v[106:107], v[38:39]
    v_cvt_pk_bf16_f32 v12, v32, v33
    v_cvt_pk_bf16_f32 v13, v34, v35
    v_cvt_pk_bf16_f32 v14, v36, v37
    v_cvt_pk_bf16_f32 v15, v38, v39
    s_nop 0
    v_permlane16_swap_b32 v12, v14
    v_permlane16_swap_b32 v13, v15
    v_mov_b32 v220, v12
    v_mov_b32 v221, v13
    v_mov_b32 v222, v14
    v_mov_b32 v223, v15
    v_mov_b32_dpp v220, v8 row_ror:8 row_mask:0xf bank_mask:0x3
    v_mov_b32_dpp v221, v9 row_ror:8 row_mask:0xf bank_mask:0x3
    v_mov_b32_dpp v222, v10 row_ror:8 row_mask:0xf bank_mask:0x3
    v_mov_b32_dpp v223, v11 row_ror:8 row_mask:0xf bank_mask:0x3
    v_mov_b32_dpp v8, v12 row_ror:8 row_mask:0xf bank_mask:0xc
    v_mov_b32_dpp v9, v13 row_ror:8 row_mask:0xf bank_mask:0xc
    v_mov_b32_dpp v10, v14 row_ror:8 row_mask:0xf bank_mask:0xc
    v_mov_b32_dpp v11, v15 row_ror:8 row_mask:0xf bank_mask:0xc
    s_mov_b32 s40, 0
    s_mov_b32 s41, 57344
    buffer_store_dwordx4 v[8:11], v5, s[12:15], s40 offen sc1
    buffer_store_dwordx4 v[220:223], v5, s[12:15], s41 offen sc1
    v_pk_mul_f32 v[24:25], v[56:57], v[42:43] op_sel:[0,1] op_sel_hi:[1,1]
    v_pk_mul_f32 v[26:27], v[58:59], v[42:43] op_sel:[0,1] op_sel_hi:[1,1]
    v_pk_fma_f32 v[108:109], v[108:109], v[42:43], v[24:25] op_sel:[0,0,0] op_sel_hi:[1,0,1]
    v_pk_fma_f32 v[110:111], v[110:111], v[42:43], v[26:27] op_sel:[0,0,0] op_sel_hi:[1,0,1]
    v_exp_f32 v24, v108
    v_exp_f32 v25, v109
    v_exp_f32 v26, v110
    v_exp_f32 v27, v111
    v_pk_fma_f32 v[24:25], v[24:25], s[46:47], s[46:47]
    v_pk_fma_f32 v[26:27], v[26:27], s[46:47], s[46:47]
    v_rcp_f32 v24, v24
    v_rcp_f32 v25, v25
    v_rcp_f32 v26, v26
    v_rcp_f32 v27, v27
    v_pk_mul_f32 v[24:25], v[108:109], v[24:25]
    v_pk_mul_f32 v[26:27], v[110:111], v[26:27]
    v_pk_mul_f32 v[28:29], v[60:61], v[42:43] op_sel:[0,1] op_sel_hi:[1,1]
    v_pk_mul_f32 v[30:31], v[62:63], v[42:43] op_sel:[0,1] op_sel_hi:[1,1]
    v_pk_fma_f32 v[112:113], v[112:113], v[42:43], v[28:29] op_sel:[0,0,0] op_sel_hi:[1,0,1]
    v_pk_fma_f32 v[114:115], v[114:115], v[42:43], v[30:31] op_sel:[0,0,0] op_sel_hi:[1,0,1]
    v_exp_f32 v28, v112
    v_exp_f32 v29, v113
    v_exp_f32 v30, v114
    v_exp_f32 v31, v115
    v_pk_fma_f32 v[28:29], v[28:29], s[46:47], s[46:47]
    v_pk_fma_f32 v[30:31], v[30:31], s[46:47], s[46:47]
    v_rcp_f32 v28, v28
    v_rcp_f32 v29, v29
    v_rcp_f32 v30, v30
    v_rcp_f32 v31, v31
    v_pk_mul_f32 v[28:29], v[112:113], v[28:29]
    v_pk_mul_f32 v[30:31], v[114:115], v[30:31]
    v_cvt_pk_bf16_f32 v16, v24, v25
    v_cvt_pk_bf16_f32 v17, v26, v27
    v_cvt_pk_bf16_f32 v18, v28, v29
    v_cvt_pk_bf16_f32 v19, v30, v31
    s_nop 0
    v_permlane16_swap_b32 v16, v18
    v_permlane16_swap_b32 v17, v19
    v_pk_mul_f32 v[32:33], v[64:65], v[42:43] op_sel:[0,1] op_sel_hi:[1,1]
    v_pk_mul_f32 v[34:35], v[66:67], v[42:43] op_sel:[0,1] op_sel_hi:[1,1]
    v_pk_fma_f32 v[116:117], v[116:117], v[42:43], v[32:33] op_sel:[0,0,0] op_sel_hi:[1,0,1]
    v_pk_fma_f32 v[118:119], v[118:119], v[42:43], v[34:35] op_sel:[0,0,0] op_sel_hi:[1,0,1]
    v_exp_f32 v32, v116
    v_exp_f32 v33, v117
    v_exp_f32 v34, v118
    v_exp_f32 v35, v119
    v_pk_fma_f32 v[32:33], v[32:33], s[46:47], s[46:47]
    v_pk_fma_f32 v[34:35], v[34:35], s[46:47], s[46:47]
    v_rcp_f32 v32, v32
    v_rcp_f32 v33, v33
    v_rcp_f32 v34, v34
    v_rcp_f32 v35, v35
    v_pk_mul_f32 v[32:33], v[116:117], v[32:33]
    v_pk_mul_f32 v[34:35], v[118:119], v[34:35]
    v_pk_mul_f32 v[36:37], v[68:69], v[42:43] op_sel:[0,1] op_sel_hi:[1,1]
    v_pk_mul_f32 v[38:39], v[70:71], v[42:43] op_sel:[0,1] op_sel_hi:[1,1]
    v_pk_fma_f32 v[120:121], v[120:121], v[42:43], v[36:37] op_sel:[0,0,0] op_sel_hi:[1,0,1]
    v_pk_fma_f32 v[122:123], v[122:123], v[42:43], v[38:39] op_sel:[0,0,0] op_sel_hi:[1,0,1]
    v_exp_f32 v36, v120
    v_exp_f32 v37, v121
    v_exp_f32 v38, v122
    v_exp_f32 v39, v123
    v_pk_fma_f32 v[36:37], v[36:37], s[46:47], s[46:47]
    v_pk_fma_f32 v[38:39], v[38:39], s[46:47], s[46:47]
    v_rcp_f32 v36, v36
    v_rcp_f32 v37, v37
    v_rcp_f32 v38, v38
    v_rcp_f32 v39, v39
    v_pk_mul_f32 v[36:37], v[120:121], v[36:37]
    v_pk_mul_f32 v[38:39], v[122:123], v[38:39]
    v_cvt_pk_bf16_f32 v20, v32, v33
    v_cvt_pk_bf16_f32 v21, v34, v35
    v_cvt_pk_bf16_f32 v22, v36, v37
    v_cvt_pk_bf16_f32 v23, v38, v39
    s_nop 0
    v_permlane16_swap_b32 v20, v22
    v_permlane16_swap_b32 v21, v23
    v_mov_b32 v224, v20
    v_mov_b32 v225, v21
    v_mov_b32 v226, v22
    v_mov_b32 v227, v23
    v_mov_b32_dpp v224, v16 row_ror:8 row_mask:0xf bank_mask:0x3
    v_mov_b32_dpp v225, v17 row_ror:8 row_mask:0xf bank_mask:0x3
    v_mov_b32_dpp v226, v18 row_ror:8 row_mask:0xf bank_mask:0x3
    v_mov_b32_dpp v227, v19 row_ror:8 row_mask:0xf bank_mask:0x3
    v_mov_b32_dpp v16, v20 row_ror:8 row_mask:0xf bank_mask:0xc
    v_mov_b32_dpp v17, v21 row_ror:8 row_mask:0xf bank_mask:0xc
    v_mov_b32_dpp v18, v22 row_ror:8 row_mask:0xf bank_mask:0xc
    v_mov_b32_dpp v19, v23 row_ror:8 row_mask:0xf bank_mask:0xc
    s_mov_b32 s40, 114688
    s_mov_b32 s41, 172032
    buffer_store_dwordx4 v[16:19], v5, s[12:15], s40 offen sc1
    buffer_store_dwordx4 v[224:227], v5, s[12:15], s41 offen sc1
    v_pk_mul_f32 v[24:25], v[56:57], v[44:45] op_sel:[0,1] op_sel_hi:[1,1]
    v_pk_mul_f32 v[26:27], v[58:59], v[44:45] op_sel:[0,1] op_sel_hi:[1,1]
    v_pk_fma_f32 v[124:125], v[124:125], v[44:45], v[24:25] op_sel:[0,0,0] op_sel_hi:[1,0,1]
    v_pk_fma_f32 v[126:127], v[126:127], v[44:45], v[26:27] op_sel:[0,0,0] op_sel_hi:[1,0,1]
    v_exp_f32 v24, v124
    v_exp_f32 v25, v125
    v_exp_f32 v26, v126
    v_exp_f32 v27, v127
    v_pk_fma_f32 v[24:25], v[24:25], s[46:47], s[46:47]
    v_pk_fma_f32 v[26:27], v[26:27], s[46:47], s[46:47]
    v_rcp_f32 v24, v24
    v_rcp_f32 v25, v25
    v_rcp_f32 v26, v26
    v_rcp_f32 v27, v27
    v_pk_mul_f32 v[24:25], v[124:125], v[24:25]
    v_pk_mul_f32 v[26:27], v[126:127], v[26:27]
    v_pk_mul_f32 v[28:29], v[60:61], v[44:45] op_sel:[0,1] op_sel_hi:[1,1]
    v_pk_mul_f32 v[30:31], v[62:63], v[44:45] op_sel:[0,1] op_sel_hi:[1,1]
    v_pk_fma_f32 v[128:129], v[128:129], v[44:45], v[28:29] op_sel:[0,0,0] op_sel_hi:[1,0,1]
    v_pk_fma_f32 v[130:131], v[130:131], v[44:45], v[30:31] op_sel:[0,0,0] op_sel_hi:[1,0,1]
    v_exp_f32 v28, v128
    v_exp_f32 v29, v129
    v_exp_f32 v30, v130
    v_exp_f32 v31, v131
    v_pk_fma_f32 v[28:29], v[28:29], s[46:47], s[46:47]
    v_pk_fma_f32 v[30:31], v[30:31], s[46:47], s[46:47]
    v_rcp_f32 v28, v28
    v_rcp_f32 v29, v29
    v_rcp_f32 v30, v30
    v_rcp_f32 v31, v31
    v_pk_mul_f32 v[28:29], v[128:129], v[28:29]
    v_pk_mul_f32 v[30:31], v[130:131], v[30:31]
    v_cvt_pk_bf16_f32 v8, v24, v25
    v_cvt_pk_bf16_f32 v9, v26, v27
    v_cvt_pk_bf16_f32 v10, v28, v29
    v_cvt_pk_bf16_f32 v11, v30, v31
    s_nop 0
    v_permlane16_swap_b32 v8, v10
    v_permlane16_swap_b32 v9, v11
    v_pk_mul_f32 v[32:33], v[64:65], v[44:45] op_sel:[0,1] op_sel_hi:[1,1]
    v_pk_mul_f32 v[34:35], v[66:67], v[44:45] op_sel:[0,1] op_sel_hi:[1,1]
    v_pk_fma_f32 v[132:133], v[132:133], v[44:45], v[32:33] op_sel:[0,0,0] op_sel_hi:[1,0,1]
    v_pk_fma_f32 v[134:135], v[134:135], v[44:45], v[34:35] op_sel:[0,0,0] op_sel_hi:[1,0,1]
    v_exp_f32 v32, v132
    v_exp_f32 v33, v133
    v_exp_f32 v34, v134
    v_exp_f32 v35, v135
    v_pk_fma_f32 v[32:33], v[32:33], s[46:47], s[46:47]
    v_pk_fma_f32 v[34:35], v[34:35], s[46:47], s[46:47]
    v_rcp_f32 v32, v32
    v_rcp_f32 v33, v33
    v_rcp_f32 v34, v34
    v_rcp_f32 v35, v35
    v_pk_mul_f32 v[32:33], v[132:133], v[32:33]
    v_pk_mul_f32 v[34:35], v[134:135], v[34:35]
    v_pk_mul_f32 v[36:37], v[68:69], v[44:45] op_sel:[0,1] op_sel_hi:[1,1]
    v_pk_mul_f32 v[38:39], v[70:71], v[44:45] op_sel:[0,1] op_sel_hi:[1,1]
    v_pk_fma_f32 v[136:137], v[136:137], v[44:45], v[36:37] op_sel:[0,0,0] op_sel_hi:[1,0,1]
    v_pk_fma_f32 v[138:139], v[138:139], v[44:45], v[38:39] op_sel:[0,0,0] op_sel_hi:[1,0,1]
    v_exp_f32 v36, v136
    v_exp_f32 v37, v137
    v_exp_f32 v38, v138
    v_exp_f32 v39, v139
    v_pk_fma_f32 v[36:37], v[36:37], s[46:47], s[46:47]
    v_pk_fma_f32 v[38:39], v[38:39], s[46:47], s[46:47]
    v_rcp_f32 v36, v36
    v_rcp_f32 v37, v37
    v_rcp_f32 v38, v38
    v_rcp_f32 v39, v39
    v_pk_mul_f32 v[36:37], v[136:137], v[36:37]
    v_pk_mul_f32 v[38:39], v[138:139], v[38:39]
    v_cvt_pk_bf16_f32 v12, v32, v33
    v_cvt_pk_bf16_f32 v13, v34, v35
    v_cvt_pk_bf16_f32 v14, v36, v37
    v_cvt_pk_bf16_f32 v15, v38, v39
    s_nop 0
    v_permlane16_swap_b32 v12, v14
    v_permlane16_swap_b32 v13, v15
    v_mov_b32 v228, v12
    v_mov_b32 v229, v13
    v_mov_b32 v230, v14
    v_mov_b32 v231, v15
    v_mov_b32_dpp v228, v8 row_ror:8 row_mask:0xf bank_mask:0x3
    v_mov_b32_dpp v229, v9 row_ror:8 row_mask:0xf bank_mask:0x3
    v_mov_b32_dpp v230, v10 row_ror:8 row_mask:0xf bank_mask:0x3
    v_mov_b32_dpp v231, v11 row_ror:8 row_mask:0xf bank_mask:0x3
    v_mov_b32_dpp v8, v12 row_ror:8 row_mask:0xf bank_mask:0xc
    v_mov_b32_dpp v9, v13 row_ror:8 row_mask:0xf bank_mask:0xc
    v_mov_b32_dpp v10, v14 row_ror:8 row_mask:0xf bank_mask:0xc
    v_mov_b32_dpp v11, v15 row_ror:8 row_mask:0xf bank_mask:0xc
    s_mov_b32 s40, 229376
    s_mov_b32 s41, 286720
    buffer_store_dwordx4 v[8:11], v5, s[12:15], s40 offen sc1
    buffer_store_dwordx4 v[228:231], v5, s[12:15], s41 offen sc1
    v_pk_mul_f32 v[24:25], v[56:57], v[46:47] op_sel:[0,1] op_sel_hi:[1,1]
    v_pk_mul_f32 v[26:27], v[58:59], v[46:47] op_sel:[0,1] op_sel_hi:[1,1]
    v_pk_fma_f32 v[140:141], v[140:141], v[46:47], v[24:25] op_sel:[0,0,0] op_sel_hi:[1,0,1]
    v_pk_fma_f32 v[142:143], v[142:143], v[46:47], v[26:27] op_sel:[0,0,0] op_sel_hi:[1,0,1]
    v_exp_f32 v24, v140
    v_exp_f32 v25, v141
    v_exp_f32 v26, v142
    v_exp_f32 v27, v143
    v_pk_fma_f32 v[24:25], v[24:25], s[46:47], s[46:47]
    v_pk_fma_f32 v[26:27], v[26:27], s[46:47], s[46:47]
    v_rcp_f32 v24, v24
    v_rcp_f32 v25, v25
    v_rcp_f32 v26, v26
    v_rcp_f32 v27, v27
    v_pk_mul_f32 v[24:25], v[140:141], v[24:25]
    v_pk_mul_f32 v[26:27], v[142:143], v[26:27]
    v_pk_mul_f32 v[28:29], v[60:61], v[46:47] op_sel:[0,1] op_sel_hi:[1,1]
    v_pk_mul_f32 v[30:31], v[62:63], v[46:47] op_sel:[0,1] op_sel_hi:[1,1]
    v_pk_fma_f32 v[144:145], v[144:145], v[46:47], v[28:29] op_sel:[0,0,0] op_sel_hi:[1,0,1]
    v_pk_fma_f32 v[146:147], v[146:147], v[46:47], v[30:31] op_sel:[0,0,0] op_sel_hi:[1,0,1]
    v_exp_f32 v28, v144
    v_exp_f32 v29, v145
    v_exp_f32 v30, v146
    v_exp_f32 v31, v147
    v_pk_fma_f32 v[28:29], v[28:29], s[46:47], s[46:47]
    v_pk_fma_f32 v[30:31], v[30:31], s[46:47], s[46:47]
    v_rcp_f32 v28, v28
    v_rcp_f32 v29, v29
    v_rcp_f32 v30, v30
    v_rcp_f32 v31, v31
    v_pk_mul_f32 v[28:29], v[144:145], v[28:29]
    v_pk_mul_f32 v[30:31], v[146:147], v[30:31]
    v_cvt_pk_bf16_f32 v16, v24, v25
    v_cvt_pk_bf16_f32 v17, v26, v27
    v_cvt_pk_bf16_f32 v18, v28, v29
    v_cvt_pk_bf16_f32 v19, v30, v31
    s_nop 0
    v_permlane16_swap_b32 v16, v18
    v_permlane16_swap_b32 v17, v19
    v_pk_mul_f32 v[32:33], v[64:65], v[46:47] op_sel:[0,1] op_sel_hi:[1,1]
    v_pk_mul_f32 v[34:35], v[66:67], v[46:47] op_sel:[0,1] op_sel_hi:[1,1]
    v_pk_fma_f32 v[148:149], v[148:149], v[46:47], v[32:33] op_sel:[0,0,0] op_sel_hi:[1,0,1]
    v_pk_fma_f32 v[150:151], v[150:151], v[46:47], v[34:35] op_sel:[0,0,0] op_sel_hi:[1,0,1]
    v_exp_f32 v32, v148
    v_exp_f32 v33, v149
    v_exp_f32 v34, v150
    v_exp_f32 v35, v151
    v_pk_fma_f32 v[32:33], v[32:33], s[46:47], s[46:47]
    v_pk_fma_f32 v[34:35], v[34:35], s[46:47], s[46:47]
    v_rcp_f32 v32, v32
    v_rcp_f32 v33, v33
    v_rcp_f32 v34, v34
    v_rcp_f32 v35, v35
    v_pk_mul_f32 v[32:33], v[148:149], v[32:33]
    v_pk_mul_f32 v[34:35], v[150:151], v[34:35]
    v_pk_mul_f32 v[36:37], v[68:69], v[46:47] op_sel:[0,1] op_sel_hi:[1,1]
    v_pk_mul_f32 v[38:39], v[70:71], v[46:47] op_sel:[0,1] op_sel_hi:[1,1]
    v_pk_fma_f32 v[152:153], v[152:153], v[46:47], v[36:37] op_sel:[0,0,0] op_sel_hi:[1,0,1]
    v_pk_fma_f32 v[154:155], v[154:155], v[46:47], v[38:39] op_sel:[0,0,0] op_sel_hi:[1,0,1]
    v_exp_f32 v36, v152
    v_exp_f32 v37, v153
    v_exp_f32 v38, v154
    v_exp_f32 v39, v155
    v_pk_fma_f32 v[36:37], v[36:37], s[46:47], s[46:47]
    v_pk_fma_f32 v[38:39], v[38:39], s[46:47], s[46:47]
    v_rcp_f32 v36, v36
    v_rcp_f32 v37, v37
    v_rcp_f32 v38, v38
    v_rcp_f32 v39, v39
    v_pk_mul_f32 v[36:37], v[152:153], v[36:37]
    v_pk_mul_f32 v[38:39], v[154:155], v[38:39]
    v_cvt_pk_bf16_f32 v20, v32, v33
    v_cvt_pk_bf16_f32 v21, v34, v35
    v_cvt_pk_bf16_f32 v22, v36, v37
    v_cvt_pk_bf16_f32 v23, v38, v39
    s_nop 0
    v_permlane16_swap_b32 v20, v22
    v_permlane16_swap_b32 v21, v23
    v_mov_b32 v220, v20
    v_mov_b32 v221, v21
    v_mov_b32 v222, v22
    v_mov_b32 v223, v23
    v_mov_b32_dpp v220, v16 row_ror:8 row_mask:0xf bank_mask:0x3
    v_mov_b32_dpp v221, v17 row_ror:8 row_mask:0xf bank_mask:0x3
    v_mov_b32_dpp v222, v18 row_ror:8 row_mask:0xf bank_mask:0x3
    v_mov_b32_dpp v223, v19 row_ror:8 row_mask:0xf bank_mask:0x3
    v_mov_b32_dpp v16, v20 row_ror:8 row_mask:0xf bank_mask:0xc
    v_mov_b32_dpp v17, v21 row_ror:8 row_mask:0xf bank_mask:0xc
    v_mov_b32_dpp v18, v22 row_ror:8 row_mask:0xf bank_mask:0xc
    v_mov_b32_dpp v19, v23 row_ror:8 row_mask:0xf bank_mask:0xc
    s_mov_b32 s40, 344064
    s_mov_b32 s41, 401408
    buffer_store_dwordx4 v[16:19], v5, s[12:15], s40 offen sc1
    buffer_store_dwordx4 v[220:223], v5, s[12:15], s41 offen sc1
    v_pk_mul_f32 v[24:25], v[56:57], v[48:49] op_sel:[0,1] op_sel_hi:[1,1]
    v_pk_mul_f32 v[26:27], v[58:59], v[48:49] op_sel:[0,1] op_sel_hi:[1,1]
    v_pk_fma_f32 v[156:157], v[156:157], v[48:49], v[24:25] op_sel:[0,0,0] op_sel_hi:[1,0,1]
    v_pk_fma_f32 v[158:159], v[158:159], v[48:49], v[26:27] op_sel:[0,0,0] op_sel_hi:[1,0,1]
    v_exp_f32 v24, v156
    v_exp_f32 v25, v157
    v_exp_f32 v26, v158
    v_exp_f32 v27, v159
    v_pk_fma_f32 v[24:25], v[24:25], s[46:47], s[46:47]
    v_pk_fma_f32 v[26:27], v[26:27], s[46:47], s[46:47]
    v_rcp_f32 v24, v24
    v_rcp_f32 v25, v25
    v_rcp_f32 v26, v26
    v_rcp_f32 v27, v27
    v_pk_mul_f32 v[24:25], v[156:157], v[24:25]
    v_pk_mul_f32 v[26:27], v[158:159], v[26:27]
    v_pk_mul_f32 v[28:29], v[60:61], v[48:49] op_sel:[0,1] op_sel_hi:[1,1]
    v_pk_mul_f32 v[30:31], v[62:63], v[48:49] op_sel:[0,1] op_sel_hi:[1,1]
    v_pk_fma_f32 v[160:161], v[160:161], v[48:49], v[28:29] op_sel:[0,0,0] op_sel_hi:[1,0,1]
    v_pk_fma_f32 v[162:163], v[162:163], v[48:49], v[30:31] op_sel:[0,0,0] op_sel_hi:[1,0,1]
    v_exp_f32 v28, v160
    v_exp_f32 v29, v161
    v_exp_f32 v30, v162
    v_exp_f32 v31, v163
    v_pk_fma_f32 v[28:29], v[28:29], s[46:47], s[46:47]
    v_pk_fma_f32 v[30:31], v[30:31], s[46:47], s[46:47]
    v_rcp_f32 v28, v28
    v_rcp_f32 v29, v29
    v_rcp_f32 v30, v30
    v_rcp_f32 v31, v31
    v_pk_mul_f32 v[28:29], v[160:161], v[28:29]
    v_pk_mul_f32 v[30:31], v[162:163], v[30:31]
    v_cvt_pk_bf16_f32 v8, v24, v25
    v_cvt_pk_bf16_f32 v9, v26, v27
    v_cvt_pk_bf16_f32 v10, v28, v29
    v_cvt_pk_bf16_f32 v11, v30, v31
    s_nop 0
    v_permlane16_swap_b32 v8, v10
    v_permlane16_swap_b32 v9, v11
    v_pk_mul_f32 v[32:33], v[64:65], v[48:49] op_sel:[0,1] op_sel_hi:[1,1]
    v_pk_mul_f32 v[34:35], v[66:67], v[48:49] op_sel:[0,1] op_sel_hi:[1,1]
    v_pk_fma_f32 v[164:165], v[164:165], v[48:49], v[32:33] op_sel:[0,0,0] op_sel_hi:[1,0,1]
    v_pk_fma_f32 v[166:167], v[166:167], v[48:49], v[34:35] op_sel:[0,0,0] op_sel_hi:[1,0,1]
    v_exp_f32 v32, v164
    v_exp_f32 v33, v165
    v_exp_f32 v34, v166
    v_exp_f32 v35, v167
    v_pk_fma_f32 v[32:33], v[32:33], s[46:47], s[46:47]
    v_pk_fma_f32 v[34:35], v[34:35], s[46:47], s[46:47]
    v_rcp_f32 v32, v32
    v_rcp_f32 v33, v33
    v_rcp_f32 v34, v34
    v_rcp_f32 v35, v35
    v_pk_mul_f32 v[32:33], v[164:165], v[32:33]
    v_pk_mul_f32 v[34:35], v[166:167], v[34:35]
    v_pk_mul_f32 v[36:37], v[68:69], v[48:49] op_sel:[0,1] op_sel_hi:[1,1]
    v_pk_mul_f32 v[38:39], v[70:71], v[48:49] op_sel:[0,1] op_sel_hi:[1,1]
    v_pk_fma_f32 v[168:169], v[168:169], v[48:49], v[36:37] op_sel:[0,0,0] op_sel_hi:[1,0,1]
    v_pk_fma_f32 v[170:171], v[170:171], v[48:49], v[38:39] op_sel:[0,0,0] op_sel_hi:[1,0,1]
    v_exp_f32 v36, v168
    v_exp_f32 v37, v169
    v_exp_f32 v38, v170
    v_exp_f32 v39, v171
    v_pk_fma_f32 v[36:37], v[36:37], s[46:47], s[46:47]
    v_pk_fma_f32 v[38:39], v[38:39], s[46:47], s[46:47]
    v_rcp_f32 v36, v36
    v_rcp_f32 v37, v37
    v_rcp_f32 v38, v38
    v_rcp_f32 v39, v39
    v_pk_mul_f32 v[36:37], v[168:169], v[36:37]
    v_pk_mul_f32 v[38:39], v[170:171], v[38:39]
    v_cvt_pk_bf16_f32 v12, v32, v33
    v_cvt_pk_bf16_f32 v13, v34, v35
    v_cvt_pk_bf16_f32 v14, v36, v37
    v_cvt_pk_bf16_f32 v15, v38, v39
    s_nop 0
    v_permlane16_swap_b32 v12, v14
    v_permlane16_swap_b32 v13, v15
    v_mov_b32 v224, v12
    v_mov_b32 v225, v13
    v_mov_b32 v226, v14
    v_mov_b32 v227, v15
    v_mov_b32_dpp v224, v8 row_ror:8 row_mask:0xf bank_mask:0x3
    v_mov_b32_dpp v225, v9 row_ror:8 row_mask:0xf bank_mask:0x3
    v_mov_b32_dpp v226, v10 row_ror:8 row_mask:0xf bank_mask:0x3
    v_mov_b32_dpp v227, v11 row_ror:8 row_mask:0xf bank_mask:0x3
    v_mov_b32_dpp v8, v12 row_ror:8 row_mask:0xf bank_mask:0xc
    v_mov_b32_dpp v9, v13 row_ror:8 row_mask:0xf bank_mask:0xc
    v_mov_b32_dpp v10, v14 row_ror:8 row_mask:0xf bank_mask:0xc
    v_mov_b32_dpp v11, v15 row_ror:8 row_mask:0xf bank_mask:0xc
    s_mov_b32 s40, 458752
    s_mov_b32 s41, 516096
    buffer_store_dwordx4 v[8:11], v5, s[12:15], s40 offen sc1
    buffer_store_dwordx4 v[224:227], v5, s[12:15], s41 offen sc1
    v_pk_mul_f32 v[24:25], v[56:57], v[50:51] op_sel:[0,1] op_sel_hi:[1,1]
    v_pk_mul_f32 v[26:27], v[58:59], v[50:51] op_sel:[0,1] op_sel_hi:[1,1]
    v_pk_fma_f32 v[172:173], v[172:173], v[50:51], v[24:25] op_sel:[0,0,0] op_sel_hi:[1,0,1]
    v_pk_fma_f32 v[174:175], v[174:175], v[50:51], v[26:27] op_sel:[0,0,0] op_sel_hi:[1,0,1]
    v_exp_f32 v24, v172
    v_exp_f32 v25, v173
    v_exp_f32 v26, v174
    v_exp_f32 v27, v175
    v_pk_fma_f32 v[24:25], v[24:25], s[46:47], s[46:47]
    v_pk_fma_f32 v[26:27], v[26:27], s[46:47], s[46:47]
    v_rcp_f32 v24, v24
    v_rcp_f32 v25, v25
    v_rcp_f32 v26, v26
    v_rcp_f32 v27, v27
    v_pk_mul_f32 v[24:25], v[172:173], v[24:25]
    v_pk_mul_f32 v[26:27], v[174:175], v[26:27]
    v_pk_mul_f32 v[28:29], v[60:61], v[50:51] op_sel:[0,1] op_sel_hi:[1,1]
    v_pk_mul_f32 v[30:31], v[62:63], v[50:51] op_sel:[0,1] op_sel_hi:[1,1]
    v_pk_fma_f32 v[176:177], v[176:177], v[50:51], v[28:29] op_sel:[0,0,0] op_sel_hi:[1,0,1]
    v_pk_fma_f32 v[178:179], v[178:179], v[50:51], v[30:31] op_sel:[0,0,0] op_sel_hi:[1,0,1]
    v_exp_f32 v28, v176
    v_exp_f32 v29, v177
    v_exp_f32 v30, v178
    v_exp_f32 v31, v179
    v_pk_fma_f32 v[28:29], v[28:29], s[46:47], s[46:47]
    v_pk_fma_f32 v[30:31], v[30:31], s[46:47], s[46:47]
    v_rcp_f32 v28, v28
    v_rcp_f32 v29, v29
    v_rcp_f32 v30, v30
    v_rcp_f32 v31, v31
    v_pk_mul_f32 v[28:29], v[176:177], v[28:29]
    v_pk_mul_f32 v[30:31], v[178:179], v[30:31]
    v_cvt_pk_bf16_f32 v16, v24, v25
    v_cvt_pk_bf16_f32 v17, v26, v27
    v_cvt_pk_bf16_f32 v18, v28, v29
    v_cvt_pk_bf16_f32 v19, v30, v31
    s_nop 0
    v_permlane16_swap_b32 v16, v18
    v_permlane16_swap_b32 v17, v19
    v_pk_mul_f32 v[32:33], v[64:65], v[50:51] op_sel:[0,1] op_sel_hi:[1,1]
    v_pk_mul_f32 v[34:35], v[66:67], v[50:51] op_sel:[0,1] op_sel_hi:[1,1]
    v_pk_fma_f32 v[180:181], v[180:181], v[50:51], v[32:33] op_sel:[0,0,0] op_sel_hi:[1,0,1]
    v_pk_fma_f32 v[182:183], v[182:183], v[50:51], v[34:35] op_sel:[0,0,0] op_sel_hi:[1,0,1]
    v_exp_f32 v32, v180
    v_exp_f32 v33, v181
    v_exp_f32 v34, v182
    v_exp_f32 v35, v183
    v_pk_fma_f32 v[32:33], v[32:33], s[46:47], s[46:47]
    v_pk_fma_f32 v[34:35], v[34:35], s[46:47], s[46:47]
    v_rcp_f32 v32, v32
    v_rcp_f32 v33, v33
    v_rcp_f32 v34, v34
    v_rcp_f32 v35, v35
    v_pk_mul_f32 v[32:33], v[180:181], v[32:33]
    v_pk_mul_f32 v[34:35], v[182:183], v[34:35]
    v_pk_mul_f32 v[36:37], v[68:69], v[50:51] op_sel:[0,1] op_sel_hi:[1,1]
    v_pk_mul_f32 v[38:39], v[70:71], v[50:51] op_sel:[0,1] op_sel_hi:[1,1]
    v_pk_fma_f32 v[184:185], v[184:185], v[50:51], v[36:37] op_sel:[0,0,0] op_sel_hi:[1,0,1]
    v_pk_fma_f32 v[186:187], v[186:187], v[50:51], v[38:39] op_sel:[0,0,0] op_sel_hi:[1,0,1]
    v_exp_f32 v36, v184
    v_exp_f32 v37, v185
    v_exp_f32 v38, v186
    v_exp_f32 v39, v187
    v_pk_fma_f32 v[36:37], v[36:37], s[46:47], s[46:47]
    v_pk_fma_f32 v[38:39], v[38:39], s[46:47], s[46:47]
    v_rcp_f32 v36, v36
    v_rcp_f32 v37, v37
    v_rcp_f32 v38, v38
    v_rcp_f32 v39, v39
    v_pk_mul_f32 v[36:37], v[184:185], v[36:37]
    v_pk_mul_f32 v[38:39], v[186:187], v[38:39]
    v_cvt_pk_bf16_f32 v20, v32, v33
    v_cvt_pk_bf16_f32 v21, v34, v35
    v_cvt_pk_bf16_f32 v22, v36, v37
    v_cvt_pk_bf16_f32 v23, v38, v39
    s_nop 0
    v_permlane16_swap_b32 v20, v22
    v_permlane16_swap_b32 v21, v23
    v_mov_b32 v228, v20
    v_mov_b32 v229, v21
    v_mov_b32 v230, v22
    v_mov_b32 v231, v23
    v_mov_b32_dpp v228, v16 row_ror:8 row_mask:0xf bank_mask:0x3
    v_mov_b32_dpp v229, v17 row_ror:8 row_mask:0xf bank_mask:0x3
    v_mov_b32_dpp v230, v18 row_ror:8 row_mask:0xf bank_mask:0x3
    v_mov_b32_dpp v231, v19 row_ror:8 row_mask:0xf bank_mask:0x3
    v_mov_b32_dpp v16, v20 row_ror:8 row_mask:0xf bank_mask:0xc
    v_mov_b32_dpp v17, v21 row_ror:8 row_mask:0xf bank_mask:0xc
    v_mov_b32_dpp v18, v22 row_ror:8 row_mask:0xf bank_mask:0xc
    v_mov_b32_dpp v19, v23 row_ror:8 row_mask:0xf bank_mask:0xc
    s_mov_b32 s40, 573440
    s_mov_b32 s41, 630784
    buffer_store_dwordx4 v[16:19], v5, s[12:15], s40 offen sc1
    buffer_store_dwordx4 v[228:231], v5, s[12:15], s41 offen sc1
    v_pk_mul_f32 v[24:25], v[56:57], v[52:53] op_sel:[0,1] op_sel_hi:[1,1]
    v_pk_mul_f32 v[26:27], v[58:59], v[52:53] op_sel:[0,1] op_sel_hi:[1,1]
    v_pk_fma_f32 v[188:189], v[188:189], v[52:53], v[24:25] op_sel:[0,0,0] op_sel_hi:[1,0,1]
    v_pk_fma_f32 v[190:191], v[190:191], v[52:53], v[26:27] op_sel:[0,0,0] op_sel_hi:[1,0,1]
    v_exp_f32 v24, v188
    v_exp_f32 v25, v189
    v_exp_f32 v26, v190
    v_exp_f32 v27, v191
    v_pk_fma_f32 v[24:25], v[24:25], s[46:47], s[46:47]
    v_pk_fma_f32 v[26:27], v[26:27], s[46:47], s[46:47]
    v_rcp_f32 v24, v24
    v_rcp_f32 v25, v25
    v_rcp_f32 v26, v26
    v_rcp_f32 v27, v27
    v_pk_mul_f32 v[24:25], v[188:189], v[24:25]
    v_pk_mul_f32 v[26:27], v[190:191], v[26:27]
    v_pk_mul_f32 v[28:29], v[60:61], v[52:53] op_sel:[0,1] op_sel_hi:[1,1]
    v_pk_mul_f32 v[30:31], v[62:63], v[52:53] op_sel:[0,1] op_sel_hi:[1,1]
    v_pk_fma_f32 v[192:193], v[192:193], v[52:53], v[28:29] op_sel:[0,0,0] op_sel_hi:[1,0,1]
    v_pk_fma_f32 v[194:195], v[194:195], v[52:53], v[30:31] op_sel:[0,0,0] op_sel_hi:[1,0,1]
    v_exp_f32 v28, v192
    v_exp_f32 v29, v193
    v_exp_f32 v30, v194
    v_exp_f32 v31, v195
    v_pk_fma_f32 v[28:29], v[28:29], s[46:47], s[46:47]
    v_pk_fma_f32 v[30:31], v[30:31], s[46:47], s[46:47]
    v_rcp_f32 v28, v28
    v_rcp_f32 v29, v29
    v_rcp_f32 v30, v30
    v_rcp_f32 v31, v31
    v_pk_mul_f32 v[28:29], v[192:193], v[28:29]
    v_pk_mul_f32 v[30:31], v[194:195], v[30:31]
    v_cvt_pk_bf16_f32 v8, v24, v25
    v_cvt_pk_bf16_f32 v9, v26, v27
    v_cvt_pk_bf16_f32 v10, v28, v29
    v_cvt_pk_bf16_f32 v11, v30, v31
    s_nop 0
    v_permlane16_swap_b32 v8, v10
    v_permlane16_swap_b32 v9, v11
    v_pk_mul_f32 v[32:33], v[64:65], v[52:53] op_sel:[0,1] op_sel_hi:[1,1]
    v_pk_mul_f32 v[34:35], v[66:67], v[52:53] op_sel:[0,1] op_sel_hi:[1,1]
    v_pk_fma_f32 v[196:197], v[196:197], v[52:53], v[32:33] op_sel:[0,0,0] op_sel_hi:[1,0,1]
    v_pk_fma_f32 v[198:199], v[198:199], v[52:53], v[34:35] op_sel:[0,0,0] op_sel_hi:[1,0,1]
    v_exp_f32 v32, v196
    v_exp_f32 v33, v197
    v_exp_f32 v34, v198
    v_exp_f32 v35, v199
    v_pk_fma_f32 v[32:33], v[32:33], s[46:47], s[46:47]
    v_pk_fma_f32 v[34:35], v[34:35], s[46:47], s[46:47]
    v_rcp_f32 v32, v32
    v_rcp_f32 v33, v33
    v_rcp_f32 v34, v34
    v_rcp_f32 v35, v35
    v_pk_mul_f32 v[32:33], v[196:197], v[32:33]
    v_pk_mul_f32 v[34:35], v[198:199], v[34:35]
    v_pk_mul_f32 v[36:37], v[68:69], v[52:53] op_sel:[0,1] op_sel_hi:[1,1]
    v_pk_mul_f32 v[38:39], v[70:71], v[52:53] op_sel:[0,1] op_sel_hi:[1,1]
    v_pk_fma_f32 v[200:201], v[200:201], v[52:53], v[36:37] op_sel:[0,0,0] op_sel_hi:[1,0,1]
    v_pk_fma_f32 v[202:203], v[202:203], v[52:53], v[38:39] op_sel:[0,0,0] op_sel_hi:[1,0,1]
    v_exp_f32 v36, v200
    v_exp_f32 v37, v201
    v_exp_f32 v38, v202
    v_exp_f32 v39, v203
    v_pk_fma_f32 v[36:37], v[36:37], s[46:47], s[46:47]
    v_pk_fma_f32 v[38:39], v[38:39], s[46:47], s[46:47]
    v_rcp_f32 v36, v36
    v_rcp_f32 v37, v37
    v_rcp_f32 v38, v38
    v_rcp_f32 v39, v39
    v_pk_mul_f32 v[36:37], v[200:201], v[36:37]
    v_pk_mul_f32 v[38:39], v[202:203], v[38:39]
    v_cvt_pk_bf16_f32 v12, v32, v33
    v_cvt_pk_bf16_f32 v13, v34, v35
    v_cvt_pk_bf16_f32 v14, v36, v37
    v_cvt_pk_bf16_f32 v15, v38, v39
    s_nop 0
    v_permlane16_swap_b32 v12, v14
    v_permlane16_swap_b32 v13, v15
    v_mov_b32 v220, v12
    v_mov_b32 v221, v13
    v_mov_b32 v222, v14
    v_mov_b32 v223, v15
    v_mov_b32_dpp v220, v8 row_ror:8 row_mask:0xf bank_mask:0x3
    v_mov_b32_dpp v221, v9 row_ror:8 row_mask:0xf bank_mask:0x3
    v_mov_b32_dpp v222, v10 row_ror:8 row_mask:0xf bank_mask:0x3
    v_mov_b32_dpp v223, v11 row_ror:8 row_mask:0xf bank_mask:0x3
    v_mov_b32_dpp v8, v12 row_ror:8 row_mask:0xf bank_mask:0xc
    v_mov_b32_dpp v9, v13 row_ror:8 row_mask:0xf bank_mask:0xc
    v_mov_b32_dpp v10, v14 row_ror:8 row_mask:0xf bank_mask:0xc
    v_mov_b32_dpp v11, v15 row_ror:8 row_mask:0xf bank_mask:0xc
    s_mov_b32 s40, 688128
    s_mov_b32 s41, 745472
    buffer_store_dwordx4 v[8:11], v5, s[12:15], s40 offen sc1
    buffer_store_dwordx4 v[220:223], v5, s[12:15], s41 offen sc1
    v_pk_mul_f32 v[24:25], v[56:57], v[54:55] op_sel:[0,1] op_sel_hi:[1,1]
    v_pk_mul_f32 v[26:27], v[58:59], v[54:55] op_sel:[0,1] op_sel_hi:[1,1]
    v_pk_fma_f32 v[204:205], v[204:205], v[54:55], v[24:25] op_sel:[0,0,0] op_sel_hi:[1,0,1]
    v_pk_fma_f32 v[206:207], v[206:207], v[54:55], v[26:27] op_sel:[0,0,0] op_sel_hi:[1,0,1]
    v_exp_f32 v24, v204
    v_exp_f32 v25, v205
    v_exp_f32 v26, v206
    v_exp_f32 v27, v207
    v_pk_fma_f32 v[24:25], v[24:25], s[46:47], s[46:47]
    v_pk_fma_f32 v[26:27], v[26:27], s[46:47], s[46:47]
    v_rcp_f32 v24, v24
    v_rcp_f32 v25, v25
    v_rcp_f32 v26, v26
    v_rcp_f32 v27, v27
    v_pk_mul_f32 v[24:25], v[204:205], v[24:25]
    v_pk_mul_f32 v[26:27], v[206:207], v[26:27]
    v_pk_mul_f32 v[28:29], v[60:61], v[54:55] op_sel:[0,1] op_sel_hi:[1,1]
    v_pk_mul_f32 v[30:31], v[62:63], v[54:55] op_sel:[0,1] op_sel_hi:[1,1]
    v_pk_fma_f32 v[208:209], v[208:209], v[54:55], v[28:29] op_sel:[0,0,0] op_sel_hi:[1,0,1]
    v_pk_fma_f32 v[210:211], v[210:211], v[54:55], v[30:31] op_sel:[0,0,0] op_sel_hi:[1,0,1]
    v_exp_f32 v28, v208
    v_exp_f32 v29, v209
    v_exp_f32 v30, v210
    v_exp_f32 v31, v211
    v_pk_fma_f32 v[28:29], v[28:29], s[46:47], s[46:47]
    v_pk_fma_f32 v[30:31], v[30:31], s[46:47], s[46:47]
    v_rcp_f32 v28, v28
    v_rcp_f32 v29, v29
    v_rcp_f32 v30, v30
    v_rcp_f32 v31, v31
    v_pk_mul_f32 v[28:29], v[208:209], v[28:29]
    v_pk_mul_f32 v[30:31], v[210:211], v[30:31]
    v_cvt_pk_bf16_f32 v16, v24, v25
    v_cvt_pk_bf16_f32 v17, v26, v27
    v_cvt_pk_bf16_f32 v18, v28, v29
    v_cvt_pk_bf16_f32 v19, v30, v31
    s_nop 0
    v_permlane16_swap_b32 v16, v18
    v_permlane16_swap_b32 v17, v19
    v_pk_mul_f32 v[32:33], v[64:65], v[54:55] op_sel:[0,1] op_sel_hi:[1,1]
    v_pk_mul_f32 v[34:35], v[66:67], v[54:55] op_sel:[0,1] op_sel_hi:[1,1]
    v_pk_fma_f32 v[212:213], v[212:213], v[54:55], v[32:33] op_sel:[0,0,0] op_sel_hi:[1,0,1]
    v_pk_fma_f32 v[214:215], v[214:215], v[54:55], v[34:35] op_sel:[0,0,0] op_sel_hi:[1,0,1]
    v_exp_f32 v32, v212
    v_exp_f32 v33, v213
    v_exp_f32 v34, v214
    v_exp_f32 v35, v215
    v_pk_fma_f32 v[32:33], v[32:33], s[46:47], s[46:47]
    v_pk_fma_f32 v[34:35], v[34:35], s[46:47], s[46:47]
    v_rcp_f32 v32, v32
    v_rcp_f32 v33, v33
    v_rcp_f32 v34, v34
    v_rcp_f32 v35, v35
    v_pk_mul_f32 v[32:33], v[212:213], v[32:33]
    v_pk_mul_f32 v[34:35], v[214:215], v[34:35]
    v_pk_mul_f32 v[36:37], v[68:69], v[54:55] op_sel:[0,1] op_sel_hi:[1,1]
    v_pk_mul_f32 v[38:39], v[70:71], v[54:55] op_sel:[0,1] op_sel_hi:[1,1]
    v_pk_fma_f32 v[216:217], v[216:217], v[54:55], v[36:37] op_sel:[0,0,0] op_sel_hi:[1,0,1]
    v_pk_fma_f32 v[218:219], v[218:219], v[54:55], v[38:39] op_sel:[0,0,0] op_sel_hi:[1,0,1]
    v_exp_f32 v36, v216
    v_exp_f32 v37, v217
    v_exp_f32 v38, v218
    v_exp_f32 v39, v219
    v_pk_fma_f32 v[36:37], v[36:37], s[46:47], s[46:47]
    v_pk_fma_f32 v[38:39], v[38:39], s[46:47], s[46:47]
    v_rcp_f32 v36, v36
    v_rcp_f32 v37, v37
    v_rcp_f32 v38, v38
    v_rcp_f32 v39, v39
    v_pk_mul_f32 v[36:37], v[216:217], v[36:37]
    v_pk_mul_f32 v[38:39], v[218:219], v[38:39]
    v_cvt_pk_bf16_f32 v20, v32, v33
    v_cvt_pk_bf16_f32 v21, v34, v35
    v_cvt_pk_bf16_f32 v22, v36, v37
    v_cvt_pk_bf16_f32 v23, v38, v39
    s_nop 0
    v_permlane16_swap_b32 v20, v22
    v_permlane16_swap_b32 v21, v23
    v_mov_b32 v224, v20
    v_mov_b32 v225, v21
    v_mov_b32 v226, v22
    v_mov_b32 v227, v23
    v_mov_b32_dpp v224, v16 row_ror:8 row_mask:0xf bank_mask:0x3
    v_mov_b32_dpp v225, v17 row_ror:8 row_mask:0xf bank_mask:0x3
    v_mov_b32_dpp v226, v18 row_ror:8 row_mask:0xf bank_mask:0x3
    v_mov_b32_dpp v227, v19 row_ror:8 row_mask:0xf bank_mask:0x3
    v_mov_b32_dpp v16, v20 row_ror:8 row_mask:0xf bank_mask:0xc
    v_mov_b32_dpp v17, v21 row_ror:8 row_mask:0xf bank_mask:0xc
    v_mov_b32_dpp v18, v22 row_ror:8 row_mask:0xf bank_mask:0xc
    v_mov_b32_dpp v19, v23 row_ror:8 row_mask:0xf bank_mask:0xc
    s_mov_b32 s40, 802816
    s_mov_b32 s41, 860160
    buffer_store_dwordx4 v[16:19], v5, s[12:15], s40 offen sc1
    buffer_store_dwordx4 v[224:227], v5, s[12:15], s41 offen sc1
L_g1end_g1:
    s_branch L_g2_entry
L_oolb1_g1:
    s_waitcnt vmcnt(0)
    s_barrier
    s_cmp_lg_u32 s20, 0
    s_cbranch_scc1 L_nosigb_g1
    s_add_u32 s96, s84, 0x2c30000
    s_addc_u32 s97, s85, 0
    s_and_b32 s97, s97, 0xffff
    s_mov_b32 s98, 0x3000
    s_mov_b32 s99, 0x20000
    s_lshr_b32 s40, s2, 3
    s_lshl_b32 s40, s40, 7
    s_and_b32 s41, s2, 7
    s_lshl_b32 s41, s41, 2
    s_add_u32 s40, s40, s41
    s_add_u32 s40, s40, 4096
    v_mov_b32 v2, s40
    v_mov_b32 v3, 1
    s_mov_b64 exec, 1
    buffer_store_dword v3, v2, s[96:99], 0 offen sc1
    s_mov_b64 exec, -1
L_nosigb_g1:
    s_branch L_retb1_g1
L_loader_g1:
    s_sub_u32 s35, s20, 4
    s_mov_b32 s4, s80
    s_and_b32 s5, s81, 0xffff
    s_mov_b32 s6, 0x400000
    s_mov_b32 s7, 0x20000
    s_mov_b32 s8, s82
    s_and_b32 s9, s83, 0xffff
    s_mov_b32 s10, 0x700000
    s_mov_b32 s11, 0x20000
    s_lshl_b32 s28, s76, 7
    s_mul_i32 s29, s76, 458752
    s_mul_i32 s30, s35, 4096
    s_mul_i32 s31, s35, 8192
    s_add_u32 s31, s31, 16384
    s_mov_b32 s33, 0
    s_add_u32 s28, s28, 128
    s_add_u32 s29, s29, 458752
    s_cmp_eq_u32 s28, 2048
    s_cselect_b32 s28, 0, s28
    s_cselect_b32 s29, 0, s29
    s_add_u32 s33, s33, 1
    s_cmp_eq_u32 s33, 3
    s_cselect_b32 s42, s44, s43
    s_cselect_b32 s33, 0, s33
    s_add_u32 s30, s30, s42
    s_add_u32 s31, s31, s42
    s_add_u32 m0, s30, 0
    s_nop 0
    buffer_load_dwordx4 v240, s[4:7], s28 offen lds
    s_add_u32 m0, s30, 1024
    s_nop 0
    buffer_load_dwordx4 v241, s[4:7], s28 offen lds
    s_add_u32 m0, s30, 2048
    s_nop 0
    buffer_load_dwordx4 v242, s[4:7], s28 offen lds
    s_add_u32 m0, s30, 3072
    s_nop 0
    buffer_load_dwordx4 v243, s[4:7], s28 offen lds
    s_add_u32 m0, s31, 0
    s_nop 0
    buffer_load_dwordx4 v244, s[8:11], s29 offen lds
    s_add_u32 m0, s31, 1024
    s_nop 0
    buffer_load_dwordx4 v245, s[8:11], s29 offen lds
    s_add_u32 m0, s31, 2048
    s_nop 0
    buffer_load_dwordx4 v246, s[8:11], s29 offen lds
    s_add_u32 m0, s31, 3072
    s_nop 0
    buffer_load_dwordx4 v247, s[8:11], s29 offen lds
    s_add_u32 m0, s31, 4096
    s_nop 0
    buffer_load_dwordx4 v248, s[8:11], s29 offen lds
    s_add_u32 m0, s31, 5120
    s_nop 0
    buffer_load_dwordx4 v249, s[8:11], s29 offen lds
    s_add_u32 m0, s31, 6144
    s_nop 0
    buffer_load_dwordx4 v250, s[8:11], s29 offen lds
    s_add_u32 m0, s31, 7168
    s_nop 0
    buffer_load_dwordx4 v251, s[8:11], s29 offen lds
    s_add_u32 s28, s28, 128
    s_add_u32 s29, s29, 458752
    s_cmp_eq_u32 s28, 2048
    s_cselect_b32 s28, 0, s28
    s_cselect_b32 s29, 0, s29
    s_add_u32 s33, s33, 1
    s_cmp_eq_u32 s33, 3
    s_cselect_b32 s42, s44, s43
    s_cselect_b32 s33, 0, s33
    s_add_u32 s30, s30, s42
    s_add_u32 s31, s31, s42
    s_lshl_b32 s66, s2, 2
    s_add_u32 s66, s66, s35
    v_lshlrev_b32 v6, 6, v0
    v_mov_b32 v7, 0
    s_add_u32 s72, s84, 0x2c10000
    s_addc_u32 s73, s85, 0
    s_and_b32 s73, s73, 0xffff
    s_mov_b32 s74, 0x10000
    s_mov_b32 s75, 0x20000
    s_mov_b32 s68, s88
    s_and_b32 s69, s89, 0xffff
    s_mov_b32 s70, 0x700000
    s_mov_b32 s71, 0x20000
    s_add_u32 s48, s84, 0x1200000
    s_addc_u32 s49, s85, 0
    s_and_b32 s49, s49, 0xffff
    s_mov_b32 s50, 0x426300
    s_mov_b32 s51, 0x20000
    s_add_u32 s52, s84, 0x2c40000
    s_addc_u32 s53, s85, 0
    s_and_b32 s53, s53, 0xffff
    s_mov_b32 s54, 0x38000
    s_mov_b32 s55, 0x20000
    v_and_b32 v8, 1, v0
    v_mul_u32_u24 v8, 8448, v8
    v_lshrrev_b32 v9, 1, v0
    v_lshl_add_u32 v8, v9, 4, v8
    v_and_b32 v10, 15, v0
    v_lshlrev_b32 v10, 4, v10
    v_lshrrev_b32 v9, 4, v0
    v_mul_u32_u24 v9, 14336, v9
    v_add_u32 v9, v9, v10
    s_lshl_b32 s40, s35, 8
    s_add_u32 s40, s40, 148480
    v_add_u32 v10, s40, v10
    s_add_u32 s96, s84, 0x2c30000
    s_addc_u32 s97, s85, 0
    s_and_b32 s97, s97, 0xffff
    s_mov_b32 s98, 0x3000
    s_mov_b32 s99, 0x20000
    v_and_b32 v12, 15, v0
    s_lshr_b32 s40, s76, 1
    s_lshl_b32 s40, s40, 1
    v_lshrrev_b32 v11, 3, v12
    v_add_u32 v11, s40, v11
    v_lshlrev_b32 v11, 7, v11
    v_and_b32 v13, 7, v0
    v_lshl_add_u32 v11, v13, 2, v11
    s_lshr_b32 s40, s2, 5
    s_lshl_b32 s40, s40, 9
    s_and_b32 s41, s2, 4
    s_lshl_b32 s41, s41, 2
    s_add_u32 s40, s40, s41
    s_add_u32 s40, s40, 4096
    v_and_b32 v13, 3, v12
    v_lshlrev_b32 v13, 7, v13
    v_add_u32 v13, s40, v13
    v_lshrrev_b32 v12, 2, v12
    v_lshl_add_u32 v13, v12, 2, v13
    v_and_b32 v12, 16, v0
    v_cmp_eq_u32 vcc, 0, v12
    s_nop 1
    v_cndmask_b32 v11, v13, v11, vcc
    v_mov_b32 v12, 0
    s_mov_b32 s32, 0
L_load_g1:
    s_cmp_le_u32 s32, 9
    s_cbranch_scc1 L_wa_g1
    s_cmp_eq_u32 s32, 10
    s_cbranch_scc1 L_wb_g1
    s_cmp_gt_u32 s32, 12
    s_cbranch_scc1 L_wa_g1
    s_waitcnt vmcnt(17)
    s_branch L_wd_g1
L_wb_g1:
    s_waitcnt vmcnt(13)
    s_branch L_wd_g1
L_wa_g1:
    s_waitcnt vmcnt(12)
L_wd_g1:
    s_barrier
    s_add_u32 m0, s30, 0
    s_nop 0
    buffer_load_dwordx4 v240, s[4:7], s28 offen lds
    s_add_u32 m0, s30, 1024
    s_nop 0
    buffer_load_dwordx4 v241, s[4:7], s28 offen lds
    s_add_u32 m0, s30, 2048
    s_nop 0
    buffer_load_dwordx4 v242, s[4:7], s28 offen lds
    s_add_u32 m0, s30, 3072
    s_nop 0
    buffer_load_dwordx4 v243, s[4:7], s28 offen lds
    s_add_u32 m0, s31, 0
    s_nop 0
    buffer_load_dwordx4 v244, s[8:11], s29 offen lds
    s_add_u32 m0, s31, 1024
    s_nop 0
    buffer_load_dwordx4 v245, s[8:11], s29 offen lds
    s_add_u32 m0, s31, 2048
    s_nop 0
    buffer_load_dwordx4 v246, s[8:11], s29 offen lds
    s_add_u32 m0, s31, 3072
    s_nop 0
    buffer_load_dwordx4 v247, s[8:11], s29 offen lds
    s_add_u32 m0, s31, 4096
    s_nop 0
    buffer_load_dwordx4 v248, s[8:11], s29 offen lds
    s_add_u32 m0, s31, 5120
    s_nop 0
    buffer_load_dwordx4 v249, s[8:11], s29 offen lds
    s_add_u32 m0, s31, 6144
    s_nop 0
    buffer_load_dwordx4 v250, s[8:11], s29 offen lds
    s_add_u32 m0, s31, 7168
    s_nop 0
    buffer_load_dwordx4 v251, s[8:11], s29 offen lds
    s_add_u32 s28, s28, 128
    s_add_u32 s29, s29, 458752
    s_cmp_eq_u32 s28, 2048
    s_cselect_b32 s28, 0, s28
    s_cselect_b32 s29, 0, s29
    s_add_u32 s33, s33, 1
    s_cmp_eq_u32 s33, 3
    s_cselect_b32 s42, s44, s43
    s_cselect_b32 s33, 0, s33
    s_add_u32 s30, s30, s42
    s_add_u32 s31, s31, s42
    s_cmp_lg_u32 s32, 9
    s_cbranch_scc1 L_nop1_g1
    buffer_load_dword v12, v11, s[96:99], 0 offen sc1
L_nop1_g1:
    s_cmp_lg_u32 s32, 10
    s_cbranch_scc1 L_nop2_g1
    s_waitcnt vmcnt(12)
    s_mov_b32 s42, 0
    s_branch L_pc_g1
L_poll_g1:
    s_sleep 16
    buffer_load_dword v12, v11, s[96:99], 0 offen sc1
    s_waitcnt vmcnt(0)
L_pc_g1:
    v_cmp_eq_u32 vcc, 1, v12
    s_cmp_eq_u64 vcc, -1
    s_cbranch_scc1 L_pollok_g1
    s_add_u32 s42, s42, 1
    s_cmp_lt_u32 s42, 0x8000
    s_cbranch_scc1 L_poll_g1
L_pollok_g1:
    s_lshl_b32 s40, s76, 1
    s_lshr_b32 s41, s35, 1
    s_add_u32 s40, s40, s41
    s_lshr_b32 s41, s40, 3
    s_and_b32 s42, s35, 1
    s_lshl_b32 s42, s42, 2
    s_add_u32 s41, s41, s42
    s_lshl_b32 s41, s41, 6
    s_lshr_b32 s42, s40, 2
    s_and_b32 s42, s42, 1
    s_lshl_b32 s42, s42, 5
    s_add_u32 s41, s41, s42
    s_lshl_b32 s41, s41, 4
    s_and_b32 s40, s40, 3
    s_lshl_b32 s40, s40, 2
    s_add_u32 s41, s41, s40
    s_add_u32 s41, s41, 4333824
    s_lshl_b32 s40, s35, 8
    s_add_u32 m0, s40, 147456
    s_nop 0
    buffer_load_dword v8, s[48:51], s41 offen sc1 lds
    s_lshl_b32 s41, s77, 10
    s_lshl_b32 s40, s35, 8
    s_add_u32 s41, s41, s40
    buffer_load_dwordx4 v[16:19], v9, s[52:55], s41 offen sc1
    s_add_u32 s41, s41, 57344
    buffer_load_dwordx4 v[20:23], v9, s[52:55], s41 offen sc1
    s_add_u32 s41, s41, 57344
    buffer_load_dwordx4 v[24:27], v9, s[52:55], s41 offen sc1
    s_add_u32 s41, s41, 57344
    buffer_load_dwordx4 v[28:31], v9, s[52:55], s41 offen sc1
L_nop2_g1:
    s_add_u32 s32, s32, 1
    s_cmp_lt_u32 s32, 14
    s_cbranch_scc1 L_load_g1
    s_lshl_b32 s40, s66, 13
    buffer_load_dword v5, v6, s[68:71], s40 offen
    s_add_u32 s40, s40, 4096
    buffer_load_dword v5, v6, s[68:71], s40 offen
    s_waitcnt vmcnt(14)
    s_barrier
    v_pk_add_f32 v[16:17], v[16:17], v[20:21]
    v_pk_add_f32 v[18:19], v[18:19], v[22:23]
    v_pk_add_f32 v[24:25], v[24:25], v[28:29]
    v_pk_add_f32 v[26:27], v[26:27], v[30:31]
    v_pk_add_f32 v[16:17], v[16:17], v[24:25]
    v_pk_add_f32 v[18:19], v[18:19], v[26:27]
    v_mov_b32 v32, v16
    v_mov_b32 v33, v17
    v_mov_b32 v34, v18
    v_mov_b32 v35, v19
    v_permlane32_swap_b32 v16, v32
    v_permlane32_swap_b32 v17, v33
    v_permlane32_swap_b32 v18, v34
    v_permlane32_swap_b32 v19, v35
    v_pk_add_f32 v[16:17], v[16:17], v[32:33]
    v_pk_add_f32 v[18:19], v[18:19], v[34:35]
    v_mov_b32 v32, v16
    v_mov_b32 v33, v17
    v_mov_b32 v34, v18
    v_mov_b32 v35, v19
    v_permlane16_swap_b32 v16, v32
    v_permlane16_swap_b32 v17, v33
    v_permlane16_swap_b32 v18, v34
    v_permlane16_swap_b32 v19, v35
    v_pk_add_f32 v[16:17], v[16:17], v[32:33]
    v_pk_add_f32 v[18:19], v[18:19], v[34:35]
    s_mov_b64 exec, 0xffff
    ds_write_b128 v10, v[16:19]
    s_mov_b64 exec, -1
    s_waitcnt lgkmcnt(0)
    s_waitcnt vmcnt(2)
    s_barrier
    s_branch L_g2_entry
L_col_role:
    s_sub_u32 s3, s2, 224
    s_load_dwordx4 s[16:19], s[0:1], 8
    s_and_b32 s21, s2, 7
    s_lshr_b32 s22, s2, 3
    s_and_b32 s22, s22, 15
    s_and_b32 s24, s21, 3
    s_lshl_b32 s24, s24, 1
    s_and_b32 s25, s22, 1
    s_add_u32 s24, s24, s25
    s_lshr_b32 s23, s21, 2
    s_lshl_b32 s23, s23, 3
    s_lshr_b32 s25, s22, 1
    s_add_u32 s23, s23, s25
    s_lshl_b32 s25, s23, 2
    s_and_b32 s26, s20, 3
    s_add_u32 s25, s25, s26
    s_lshl_b32 s25, s25, 5
    s_lshl_b32 s26, s24, 2
    s_add_u32 s25, s25, s26
    s_lshr_b32 s26, s20, 2
    s_add_u32 s25, s25, s26
    s_mul_i32 s26, s25, 1026
    s_add_u32 s27, s26, 2052
    s_lshr_b32 s28, s23, 1
    s_lshl_b32 s28, s28, 6
    s_and_b32 s29, s23, 1
    s_lshl_b32 s29, s29, 5
    s_add_u32 s28, s28, s29
    s_lshl_b32 s29, s24, 2
    s_add_u32 s28, s28, s29
    s_lshl_b32 s28, s28, 4
    v_lshlrev_b32 v1, 4, v0
    v_mov_b32 v3, 1024
    s_and_b32 s34, s2, 127
    s_waitcnt lgkmcnt(0)
    s_mov_b32 s4, s16
    s_and_b32 s5, s17, 0xffff
    s_mov_b32 s6, 0x201000
    s_mov_b32 s7, 0x20000
    s_mov_b32 s8, s18
    s_and_b32 s9, s19, 0xffff
    s_mov_b32 s10, 0x201000
    s_mov_b32 s11, 0x20000
    v_mov_b32 v8, 0
    v_mov_b32 v9, 0
    v_mov_b32 v10, 0
    v_mov_b32 v11, 0
    v_lshrrev_b32 v12, 1, v0
    v_lshlrev_b32 v12, 7, v12
    v_and_b32 v13, 1, v0
    v_lshl_add_u32 v12, v13, 4, v12
    s_add_u32 s96, s84, 0x2c30000
    s_addc_u32 s97, s85, 0
    s_and_b32 s97, s97, 0xffff
    s_mov_b32 s98, 0x3000
    s_mov_b32 s99, 0x20000
    s_mov_b32 s92, s86
    s_and_b32 s93, s87, 0xffff
    s_mov_b32 s94, 0x100
    s_mov_b32 s95, 0x20000
    s_cmp_ge_u32 s2, 240
    s_cbranch_scc1 L_nofz_wc
    s_cmp_lg_u32 s20, 1
    s_cbranch_scc1 L_nofz_wc
    s_add_u32 s44, s84, 0x2c10000
    s_addc_u32 s45, s85, 0
    s_and_b32 s45, s45, 0xffff
    s_mov_b32 s46, 0x10000
    s_mov_b32 s47, 0x20000
    v_lshlrev_b32 v12, 6, v0
    s_sub_u32 s40, s2, 224
    s_lshl_b32 s40, s40, 12
    buffer_store_dword v8, v12, s[44:47], s40 offen sc1
L_nofz_wc:
    s_cmp_lg_u32 s2, 240
    s_cbranch_scc1 L_noclr_wc
    s_cmp_lg_u32 s20, 7
    s_cbranch_scc1 L_noclr_wc
    buffer_store_dwordx4 v[8:11], v12, s[96:99], 0 offen sc1
    s_mov_b32 s40, 4096
    buffer_store_dwordx4 v[8:11], v12, s[96:99], s40 offen sc1
    s_mov_b32 s40, 8192
    buffer_store_dwordx4 v[8:11], v12, s[96:99], s40 offen sc1
L_noclr_wc:
    v_mov_b32 v2, 0
    buffer_load_dwordx4 v[16:19], v1, s[4:7], s26 offen nt
    buffer_load_dwordx4 v[24:27], v1, s[8:11], s26 offen nt
    buffer_load_ushort v32, v3, s[4:7], s26 offen
    buffer_load_ushort v33, v3, s[8:11], s26 offen
    buffer_load_dwordx4 v[20:23], v1, s[4:7], s27 offen nt
    buffer_load_dwordx4 v[28:31], v1, s[8:11], s27 offen nt
    buffer_load_ushort v34, v3, s[4:7], s27 offen
    buffer_load_ushort v35, v3, s[8:11], s27 offen
    s_mov_b32 s36, s82
    s_and_b32 s37, s83, 0xffff
    s_mov_b32 s38, 0x700000
    s_mov_b32 s39, 0x20000
    s_lshl_b32 s35, s34, 3
    s_add_u32 s35, s35, s20
    s_lshl_b32 s35, s35, 13
    v_lshlrev_b32 v2, 6, v0
    s_add_u32 s12, s84, 0x1680000
    s_addc_u32 s13, s85, 0
    s_and_b32 s13, s13, 0xffff
    s_mov_b32 s14, 0x422100
    s_mov_b32 s15, 0x20000
    v_mul_u32_u24 v4, 584, v0
    s_lshl_b32 s31, s20, 2
    s_add_u32 s31, s31, 98304
    v_add_u32 v4, s31, v4
    s_mov_b32 s29, 0x05040100
    s_mov_b32 s30, 0x07060302
    s_cmp_lg_u32 s2, 255
    s_cbranch_scc1 L_notab_wc
    s_cmp_lg_u32 s20, 7
    s_cbranch_scc1 L_notab_wc
    v_and_b32 v132, 31, v0
    v_lshrrev_b32 v133, 2, v132
    v_and_b32 v133, 1, v133
    v_lshlrev_b32 v133, 4, v133
    v_lshrrev_b32 v134, 3, v132
    v_lshl_add_u32 v133, v134, 2, v133
    v_and_b32 v134, 3, v132
    v_add_u32 v133, v133, v134
    v_cvt_f32_u32 v133, v133
    v_mul_f32 v140, 0x3d000000, v133
    v_mul_f32 v141, 0x3a800000, v133
    v_lshrrev_b32 v142, 5, v0
    v_cvt_f32_u32 v142, v142
    v_mul_f32 v142, 0x40800000, v142
    v_mov_b32 v143, 0x0
    v_fma_f32 v132, v142, v140, v143
    v_fract_f32 v132, v132
    v_sin_f32 v134, v132
    v_cos_f32 v133, v132
    s_nop 0
    v_cvt_pk_bf16_f32 v68, v133, v134
    v_add_f32 v132, 0x3f800000, v142
    v_fma_f32 v132, v132, v140, v143
    v_fract_f32 v132, v132
    v_sin_f32 v134, v132
    v_cos_f32 v133, v132
    s_nop 0
    v_cvt_pk_bf16_f32 v69, v133, v134
    v_add_f32 v132, 0x40000000, v142
    v_fma_f32 v132, v132, v140, v143
    v_fract_f32 v132, v132
    v_sin_f32 v134, v132
    v_cos_f32 v133, v132
    s_nop 0
    v_cvt_pk_bf16_f32 v70, v133, v134
    v_add_f32 v132, 0x40400000, v142
    v_fma_f32 v132, v132, v140, v143
    v_fract_f32 v132, v132
    v_sin_f32 v134, v132
    v_cos_f32 v133, v132
    s_nop 0
    v_cvt_pk_bf16_f32 v71, v133, v134
    v_add_f32 v132, 0x41000000, v142
    v_fma_f32 v132, v132, v140, v143
    v_fract_f32 v132, v132
    v_sin_f32 v134, v132
    v_cos_f32 v133, v132
    s_nop 0
    v_cvt_pk_bf16_f32 v72, v133, v134
    v_add_f32 v132, 0x41100000, v142
    v_fma_f32 v132, v132, v140, v143
    v_fract_f32 v132, v132
    v_sin_f32 v134, v132
    v_cos_f32 v133, v132
    s_nop 0
    v_cvt_pk_bf16_f32 v73, v133, v134
    v_add_f32 v132, 0x41200000, v142
    v_fma_f32 v132, v132, v140, v143
    v_fract_f32 v132, v132
    v_sin_f32 v134, v132
    v_cos_f32 v133, v132
    s_nop 0
    v_cvt_pk_bf16_f32 v74, v133, v134
    v_add_f32 v132, 0x41300000, v142
    v_fma_f32 v132, v132, v140, v143
    v_fract_f32 v132, v132
    v_sin_f32 v134, v132
    v_cos_f32 v133, v132
    s_nop 0
    v_cvt_pk_bf16_f32 v75, v133, v134
    v_mov_b32 v143, 0x3e800000
    v_fma_f32 v132, v142, v140, v143
    v_fract_f32 v132, v132
    v_sin_f32 v134, v132
    v_cos_f32 v133, v132
    s_nop 0
    v_cvt_pk_bf16_f32 v76, v133, v134
    v_add_f32 v132, 0x3f800000, v142
    v_fma_f32 v132, v132, v140, v143
    v_fract_f32 v132, v132
    v_sin_f32 v134, v132
    v_cos_f32 v133, v132
    s_nop 0
    v_cvt_pk_bf16_f32 v77, v133, v134
    v_add_f32 v132, 0x40000000, v142
    v_fma_f32 v132, v132, v140, v143
    v_fract_f32 v132, v132
    v_sin_f32 v134, v132
    v_cos_f32 v133, v132
    s_nop 0
    v_cvt_pk_bf16_f32 v78, v133, v134
    v_add_f32 v132, 0x40400000, v142
    v_fma_f32 v132, v132, v140, v143
    v_fract_f32 v132, v132
    v_sin_f32 v134, v132
    v_cos_f32 v133, v132
    s_nop 0
    v_cvt_pk_bf16_f32 v79, v133, v134
    v_add_f32 v132, 0x41000000, v142
    v_fma_f32 v132, v132, v140, v143
    v_fract_f32 v132, v132
    v_sin_f32 v134, v132
    v_cos_f32 v133, v132
    s_nop 0
    v_cvt_pk_bf16_f32 v80, v133, v134
    v_add_f32 v132, 0x41100000, v142
    v_fma_f32 v132, v132, v140, v143
    v_fract_f32 v132, v132
    v_sin_f32 v134, v132
    v_cos_f32 v133, v132
    s_nop 0
    v_cvt_pk_bf16_f32 v81, v133, v134
    v_add_f32 v132, 0x41200000, v142
    v_fma_f32 v132, v132, v140, v143
    v_fract_f32 v132, v132
    v_sin_f32 v134, v132
    v_cos_f32 v133, v132
    s_nop 0
    v_cvt_pk_bf16_f32 v82, v133, v134
    v_add_f32 v132, 0x41300000, v142
    v_fma_f32 v132, v132, v140, v143
    v_fract_f32 v132, v132
    v_sin_f32 v134, v132
    v_cos_f32 v133, v132
    s_nop 0
    v_cvt_pk_bf16_f32 v83, v133, v134
    v_mul_f32 v132, v142, v141
    v_fract_f32 v132, v132
    v_sin_f32 v100, v132
    v_cos_f32 v84, v132
    v_add_f32 v132, 0x3f800000, v142
    v_mul_f32 v132, v132, v141
    v_fract_f32 v132, v132
    v_sin_f32 v101, v132
    v_cos_f32 v85, v132
    v_add_f32 v132, 0x40000000, v142
    v_mul_f32 v132, v132, v141
    v_fract_f32 v132, v132
    v_sin_f32 v102, v132
    v_cos_f32 v86, v132
    v_add_f32 v132, 0x40400000, v142
    v_mul_f32 v132, v132, v141
    v_fract_f32 v132, v132
    v_sin_f32 v103, v132
    v_cos_f32 v87, v132
    v_add_f32 v132, 0x41000000, v142
    v_mul_f32 v132, v132, v141
    v_fract_f32 v132, v132
    v_sin_f32 v104, v132
    v_cos_f32 v88, v132
    v_add_f32 v132, 0x41100000, v142
    v_mul_f32 v132, v132, v141
    v_fract_f32 v132, v132
    v_sin_f32 v105, v132
    v_cos_f32 v89, v132
    v_add_f32 v132, 0x41200000, v142
    v_mul_f32 v132, v132, v141
    v_fract_f32 v132, v132
    v_sin_f32 v106, v132
    v_cos_f32 v90, v132
    v_add_f32 v132, 0x41300000, v142
    v_mul_f32 v132, v132, v141
    v_fract_f32 v132, v132
    v_sin_f32 v107, v132
    v_cos_f32 v91, v132
    v_add_f32 v132, 0x41800000, v142
    v_mul_f32 v132, v132, v141
    v_fract_f32 v132, v132
    v_sin_f32 v108, v132
    v_cos_f32 v92, v132
    v_add_f32 v132, 0x41880000, v142
    v_mul_f32 v132, v132, v141
    v_fract_f32 v132, v132
    v_sin_f32 v109, v132
    v_cos_f32 v93, v132
    v_add_f32 v132, 0x41900000, v142
    v_mul_f32 v132, v132, v141
    v_fract_f32 v132, v132
    v_sin_f32 v110, v132
    v_cos_f32 v94, v132
    v_add_f32 v132, 0x41980000, v142
    v_mul_f32 v132, v132, v141
    v_fract_f32 v132, v132
    v_sin_f32 v111, v132
    v_cos_f32 v95, v132
    v_add_f32 v132, 0x41c00000, v142
    v_mul_f32 v132, v132, v141
    v_fract_f32 v132, v132
    v_sin_f32 v112, v132
    v_cos_f32 v96, v132
    v_add_f32 v132, 0x41c80000, v142
    v_mul_f32 v132, v132, v141
    v_fract_f32 v132, v132
    v_sin_f32 v113, v132
    v_cos_f32 v97, v132
    v_add_f32 v132, 0x41d00000, v142
    v_mul_f32 v132, v132, v141
    v_fract_f32 v132, v132
    v_sin_f32 v114, v132
    v_cos_f32 v98, v132
    v_add_f32 v132, 0x41d80000, v142
    v_mul_f32 v132, v132, v141
    v_fract_f32 v132, v132
    v_sin_f32 v115, v132
    v_cos_f32 v99, v132
    v_and_b32 v132, 31, v0
    v_cvt_f32_u32 v132, v132
    v_mul_f32 v140, 0x3d000000, v132
    v_mul_f32 v132, v142, v140
    v_fract_f32 v132, v132
    v_sin_f32 v134, v132
    v_cos_f32 v133, v132
    s_nop 0
    v_cvt_pk_bf16_f32 v116, v133, v134
    v_add_f32 v132, 0x3f800000, v142
    v_mul_f32 v132, v132, v140
    v_fract_f32 v132, v132
    v_sin_f32 v134, v132
    v_cos_f32 v133, v132
    s_nop 0
    v_cvt_pk_bf16_f32 v117, v133, v134
    v_add_f32 v132, 0x40000000, v142
    v_mul_f32 v132, v132, v140
    v_fract_f32 v132, v132
    v_sin_f32 v134, v132
    v_cos_f32 v133, v132
    s_nop 0
    v_cvt_pk_bf16_f32 v118, v133, v134
    v_add_f32 v132, 0x40400000, v142
    v_mul_f32 v132, v132, v140
    v_fract_f32 v132, v132
    v_sin_f32 v134, v132
    v_cos_f32 v133, v132
    s_nop 0
    v_cvt_pk_bf16_f32 v119, v133, v134
    v_add_f32 v132, 0x41000000, v142
    v_mul_f32 v132, v132, v140
    v_fract_f32 v132, v132
    v_sin_f32 v134, v132
    v_cos_f32 v133, v132
    s_nop 0
    v_cvt_pk_bf16_f32 v120, v133, v134
    v_add_f32 v132, 0x41100000, v142
    v_mul_f32 v132, v132, v140
    v_fract_f32 v132, v132
    v_sin_f32 v134, v132
    v_cos_f32 v133, v132
    s_nop 0
    v_cvt_pk_bf16_f32 v121, v133, v134
    v_add_f32 v132, 0x41200000, v142
    v_mul_f32 v132, v132, v140
    v_fract_f32 v132, v132
    v_sin_f32 v134, v132
    v_cos_f32 v133, v132
    s_nop 0
    v_cvt_pk_bf16_f32 v122, v133, v134
    v_add_f32 v132, 0x41300000, v142
    v_mul_f32 v132, v132, v140
    v_fract_f32 v132, v132
    v_sin_f32 v134, v132
    v_cos_f32 v133, v132
    s_nop 0
    v_cvt_pk_bf16_f32 v123, v133, v134
    v_add_f32 v132, 0x41800000, v142
    v_mul_f32 v132, v132, v140
    v_fract_f32 v132, v132
    v_sin_f32 v134, v132
    v_cos_f32 v133, v132
    s_nop 0
    v_cvt_pk_bf16_f32 v124, v133, v134
    v_add_f32 v132, 0x41880000, v142
    v_mul_f32 v132, v132, v140
    v_fract_f32 v132, v132
    v_sin_f32 v134, v132
    v_cos_f32 v133, v132
    s_nop 0
    v_cvt_pk_bf16_f32 v125, v133, v134
    v_add_f32 v132, 0x41900000, v142
    v_mul_f32 v132, v132, v140
    v_fract_f32 v132, v132
    v_sin_f32 v134, v132
    v_cos_f32 v133, v132
    s_nop 0
    v_cvt_pk_bf16_f32 v126, v133, v134
    v_add_f32 v132, 0x41980000, v142
    v_mul_f32 v132, v132, v140
    v_fract_f32 v132, v132
    v_sin_f32 v134, v132
    v_cos_f32 v133, v132
    s_nop 0
    v_cvt_pk_bf16_f32 v127, v133, v134
    v_add_f32 v132, 0x41c00000, v142
    v_mul_f32 v132, v132, v140
    v_fract_f32 v132, v132
    v_sin_f32 v134, v132
    v_cos_f32 v133, v132
    s_nop 0
    v_cvt_pk_bf16_f32 v128, v133, v134
    v_add_f32 v132, 0x41c80000, v142
    v_mul_f32 v132, v132, v140
    v_fract_f32 v132, v132
    v_sin_f32 v134, v132
    v_cos_f32 v133, v132
    s_nop 0
    v_cvt_pk_bf16_f32 v129, v133, v134
    v_add_f32 v132, 0x41d00000, v142
    v_mul_f32 v132, v132, v140
    v_fract_f32 v132, v132
    v_sin_f32 v134, v132
    v_cos_f32 v133, v132
    s_nop 0
    v_cvt_pk_bf16_f32 v130, v133, v134
    v_add_f32 v132, 0x41d80000, v142
    v_mul_f32 v132, v132, v140
    v_fract_f32 v132, v132
    v_sin_f32 v134, v132
    v_cos_f32 v133, v132
    s_nop 0
    v_cvt_pk_bf16_f32 v131, v133, v134
    s_add_u32 s44, s84, 0x2c00000
    s_addc_u32 s45, s85, 0
    s_and_b32 s45, s45, 0xffff
    s_mov_b32 s46, 0x4000
    s_mov_b32 s47, 0x20000
    v_lshlrev_b32 v144, 4, v0
    s_mov_b32 s40, 0
    buffer_store_dwordx4 v[68:71], v144, s[44:47], s40 offen offset:0 sc1
    buffer_store_dwordx4 v[72:75], v144, s[44:47], s40 offen offset:1024 sc1
    buffer_store_dwordx4 v[76:79], v144, s[44:47], s40 offen offset:2048 sc1
    buffer_store_dwordx4 v[80:83], v144, s[44:47], s40 offen offset:3072 sc1
    s_add_u32 s40, s40, 4096
    buffer_store_dwordx4 v[84:87], v144, s[44:47], s40 offen offset:0 sc1
    buffer_store_dwordx4 v[88:91], v144, s[44:47], s40 offen offset:1024 sc1
    buffer_store_dwordx4 v[92:95], v144, s[44:47], s40 offen offset:2048 sc1
    buffer_store_dwordx4 v[96:99], v144, s[44:47], s40 offen offset:3072 sc1
    s_add_u32 s40, s40, 4096
    buffer_store_dwordx4 v[100:103], v144, s[44:47], s40 offen offset:0 sc1
    buffer_store_dwordx4 v[104:107], v144, s[44:47], s40 offen offset:1024 sc1
    buffer_store_dwordx4 v[108:111], v144, s[44:47], s40 offen offset:2048 sc1
    buffer_store_dwordx4 v[112:115], v144, s[44:47], s40 offen offset:3072 sc1
    s_add_u32 s40, s40, 4096
    buffer_store_dwordx4 v[116:119], v144, s[44:47], s40 offen offset:0 sc1
    buffer_store_dwordx4 v[120:123], v144, s[44:47], s40 offen offset:1024 sc1
    buffer_store_dwordx4 v[124:127], v144, s[44:47], s40 offen offset:2048 sc1
    buffer_store_dwordx4 v[128:131], v144, s[44:47], s40 offen offset:3072 sc1
    s_waitcnt vmcnt(0)
L_notab_wc:
    s_waitcnt vmcnt(0)
    s_cmp_lg_u32 s2, 240
    s_cbranch_scc1 L_noopen_wc
    s_cmp_lg_u32 s20, 7
    s_cbranch_scc1 L_noopen_wc
    v_mov_b32 v12, 0
    v_mov_b32 v13, 1
    s_mov_b64 exec, 1
    buffer_store_dword v13, v12, s[92:95], 0 offen sc1
    s_mov_b64 exec, -1
L_noopen_wc:
    v_perm_b32 v52, v24, v16, s29
    v_perm_b32 v53, v24, v16, s30
    v_perm_b32 v54, v25, v17, s29
    v_perm_b32 v55, v25, v17, s30
    v_perm_b32 v56, v26, v18, s29
    v_perm_b32 v57, v26, v18, s30
    v_perm_b32 v58, v27, v19, s29
    v_perm_b32 v59, v27, v19, s30
    ds_write_b32 v4, v52 offset:0
    ds_write_b32 v4, v53 offset:72
    ds_write_b32 v4, v54 offset:144
    ds_write_b32 v4, v55 offset:216
    ds_write_b32 v4, v56 offset:288
    ds_write_b32 v4, v57 offset:360
    ds_write_b32 v4, v58 offset:432
    ds_write_b32 v4, v59 offset:504
    v_perm_b32 v60, v28, v20, s29
    v_perm_b32 v61, v28, v20, s30
    v_perm_b32 v62, v29, v21, s29
    v_perm_b32 v63, v29, v21, s30
    v_perm_b32 v64, v30, v22, s29
    v_perm_b32 v65, v30, v22, s30
    v_perm_b32 v66, v31, v23, s29
    v_perm_b32 v67, v31, v23, s30
    ds_write_b32 v4, v60 offset:32
    ds_write_b32 v4, v61 offset:104
    ds_write_b32 v4, v62 offset:176
    ds_write_b32 v4, v63 offset:248
    ds_write_b32 v4, v64 offset:320
    ds_write_b32 v4, v65 offset:392
    ds_write_b32 v4, v66 offset:464
    ds_write_b32 v4, v67 offset:536
    v_lshl_or_b32 v32, v33, 16, v32
    v_lshl_or_b32 v34, v35, 16, v34
    s_mov_b64 exec, 1
    v_mov_b32 v5, s31
    ds_write_b32 v5, v32 offset:37376
    ds_write_b32 v5, v34 offset:37408
    s_mov_b64 exec, -1
    s_waitcnt lgkmcnt(0)
    s_barrier
    v_mov_b32 v65, 1
    v_mov_b32 v64, 0
    s_cmp_lg_u32 s20, 0
    s_cbranch_scc1 L_colnogate
    s_mov_b32 s92, s86
    s_and_b32 s93, s87, 0xffff
    s_mov_b32 s94, 0x100
    s_mov_b32 s95, 0x20000
    v_mov_b32 v64, 0
    buffer_load_dword v65, v64, s[92:95], 0 offen sc1
L_colnogate:
    v_lshrrev_b32 v10, 2, v0
    v_and_b32 v11, 3, v0
    v_mul_u32_u24 v8, 72, v10
    v_lshrrev_b32 v9, 3, v10
    v_lshl_add_u32 v8, v9, 3, v8
    v_lshl_add_u32 v8, v11, 4, v8
    s_mul_i32 s40, s20, 1168
    s_add_u32 s40, s40, 98304
    v_add_u32 v8, s40, v8
    s_lshl_b32 s40, s20, 4
    v_add_u32 v9, s40, v10
    s_mov_b32 s41, 8448
    v_mul_lo_u32 v9, v9, s41
    v_lshl_add_u32 v9, v11, 4, v9
    ds_read_b64 v[12:13], v8 offset:0
    ds_read_b64 v[14:15], v8 offset:8
    ds_read_b64 v[16:17], v8 offset:9344
    ds_read_b64 v[18:19], v8 offset:9352
    ds_read_b64 v[20:21], v8 offset:18688
    ds_read_b64 v[22:23], v8 offset:18696
    ds_read_b64 v[24:25], v8 offset:28032
    ds_read_b64 v[26:27], v8 offset:28040
    s_cmp_lg_u32 s20, 0
    s_cbranch_scc1 L_no5_wc
    ds_read_b64 v[28:29], v8 offset:37376
    ds_read_b64 v[30:31], v8 offset:37384
    s_add_u32 s41, s28, 4325376
    s_waitcnt lgkmcnt(0)
    buffer_store_dwordx4 v[28:31], v9, s[12:15], s41 offen sc1
L_no5_wc:
    s_add_u32 s41, s28, 0
    s_waitcnt lgkmcnt(6)
    buffer_store_dwordx4 v[12:15], v9, s[12:15], s41 offen sc1
    s_add_u32 s41, s28, 1081344
    s_waitcnt lgkmcnt(4)
    buffer_store_dwordx4 v[16:19], v9, s[12:15], s41 offen sc1
    s_add_u32 s41, s28, 2162688
    s_waitcnt lgkmcnt(2)
    buffer_store_dwordx4 v[20:23], v9, s[12:15], s41 offen sc1
    s_add_u32 s41, s28, 3244032
    s_waitcnt lgkmcnt(0)
    buffer_store_dwordx4 v[24:27], v9, s[12:15], s41 offen sc1
    s_mov_b32 s18, s84
    s_mov_b32 s19, s85
    s_lshl_b32 s21, s3, 3
    s_add_u32 s21, s21, s20
    v_lshlrev_b32 v1, 4, v0
    s_waitcnt lgkmcnt(0)
    s_add_u32 s4, s18, 0x1200000
    s_addc_u32 s5, s19, 0
    s_and_b32 s5, s5, 0xffff
    s_mov_b32 s6, 0x422100
    s_mov_b32 s7, 0x20000
    s_add_u32 s8, s18, 0x1680000
    s_addc_u32 s9, s19, 0
    s_and_b32 s9, s9, 0xffff
    s_mov_b32 s10, 0x422100
    s_mov_b32 s11, 0x20000
    s_add_u32 s12, s18, 0x1b00000
    s_addc_u32 s13, s19, 0
    s_and_b32 s13, s13, 0xffff
    s_mov_b32 s14, 0x422100
    s_mov_b32 s15, 0x20000
    v_and_b32 v5, 31, v0
    v_cvt_f32_u32 v5, v5
    v_lshrrev_b32 v3, 5, v0
    v_cvt_f32_u32 v3, v3
    v_mul_f32 v3, 0x40800000, v3
    s_and_b32 s22, s20, 1
    s_lshr_b32 s23, s20, 1
    s_and_b32 s23, s23, 1
    s_lshr_b32 s24, s20, 2
    s_lshl_b32 s25, s23, 5
    v_cvt_f32_u32 v6, s25
    v_add_f32 v6, v6, v5
    v_mul_f32 v2, 0x3c800000, v6
    v_cvt_f32_u32 v6, s22
    v_mul_f32 v4, 0x3e800000, v6
    s_lshl_b32 s25, s24, 5
    v_cvt_f32_u32 v6, s25
    v_add_f32 v6, v6, v3
    s_lshl_b32 s25, s22, 1
    s_add_u32 s25, s25, s23
    s_lshl_b32 s25, s25, 3
    s_lshl_b32 s26, s24, 2
    s_add_u32 s25, s25, s26
    s_lshl_b32 s25, s25, 10
    v_add_u32 v7, s25, v1
    v_fma_f32 v104, v6, v2, v4
    v_fract_f32 v104, v104
    v_sin_f32 v106, v104
    v_cos_f32 v105, v104
    s_nop 0
    v_cvt_pk_bf16_f32 v108, v105, v106
    v_add_f32 v104, 0x3f800000, v6
    v_fma_f32 v104, v104, v2, v4
    v_fract_f32 v104, v104
    v_sin_f32 v106, v104
    v_cos_f32 v105, v104
    s_nop 0
    v_cvt_pk_bf16_f32 v109, v105, v106
    v_add_f32 v104, 0x40000000, v6
    v_fma_f32 v104, v104, v2, v4
    v_fract_f32 v104, v104
    v_sin_f32 v106, v104
    v_cos_f32 v105, v104
    s_nop 0
    v_cvt_pk_bf16_f32 v110, v105, v106
    v_add_f32 v104, 0x40400000, v6
    v_fma_f32 v104, v104, v2, v4
    v_fract_f32 v104, v104
    v_sin_f32 v106, v104
    v_cos_f32 v105, v104
    s_nop 0
    v_cvt_pk_bf16_f32 v111, v105, v106
    ds_write_b128 v7, v[108:111] offset:8192
    v_add_f32 v104, 0x41000000, v6
    v_fma_f32 v104, v104, v2, v4
    v_fract_f32 v104, v104
    v_sin_f32 v106, v104
    v_cos_f32 v105, v104
    s_nop 0
    v_cvt_pk_bf16_f32 v112, v105, v106
    v_add_f32 v104, 0x41100000, v6
    v_fma_f32 v104, v104, v2, v4
    v_fract_f32 v104, v104
    v_sin_f32 v106, v104
    v_cos_f32 v105, v104
    s_nop 0
    v_cvt_pk_bf16_f32 v113, v105, v106
    v_add_f32 v104, 0x41200000, v6
    v_fma_f32 v104, v104, v2, v4
    v_fract_f32 v104, v104
    v_sin_f32 v106, v104
    v_cos_f32 v105, v104
    s_nop 0
    v_cvt_pk_bf16_f32 v114, v105, v106
    v_add_f32 v104, 0x41300000, v6
    v_fma_f32 v104, v104, v2, v4
    v_fract_f32 v104, v104
    v_sin_f32 v106, v104
    v_cos_f32 v105, v104
    s_nop 0
    v_cvt_pk_bf16_f32 v115, v105, v106
    ds_write_b128 v7, v[112:115] offset:9216
    v_add_f32 v104, 0x41800000, v6
    v_fma_f32 v104, v104, v2, v4
    v_fract_f32 v104, v104
    v_sin_f32 v106, v104
    v_cos_f32 v105, v104
    s_nop 0
    v_cvt_pk_bf16_f32 v108, v105, v106
    v_add_f32 v104, 0x41880000, v6
    v_fma_f32 v104, v104, v2, v4
    v_fract_f32 v104, v104
    v_sin_f32 v106, v104
    v_cos_f32 v105, v104
    s_nop 0
    v_cvt_pk_bf16_f32 v109, v105, v106
    v_add_f32 v104, 0x41900000, v6
    v_fma_f32 v104, v104, v2, v4
    v_fract_f32 v104, v104
    v_sin_f32 v106, v104
    v_cos_f32 v105, v104
    s_nop 0
    v_cvt_pk_bf16_f32 v110, v105, v106
    v_add_f32 v104, 0x41980000, v6
    v_fma_f32 v104, v104, v2, v4
    v_fract_f32 v104, v104
    v_sin_f32 v106, v104
    v_cos_f32 v105, v104
    s_nop 0
    v_cvt_pk_bf16_f32 v111, v105, v106
    ds_write_b128 v7, v[108:111] offset:10240
    v_add_f32 v104, 0x41c00000, v6
    v_fma_f32 v104, v104, v2, v4
    v_fract_f32 v104, v104
    v_sin_f32 v106, v104
    v_cos_f32 v105, v104
    s_nop 0
    v_cvt_pk_bf16_f32 v112, v105, v106
    v_add_f32 v104, 0x41c80000, v6
    v_fma_f32 v104, v104, v2, v4
    v_fract_f32 v104, v104
    v_sin_f32 v106, v104
    v_cos_f32 v105, v104
    s_nop 0
    v_cvt_pk_bf16_f32 v113, v105, v106
    v_add_f32 v104, 0x41d00000, v6
    v_fma_f32 v104, v104, v2, v4
    v_fract_f32 v104, v104
    v_sin_f32 v106, v104
    v_cos_f32 v105, v104
    s_nop 0
    v_cvt_pk_bf16_f32 v114, v105, v106
    v_add_f32 v104, 0x41d80000, v6
    v_fma_f32 v104, v104, v2, v4
    v_fract_f32 v104, v104
    v_sin_f32 v106, v104
    v_cos_f32 v105, v104
    s_nop 0
    v_cvt_pk_bf16_f32 v115, v105, v106
    ds_write_b128 v7, v[112:115] offset:11264
    v_mul_f32 v2, 0x3d000000, v5
    s_lshr_b32 s25, s20, 1
    s_lshl_b32 s26, s25, 3
    v_cvt_f32_u32 v6, s26
    v_add_f32 v6, v6, v3
    s_lshl_b32 s26, s22, 2
    s_add_u32 s26, s26, s25
    s_lshl_b32 s26, s26, 10
    v_add_u32 v7, s26, v1
    v_fma_f32 v104, v6, v2, v4
    v_fract_f32 v104, v104
    v_sin_f32 v106, v104
    v_cos_f32 v105, v104
    s_nop 0
    v_cvt_pk_bf16_f32 v108, v105, v106
    v_add_f32 v104, 0x3f800000, v6
    v_fma_f32 v104, v104, v2, v4
    v_fract_f32 v104, v104
    v_sin_f32 v106, v104
    v_cos_f32 v105, v104
    s_nop 0
    v_cvt_pk_bf16_f32 v109, v105, v106
    v_add_f32 v104, 0x40000000, v6
    v_fma_f32 v104, v104, v2, v4
    v_fract_f32 v104, v104
    v_sin_f32 v106, v104
    v_cos_f32 v105, v104
    s_nop 0
    v_cvt_pk_bf16_f32 v110, v105, v106
    v_add_f32 v104, 0x40400000, v6
    v_fma_f32 v104, v104, v2, v4
    v_fract_f32 v104, v104
    v_sin_f32 v106, v104
    v_cos_f32 v105, v104
    s_nop 0
    v_cvt_pk_bf16_f32 v111, v105, v106
    ds_write_b128 v7, v[108:111] offset:0
    s_and_b32 s25, s20, 3
    s_lshl_b32 s26, s25, 3
    v_cvt_f32_u32 v6, s26
    v_add_f32 v6, v6, v3
    s_lshr_b32 s27, s20, 2
    s_lshl_b32 s28, s27, 5
    v_cvt_f32_u32 v7, s28
    s_lshl_b32 s28, s27, 3
    s_lshl_b32 s29, s25, 1
    s_add_u32 s28, s28, s29
    s_lshl_b32 s28, s28, 10
    s_add_u32 s28, s28, 40960
    v_add_u32 v2, s28, v1
    v_add_f32 v4, v6, v7
    v_mul_f32 v119, 0x3a000000, v5
    v_mul_f32 v104, v4, v119
    v_fract_f32 v104, v104
    v_sin_f32 v110, v104
    v_cos_f32 v108, v104
    v_add_f32 v104, 0x3f800000, v4
    v_mul_f32 v104, v104, v119
    v_fract_f32 v104, v104
    v_sin_f32 v111, v104
    v_cos_f32 v109, v104
    s_nop 0
    ds_write_b128 v2, v[108:111] offset:0
    s_nop 1
    v_add_f32 v104, 0x40000000, v4
    v_mul_f32 v104, v104, v119
    v_fract_f32 v104, v104
    v_sin_f32 v110, v104
    v_cos_f32 v108, v104
    v_add_f32 v104, 0x40400000, v4
    v_mul_f32 v104, v104, v119
    v_fract_f32 v104, v104
    v_sin_f32 v111, v104
    v_cos_f32 v109, v104
    s_nop 0
    ds_write_b128 v2, v[108:111] offset:1024
    s_nop 1
    v_add_f32 v4, v5, v7
    v_mul_f32 v119, 0x3a000000, v4
    v_mul_f32 v104, v6, v119
    v_fract_f32 v104, v104
    v_sin_f32 v114, v104
    v_cos_f32 v112, v104
    v_add_f32 v104, 0x3f800000, v6
    v_mul_f32 v104, v104, v119
    v_fract_f32 v104, v104
    v_sin_f32 v115, v104
    v_cos_f32 v113, v104
    s_nop 0
    v_mul_f32 v112, 0x35800000, v112
    v_mul_f32 v113, 0x35800000, v113
    v_mul_f32 v114, 0x35800000, v114
    v_mul_f32 v115, 0x35800000, v115
    ds_write_b128 v2, v[112:115] offset:16384
    s_nop 1
    v_add_f32 v104, 0x40000000, v6
    v_mul_f32 v104, v104, v119
    v_fract_f32 v104, v104
    v_sin_f32 v114, v104
    v_cos_f32 v112, v104
    v_add_f32 v104, 0x40400000, v6
    v_mul_f32 v104, v104, v119
    v_fract_f32 v104, v104
    v_sin_f32 v115, v104
    v_cos_f32 v113, v104
    s_nop 0
    v_mul_f32 v112, 0x35800000, v112
    v_mul_f32 v113, 0x35800000, v113
    v_mul_f32 v114, 0x35800000, v114
    v_mul_f32 v115, 0x35800000, v115
    ds_write_b128 v2, v[112:115] offset:17408
    s_nop 1
    v_add_u32 v2, 40960, v1
    s_waitcnt vmcnt(0)
    s_barrier
    s_cmp_lg_u32 s20, 0
    s_cbranch_scc1 L_colnopoll
    v_mov_b32 v5, 0
    v_mov_b32 v6, v65
    s_mov_b32 s92, s86
    s_and_b32 s93, s87, 0xffff
    s_mov_b32 s94, 0x100
    s_mov_b32 s95, 0x20000
    s_mov_b32 s42, 0
L_gate_col:
    v_readfirstlane_b32 s40, v6
    s_cmp_eq_u32 s40, 1
    s_cbranch_scc1 L_gateok_col
    s_sleep 16
    buffer_load_dword v6, v5, s[92:95], 0 offen sc1
    s_waitcnt vmcnt(0)
    s_add_u32 s42, s42, 1
    s_cmp_lt_u32 s42, 0x8000
    s_cbranch_scc1 L_gate_col
L_gateok_col:
    s_add_u32 s96, s84, 0x2c30000
    s_addc_u32 s97, s85, 0
    s_and_b32 s97, s97, 0xffff
    s_mov_b32 s98, 0x3000
    s_mov_b32 s99, 0x20000
    s_lshr_b32 s40, s2, 3
    s_lshl_b32 s40, s40, 7
    s_and_b32 s41, s2, 7
    s_lshl_b32 s41, s41, 2
    s_add_u32 s40, s40, s41
    v_mov_b32 v5, s40
    v_mov_b32 v6, 1
    s_mov_b64 exec, 1
    buffer_store_dword v6, v5, s[96:99], 0 offen sc1
    s_mov_b64 exec, -1
    s_add_u32 s96, s84, 0x2c30000
    s_addc_u32 s97, s85, 0
    s_and_b32 s97, s97, 0xffff
    s_mov_b32 s98, 0x3000
    s_mov_b32 s99, 0x20000
    v_lshrrev_b32 v5, 1, v0
    v_lshlrev_b32 v5, 7, v5
    v_and_b32 v6, 1, v0
    v_lshl_add_u32 v5, v6, 4, v5
    s_mov_b32 s42, 0
L_poll_col:
    buffer_load_dwordx4 v[8:11], v5, s[96:99], 0 offen sc1
    s_waitcnt vmcnt(0)
    v_cmp_eq_u32 vcc, 1, v8
    s_mov_b64 s[40:41], vcc
    v_cmp_eq_u32 vcc, 1, v9
    s_and_b64 s[40:41], s[40:41], vcc
    v_cmp_eq_u32 vcc, 1, v10
    s_and_b64 s[40:41], s[40:41], vcc
    v_cmp_eq_u32 vcc, 1, v11
    s_and_b64 s[40:41], s[40:41], vcc
    s_cmp_eq_u64 s[40:41], -1
    s_cbranch_scc1 L_pollok_col
    s_sleep 16
    s_add_u32 s42, s42, 1
    s_cmp_lt_u32 s42, 0x8000
    s_cbranch_scc1 L_poll_col
L_pollok_col:
L_colnopoll:
    s_waitcnt lgkmcnt(0)
    s_barrier
    s_mul_i32 s40, s21, 8448
    buffer_load_dwordx4 v[8:11], v1, s[4:7], s40 offen offset:0 sc1
    buffer_load_dwordx4 v[12:15], v1, s[4:7], s40 offen offset:1024 sc1
    buffer_load_dwordx4 v[16:19], v1, s[4:7], s40 offen offset:2048 sc1
    buffer_load_dwordx4 v[20:23], v1, s[4:7], s40 offen offset:3072 sc1
    s_add_u32 s40, s40, 4096
    buffer_load_dwordx4 v[24:27], v1, s[4:7], s40 offen offset:0 sc1
    buffer_load_dwordx4 v[28:31], v1, s[4:7], s40 offen offset:1024 sc1
    buffer_load_dwordx4 v[32:35], v1, s[4:7], s40 offen offset:2048 sc1
    buffer_load_dwordx4 v[36:39], v1, s[4:7], s40 offen offset:3072 sc1
    s_mul_i32 s40, s21, 8448
    buffer_load_dwordx4 v[40:43], v1, s[8:11], s40 offen offset:0 sc1
    buffer_load_dwordx4 v[44:47], v1, s[8:11], s40 offen offset:1024 sc1
    buffer_load_dwordx4 v[48:51], v1, s[8:11], s40 offen offset:2048 sc1
    buffer_load_dwordx4 v[52:55], v1, s[8:11], s40 offen offset:3072 sc1
    s_add_u32 s40, s40, 4096
    buffer_load_dwordx4 v[56:59], v1, s[8:11], s40 offen offset:0 sc1
    buffer_load_dwordx4 v[60:63], v1, s[8:11], s40 offen offset:1024 sc1
    buffer_load_dwordx4 v[64:67], v1, s[8:11], s40 offen offset:2048 sc1
    buffer_load_dwordx4 v[68:71], v1, s[8:11], s40 offen offset:3072 sc1
    ds_read_b128 v[72:75], v1 offset:0
    ds_read_b128 v[76:79], v1 offset:1024
    ds_read_b128 v[80:83], v1 offset:2048
    ds_read_b128 v[84:87], v1 offset:3072
    ds_read_b128 v[88:91], v1 offset:4096
    ds_read_b128 v[92:95], v1 offset:5120
    ds_read_b128 v[96:99], v1 offset:6144
    ds_read_b128 v[100:103], v1 offset:7168
L_col_c:
    s_waitcnt vmcnt(8) lgkmcnt(0)
    v_mfma_f32_32x32x16_bf16 v[144:159], v[8:11], v[72:75], 0
    v_mfma_f32_32x32x16_bf16 v[144:159], v[12:15], v[76:79], v[144:159]
    v_mfma_f32_32x32x16_bf16 v[144:159], v[16:19], v[80:83], v[144:159]
    v_mfma_f32_32x32x16_bf16 v[144:159], v[20:23], v[84:87], v[144:159]
    v_mfma_f32_32x32x16_bf16 v[176:191], v[8:11], v[88:91], 0
    v_mfma_f32_32x32x16_bf16 v[176:191], v[12:15], v[92:95], v[176:191]
    v_mfma_f32_32x32x16_bf16 v[176:191], v[16:19], v[96:99], v[176:191]
    v_mfma_f32_32x32x16_bf16 v[176:191], v[20:23], v[100:103], v[176:191]
    v_mfma_f32_32x32x16_bf16 v[160:175], v[24:27], v[72:75], 0
    v_mfma_f32_32x32x16_bf16 v[160:175], v[28:31], v[76:79], v[160:175]
    v_mfma_f32_32x32x16_bf16 v[160:175], v[32:35], v[80:83], v[160:175]
    v_mfma_f32_32x32x16_bf16 v[160:175], v[36:39], v[84:87], v[160:175]
    v_mfma_f32_32x32x16_bf16 v[192:207], v[24:27], v[88:91], 0
    v_mfma_f32_32x32x16_bf16 v[192:207], v[28:31], v[92:95], v[192:207]
    v_mfma_f32_32x32x16_bf16 v[192:207], v[32:35], v[96:99], v[192:207]
    v_mfma_f32_32x32x16_bf16 v[192:207], v[36:39], v[100:103], v[192:207]
    s_add_u32 s22, s21, 256
    s_cmp_lt_u32 s22, 513
    s_cselect_b32 s23, s22, s21
    ds_read_b128 v[112:115], v2 offset:0
    ds_read_b128 v[116:119], v2 offset:1024
    ds_read_b128 v[120:123], v2 offset:2048
    ds_read_b128 v[124:127], v2 offset:3072
    s_waitcnt lgkmcnt(3)
    v_pk_mul_f32 v[104:105], v[144:145], v[112:113]
    v_pk_mul_f32 v[106:107], v[176:177], v[112:113]
    v_pk_fma_f32 v[104:105], v[176:177], v[114:115], v[104:105]
    v_pk_fma_f32 v[106:107], v[144:145], v[114:115], v[106:107] neg_lo:[1,0,0] neg_hi:[1,0,0]
    v_cvt_pk_bf16_f32 v208, v104, v106
    v_cvt_pk_bf16_f32 v209, v105, v107
    ds_read_b128 v[112:115], v2 offset:4096
    s_waitcnt lgkmcnt(3)
    v_pk_mul_f32 v[108:109], v[146:147], v[116:117]
    v_pk_mul_f32 v[110:111], v[178:179], v[116:117]
    v_pk_fma_f32 v[108:109], v[178:179], v[118:119], v[108:109]
    v_pk_fma_f32 v[110:111], v[146:147], v[118:119], v[110:111] neg_lo:[1,0,0] neg_hi:[1,0,0]
    v_cvt_pk_bf16_f32 v210, v108, v110
    v_cvt_pk_bf16_f32 v211, v109, v111
    ds_read_b128 v[116:119], v2 offset:5120
    s_waitcnt lgkmcnt(3)
    v_pk_mul_f32 v[104:105], v[148:149], v[120:121]
    v_pk_mul_f32 v[106:107], v[180:181], v[120:121]
    v_pk_fma_f32 v[104:105], v[180:181], v[122:123], v[104:105]
    v_pk_fma_f32 v[106:107], v[148:149], v[122:123], v[106:107] neg_lo:[1,0,0] neg_hi:[1,0,0]
    v_cvt_pk_bf16_f32 v212, v104, v106
    v_cvt_pk_bf16_f32 v213, v105, v107
    ds_read_b128 v[120:123], v2 offset:6144
    s_waitcnt lgkmcnt(3)
    v_pk_mul_f32 v[108:109], v[150:151], v[124:125]
    v_pk_mul_f32 v[110:111], v[182:183], v[124:125]
    v_pk_fma_f32 v[108:109], v[182:183], v[126:127], v[108:109]
    v_pk_fma_f32 v[110:111], v[150:151], v[126:127], v[110:111] neg_lo:[1,0,0] neg_hi:[1,0,0]
    v_cvt_pk_bf16_f32 v214, v108, v110
    v_cvt_pk_bf16_f32 v215, v109, v111
    ds_read_b128 v[124:127], v2 offset:7168
    s_waitcnt lgkmcnt(3)
    v_pk_mul_f32 v[104:105], v[152:153], v[112:113]
    v_pk_mul_f32 v[106:107], v[184:185], v[112:113]
    v_pk_fma_f32 v[104:105], v[184:185], v[114:115], v[104:105]
    v_pk_fma_f32 v[106:107], v[152:153], v[114:115], v[106:107] neg_lo:[1,0,0] neg_hi:[1,0,0]
    v_cvt_pk_bf16_f32 v216, v104, v106
    v_cvt_pk_bf16_f32 v217, v105, v107
    ds_read_b128 v[112:115], v2 offset:8192
    s_waitcnt lgkmcnt(3)
    v_pk_mul_f32 v[108:109], v[154:155], v[116:117]
    v_pk_mul_f32 v[110:111], v[186:187], v[116:117]
    v_pk_fma_f32 v[108:109], v[186:187], v[118:119], v[108:109]
    v_pk_fma_f32 v[110:111], v[154:155], v[118:119], v[110:111] neg_lo:[1,0,0] neg_hi:[1,0,0]
    v_cvt_pk_bf16_f32 v218, v108, v110
    v_cvt_pk_bf16_f32 v219, v109, v111
    ds_read_b128 v[116:119], v2 offset:9216
    s_waitcnt lgkmcnt(3)
    v_pk_mul_f32 v[104:105], v[156:157], v[120:121]
    v_pk_mul_f32 v[106:107], v[188:189], v[120:121]
    v_pk_fma_f32 v[104:105], v[188:189], v[122:123], v[104:105]
    v_pk_fma_f32 v[106:107], v[156:157], v[122:123], v[106:107] neg_lo:[1,0,0] neg_hi:[1,0,0]
    v_cvt_pk_bf16_f32 v220, v104, v106
    v_cvt_pk_bf16_f32 v221, v105, v107
    ds_read_b128 v[120:123], v2 offset:10240
    s_waitcnt lgkmcnt(3)
    v_pk_mul_f32 v[108:109], v[158:159], v[124:125]
    v_pk_mul_f32 v[110:111], v[190:191], v[124:125]
    v_pk_fma_f32 v[108:109], v[190:191], v[126:127], v[108:109]
    v_pk_fma_f32 v[110:111], v[158:159], v[126:127], v[110:111] neg_lo:[1,0,0] neg_hi:[1,0,0]
    v_cvt_pk_bf16_f32 v222, v108, v110
    v_cvt_pk_bf16_f32 v223, v109, v111
    ds_read_b128 v[124:127], v2 offset:11264
    s_waitcnt lgkmcnt(3)
    v_pk_mul_f32 v[104:105], v[160:161], v[112:113]
    v_pk_mul_f32 v[106:107], v[192:193], v[112:113]
    v_pk_fma_f32 v[104:105], v[192:193], v[114:115], v[104:105]
    v_pk_fma_f32 v[106:107], v[160:161], v[114:115], v[106:107] neg_lo:[1,0,0] neg_hi:[1,0,0]
    v_cvt_pk_bf16_f32 v224, v104, v106
    v_cvt_pk_bf16_f32 v225, v105, v107
    ds_read_b128 v[112:115], v2 offset:12288
    s_waitcnt lgkmcnt(3)
    v_pk_mul_f32 v[108:109], v[162:163], v[116:117]
    v_pk_mul_f32 v[110:111], v[194:195], v[116:117]
    v_pk_fma_f32 v[108:109], v[194:195], v[118:119], v[108:109]
    v_pk_fma_f32 v[110:111], v[162:163], v[118:119], v[110:111] neg_lo:[1,0,0] neg_hi:[1,0,0]
    v_cvt_pk_bf16_f32 v226, v108, v110
    v_cvt_pk_bf16_f32 v227, v109, v111
    ds_read_b128 v[116:119], v2 offset:13312
    s_waitcnt lgkmcnt(3)
    v_pk_mul_f32 v[104:105], v[164:165], v[120:121]
    v_pk_mul_f32 v[106:107], v[196:197], v[120:121]
    v_pk_fma_f32 v[104:105], v[196:197], v[122:123], v[104:105]
    v_pk_fma_f32 v[106:107], v[164:165], v[122:123], v[106:107] neg_lo:[1,0,0] neg_hi:[1,0,0]
    v_cvt_pk_bf16_f32 v228, v104, v106
    v_cvt_pk_bf16_f32 v229, v105, v107
    ds_read_b128 v[120:123], v2 offset:14336
    s_waitcnt lgkmcnt(3)
    v_pk_mul_f32 v[108:109], v[166:167], v[124:125]
    v_pk_mul_f32 v[110:111], v[198:199], v[124:125]
    v_pk_fma_f32 v[108:109], v[198:199], v[126:127], v[108:109]
    v_pk_fma_f32 v[110:111], v[166:167], v[126:127], v[110:111] neg_lo:[1,0,0] neg_hi:[1,0,0]
    v_cvt_pk_bf16_f32 v230, v108, v110
    v_cvt_pk_bf16_f32 v231, v109, v111
    ds_read_b128 v[124:127], v2 offset:15360
    s_waitcnt lgkmcnt(3)
    v_pk_mul_f32 v[104:105], v[168:169], v[112:113]
    v_pk_mul_f32 v[106:107], v[200:201], v[112:113]
    v_pk_fma_f32 v[104:105], v[200:201], v[114:115], v[104:105]
    v_pk_fma_f32 v[106:107], v[168:169], v[114:115], v[106:107] neg_lo:[1,0,0] neg_hi:[1,0,0]
    v_cvt_pk_bf16_f32 v232, v104, v106
    v_cvt_pk_bf16_f32 v233, v105, v107
    s_waitcnt lgkmcnt(2)
    v_pk_mul_f32 v[108:109], v[170:171], v[116:117]
    v_pk_mul_f32 v[110:111], v[202:203], v[116:117]
    v_pk_fma_f32 v[108:109], v[202:203], v[118:119], v[108:109]
    v_pk_fma_f32 v[110:111], v[170:171], v[118:119], v[110:111] neg_lo:[1,0,0] neg_hi:[1,0,0]
    v_cvt_pk_bf16_f32 v234, v108, v110
    v_cvt_pk_bf16_f32 v235, v109, v111
    s_waitcnt lgkmcnt(1)
    v_pk_mul_f32 v[104:105], v[172:173], v[120:121]
    v_pk_mul_f32 v[106:107], v[204:205], v[120:121]
    v_pk_fma_f32 v[104:105], v[204:205], v[122:123], v[104:105]
    v_pk_fma_f32 v[106:107], v[172:173], v[122:123], v[106:107] neg_lo:[1,0,0] neg_hi:[1,0,0]
    v_cvt_pk_bf16_f32 v236, v104, v106
    v_cvt_pk_bf16_f32 v237, v105, v107
    s_waitcnt lgkmcnt(0)
    v_pk_mul_f32 v[108:109], v[174:175], v[124:125]
    v_pk_mul_f32 v[110:111], v[206:207], v[124:125]
    v_pk_fma_f32 v[108:109], v[206:207], v[126:127], v[108:109]
    v_pk_fma_f32 v[110:111], v[174:175], v[126:127], v[110:111] neg_lo:[1,0,0] neg_hi:[1,0,0]
    v_cvt_pk_bf16_f32 v238, v108, v110
    v_cvt_pk_bf16_f32 v239, v109, v111
    s_mul_i32 s40, s23, 8448
    buffer_load_dwordx4 v[8:11], v1, s[4:7], s40 offen offset:0 sc1
    buffer_load_dwordx4 v[12:15], v1, s[4:7], s40 offen offset:1024 sc1
    buffer_load_dwordx4 v[16:19], v1, s[4:7], s40 offen offset:2048 sc1
    buffer_load_dwordx4 v[20:23], v1, s[4:7], s40 offen offset:3072 sc1
    s_add_u32 s40, s40, 4096
    buffer_load_dwordx4 v[24:27], v1, s[4:7], s40 offen offset:0 sc1
    buffer_load_dwordx4 v[28:31], v1, s[4:7], s40 offen offset:1024 sc1
    buffer_load_dwordx4 v[32:35], v1, s[4:7], s40 offen offset:2048 sc1
    buffer_load_dwordx4 v[36:39], v1, s[4:7], s40 offen offset:3072 sc1
    ds_read_b128 v[104:107], v1 offset:8192
    ds_read_b128 v[108:111], v1 offset:9216
    ds_read_b128 v[112:115], v1 offset:10240
    ds_read_b128 v[116:119], v1 offset:11264
    ds_read_b128 v[120:123], v1 offset:12288
    ds_read_b128 v[124:127], v1 offset:13312
    ds_read_b128 v[128:131], v1 offset:14336
    ds_read_b128 v[132:135], v1 offset:15360
    s_waitcnt lgkmcnt(7)
    v_mfma_f32_32x32x16_bf16 v[144:159], v[104:107], v[208:211], 0
    ds_read_b128 v[104:107], v1 offset:24576
    s_waitcnt lgkmcnt(7)
    v_mfma_f32_32x32x16_bf16 v[144:159], v[108:111], v[212:215], v[144:159]
    ds_read_b128 v[108:111], v1 offset:25600
    s_waitcnt lgkmcnt(7)
    v_mfma_f32_32x32x16_bf16 v[144:159], v[112:115], v[216:219], v[144:159]
    ds_read_b128 v[112:115], v1 offset:26624
    s_waitcnt lgkmcnt(7)
    v_mfma_f32_32x32x16_bf16 v[144:159], v[116:119], v[220:223], v[144:159]
    ds_read_b128 v[116:119], v1 offset:27648
    s_waitcnt lgkmcnt(7)
    v_mfma_f32_32x32x16_bf16 v[144:159], v[120:123], v[224:227], v[144:159]
    ds_read_b128 v[120:123], v1 offset:28672
    s_waitcnt lgkmcnt(7)
    v_mfma_f32_32x32x16_bf16 v[144:159], v[124:127], v[228:231], v[144:159]
    ds_read_b128 v[124:127], v1 offset:29696
    s_waitcnt lgkmcnt(7)
    v_mfma_f32_32x32x16_bf16 v[144:159], v[128:131], v[232:235], v[144:159]
    ds_read_b128 v[128:131], v1 offset:30720
    s_waitcnt lgkmcnt(7)
    v_mfma_f32_32x32x16_bf16 v[144:159], v[132:135], v[236:239], v[144:159]
    ds_read_b128 v[132:135], v1 offset:31744
    s_waitcnt lgkmcnt(7)
    v_mfma_f32_32x32x16_bf16 v[176:191], v[104:107], v[208:211], 0
    ds_read_b128 v[104:107], v1 offset:16384
    s_waitcnt lgkmcnt(7)
    v_mfma_f32_32x32x16_bf16 v[176:191], v[108:111], v[212:215], v[176:191]
    ds_read_b128 v[108:111], v1 offset:17408
    s_waitcnt lgkmcnt(7)
    v_mfma_f32_32x32x16_bf16 v[176:191], v[112:115], v[216:219], v[176:191]
    ds_read_b128 v[112:115], v1 offset:18432
    s_waitcnt lgkmcnt(7)
    v_mfma_f32_32x32x16_bf16 v[176:191], v[116:119], v[220:223], v[176:191]
    ds_read_b128 v[116:119], v1 offset:19456
    s_waitcnt lgkmcnt(7)
    v_mfma_f32_32x32x16_bf16 v[176:191], v[120:123], v[224:227], v[176:191]
    ds_read_b128 v[120:123], v1 offset:20480
    s_waitcnt lgkmcnt(7)
    v_mfma_f32_32x32x16_bf16 v[176:191], v[124:127], v[228:231], v[176:191]
    ds_read_b128 v[124:127], v1 offset:21504
    s_waitcnt lgkmcnt(7)
    v_mfma_f32_32x32x16_bf16 v[176:191], v[128:131], v[232:235], v[176:191]
    ds_read_b128 v[128:131], v1 offset:22528
    s_waitcnt lgkmcnt(7)
    v_mfma_f32_32x32x16_bf16 v[176:191], v[132:135], v[236:239], v[176:191]
    ds_read_b128 v[132:135], v1 offset:23552
    s_waitcnt lgkmcnt(7)
    v_mfma_f32_32x32x16_bf16 v[160:175], v[104:107], v[208:211], 0
    ds_read_b128 v[104:107], v1 offset:32768
    s_waitcnt lgkmcnt(7)
    v_mfma_f32_32x32x16_bf16 v[160:175], v[108:111], v[212:215], v[160:175]
    ds_read_b128 v[108:111], v1 offset:33792
    s_waitcnt lgkmcnt(7)
    v_mfma_f32_32x32x16_bf16 v[160:175], v[112:115], v[216:219], v[160:175]
    ds_read_b128 v[112:115], v1 offset:34816
    s_waitcnt lgkmcnt(7)
    v_mfma_f32_32x32x16_bf16 v[160:175], v[116:119], v[220:223], v[160:175]
    ds_read_b128 v[116:119], v1 offset:35840
    s_waitcnt lgkmcnt(7)
    v_mfma_f32_32x32x16_bf16 v[160:175], v[120:123], v[224:227], v[160:175]
    ds_read_b128 v[120:123], v1 offset:36864
    s_waitcnt lgkmcnt(7)
    v_mfma_f32_32x32x16_bf16 v[160:175], v[124:127], v[228:231], v[160:175]
    ds_read_b128 v[124:127], v1 offset:37888
    s_waitcnt lgkmcnt(7)
    v_mfma_f32_32x32x16_bf16 v[160:175], v[128:131], v[232:235], v[160:175]
    ds_read_b128 v[128:131], v1 offset:38912
    s_waitcnt lgkmcnt(7)
    v_mfma_f32_32x32x16_bf16 v[160:175], v[132:135], v[236:239], v[160:175]
    ds_read_b128 v[132:135], v1 offset:39936
    s_waitcnt lgkmcnt(7)
    v_mfma_f32_32x32x16_bf16 v[192:207], v[104:107], v[208:211], 0
    s_waitcnt lgkmcnt(6)
    v_mfma_f32_32x32x16_bf16 v[192:207], v[108:111], v[212:215], v[192:207]
    s_waitcnt lgkmcnt(5)
    v_mfma_f32_32x32x16_bf16 v[192:207], v[112:115], v[216:219], v[192:207]
    s_waitcnt lgkmcnt(4)
    v_mfma_f32_32x32x16_bf16 v[192:207], v[116:119], v[220:223], v[192:207]
    s_waitcnt lgkmcnt(3)
    v_mfma_f32_32x32x16_bf16 v[192:207], v[120:123], v[224:227], v[192:207]
    s_waitcnt lgkmcnt(2)
    v_mfma_f32_32x32x16_bf16 v[192:207], v[124:127], v[228:231], v[192:207]
    s_waitcnt lgkmcnt(1)
    v_mfma_f32_32x32x16_bf16 v[192:207], v[128:131], v[232:235], v[192:207]
    s_waitcnt lgkmcnt(0)
    v_mfma_f32_32x32x16_bf16 v[192:207], v[132:135], v[236:239], v[192:207]
    s_waitcnt vmcnt(8)
    v_lshlrev_b32 v104, 16, v40
    v_lshlrev_b32 v105, 16, v41
    v_and_b32 v106, 0xffff0000, v40
    v_and_b32 v107, 0xffff0000, v41
    v_pk_mul_f32 v[108:109], v[144:145], v[104:105]
    v_pk_mul_f32 v[110:111], v[144:145], v[106:107]
    v_pk_fma_f32 v[108:109], v[176:177], v[106:107], v[108:109] neg_lo:[1,0,0] neg_hi:[1,0,0]
    v_pk_fma_f32 v[110:111], v[176:177], v[104:105], v[110:111]
    v_cvt_pk_bf16_f32 v208, v108, -v110
    v_cvt_pk_bf16_f32 v209, v109, -v111
    v_lshlrev_b32 v112, 16, v42
    v_lshlrev_b32 v113, 16, v43
    v_and_b32 v114, 0xffff0000, v42
    v_and_b32 v115, 0xffff0000, v43
    v_pk_mul_f32 v[116:117], v[146:147], v[112:113]
    v_pk_mul_f32 v[118:119], v[146:147], v[114:115]
    v_pk_fma_f32 v[116:117], v[178:179], v[114:115], v[116:117] neg_lo:[1,0,0] neg_hi:[1,0,0]
    v_pk_fma_f32 v[118:119], v[178:179], v[112:113], v[118:119]
    v_cvt_pk_bf16_f32 v210, v116, -v118
    v_cvt_pk_bf16_f32 v211, v117, -v119
    v_lshlrev_b32 v104, 16, v44
    v_lshlrev_b32 v105, 16, v45
    v_and_b32 v106, 0xffff0000, v44
    v_and_b32 v107, 0xffff0000, v45
    v_pk_mul_f32 v[108:109], v[148:149], v[104:105]
    v_pk_mul_f32 v[110:111], v[148:149], v[106:107]
    v_pk_fma_f32 v[108:109], v[180:181], v[106:107], v[108:109] neg_lo:[1,0,0] neg_hi:[1,0,0]
    v_pk_fma_f32 v[110:111], v[180:181], v[104:105], v[110:111]
    v_cvt_pk_bf16_f32 v212, v108, -v110
    v_cvt_pk_bf16_f32 v213, v109, -v111
    v_lshlrev_b32 v112, 16, v46
    v_lshlrev_b32 v113, 16, v47
    v_and_b32 v114, 0xffff0000, v46
    v_and_b32 v115, 0xffff0000, v47
    v_pk_mul_f32 v[116:117], v[150:151], v[112:113]
    v_pk_mul_f32 v[118:119], v[150:151], v[114:115]
    v_pk_fma_f32 v[116:117], v[182:183], v[114:115], v[116:117] neg_lo:[1,0,0] neg_hi:[1,0,0]
    v_pk_fma_f32 v[118:119], v[182:183], v[112:113], v[118:119]
    v_cvt_pk_bf16_f32 v214, v116, -v118
    v_cvt_pk_bf16_f32 v215, v117, -v119
    v_lshlrev_b32 v104, 16, v48
    v_lshlrev_b32 v105, 16, v49
    v_and_b32 v106, 0xffff0000, v48
    v_and_b32 v107, 0xffff0000, v49
    v_pk_mul_f32 v[108:109], v[152:153], v[104:105]
    v_pk_mul_f32 v[110:111], v[152:153], v[106:107]
    v_pk_fma_f32 v[108:109], v[184:185], v[106:107], v[108:109] neg_lo:[1,0,0] neg_hi:[1,0,0]
    v_pk_fma_f32 v[110:111], v[184:185], v[104:105], v[110:111]
    v_cvt_pk_bf16_f32 v216, v108, -v110
    v_cvt_pk_bf16_f32 v217, v109, -v111
    v_lshlrev_b32 v112, 16, v50
    v_lshlrev_b32 v113, 16, v51
    v_and_b32 v114, 0xffff0000, v50
    v_and_b32 v115, 0xffff0000, v51
    v_pk_mul_f32 v[116:117], v[154:155], v[112:113]
    v_pk_mul_f32 v[118:119], v[154:155], v[114:115]
    v_pk_fma_f32 v[116:117], v[186:187], v[114:115], v[116:117] neg_lo:[1,0,0] neg_hi:[1,0,0]
    v_pk_fma_f32 v[118:119], v[186:187], v[112:113], v[118:119]
    v_cvt_pk_bf16_f32 v218, v116, -v118
    v_cvt_pk_bf16_f32 v219, v117, -v119
    v_lshlrev_b32 v104, 16, v52
    v_lshlrev_b32 v105, 16, v53
    v_and_b32 v106, 0xffff0000, v52
    v_and_b32 v107, 0xffff0000, v53
    v_pk_mul_f32 v[108:109], v[156:157], v[104:105]
    v_pk_mul_f32 v[110:111], v[156:157], v[106:107]
    v_pk_fma_f32 v[108:109], v[188:189], v[106:107], v[108:109] neg_lo:[1,0,0] neg_hi:[1,0,0]
    v_pk_fma_f32 v[110:111], v[188:189], v[104:105], v[110:111]
    v_cvt_pk_bf16_f32 v220, v108, -v110
    v_cvt_pk_bf16_f32 v221, v109, -v111
    v_lshlrev_b32 v112, 16, v54
    v_lshlrev_b32 v113, 16, v55
    v_and_b32 v114, 0xffff0000, v54
    v_and_b32 v115, 0xffff0000, v55
    v_pk_mul_f32 v[116:117], v[158:159], v[112:113]
    v_pk_mul_f32 v[118:119], v[158:159], v[114:115]
    v_pk_fma_f32 v[116:117], v[190:191], v[114:115], v[116:117] neg_lo:[1,0,0] neg_hi:[1,0,0]
    v_pk_fma_f32 v[118:119], v[190:191], v[112:113], v[118:119]
    v_cvt_pk_bf16_f32 v222, v116, -v118
    v_cvt_pk_bf16_f32 v223, v117, -v119
    v_lshlrev_b32 v104, 16, v56
    v_lshlrev_b32 v105, 16, v57
    v_and_b32 v106, 0xffff0000, v56
    v_and_b32 v107, 0xffff0000, v57
    v_pk_mul_f32 v[108:109], v[160:161], v[104:105]
    v_pk_mul_f32 v[110:111], v[160:161], v[106:107]
    v_pk_fma_f32 v[108:109], v[192:193], v[106:107], v[108:109] neg_lo:[1,0,0] neg_hi:[1,0,0]
    v_pk_fma_f32 v[110:111], v[192:193], v[104:105], v[110:111]
    v_cvt_pk_bf16_f32 v224, v108, -v110
    v_cvt_pk_bf16_f32 v225, v109, -v111
    v_lshlrev_b32 v112, 16, v58
    v_lshlrev_b32 v113, 16, v59
    v_and_b32 v114, 0xffff0000, v58
    v_and_b32 v115, 0xffff0000, v59
    v_pk_mul_f32 v[116:117], v[162:163], v[112:113]
    v_pk_mul_f32 v[118:119], v[162:163], v[114:115]
    v_pk_fma_f32 v[116:117], v[194:195], v[114:115], v[116:117] neg_lo:[1,0,0] neg_hi:[1,0,0]
    v_pk_fma_f32 v[118:119], v[194:195], v[112:113], v[118:119]
    v_cvt_pk_bf16_f32 v226, v116, -v118
    v_cvt_pk_bf16_f32 v227, v117, -v119
    v_lshlrev_b32 v104, 16, v60
    v_lshlrev_b32 v105, 16, v61
    v_and_b32 v106, 0xffff0000, v60
    v_and_b32 v107, 0xffff0000, v61
    v_pk_mul_f32 v[108:109], v[164:165], v[104:105]
    v_pk_mul_f32 v[110:111], v[164:165], v[106:107]
    v_pk_fma_f32 v[108:109], v[196:197], v[106:107], v[108:109] neg_lo:[1,0,0] neg_hi:[1,0,0]
    v_pk_fma_f32 v[110:111], v[196:197], v[104:105], v[110:111]
    v_cvt_pk_bf16_f32 v228, v108, -v110
    v_cvt_pk_bf16_f32 v229, v109, -v111
    v_lshlrev_b32 v112, 16, v62
    v_lshlrev_b32 v113, 16, v63
    v_and_b32 v114, 0xffff0000, v62
    v_and_b32 v115, 0xffff0000, v63
    v_pk_mul_f32 v[116:117], v[166:167], v[112:113]
    v_pk_mul_f32 v[118:119], v[166:167], v[114:115]
    v_pk_fma_f32 v[116:117], v[198:199], v[114:115], v[116:117] neg_lo:[1,0,0] neg_hi:[1,0,0]
    v_pk_fma_f32 v[118:119], v[198:199], v[112:113], v[118:119]
    v_cvt_pk_bf16_f32 v230, v116, -v118
    v_cvt_pk_bf16_f32 v231, v117, -v119
    v_lshlrev_b32 v104, 16, v64
    v_lshlrev_b32 v105, 16, v65
    v_and_b32 v106, 0xffff0000, v64
    v_and_b32 v107, 0xffff0000, v65
    v_pk_mul_f32 v[108:109], v[168:169], v[104:105]
    v_pk_mul_f32 v[110:111], v[168:169], v[106:107]
    v_pk_fma_f32 v[108:109], v[200:201], v[106:107], v[108:109] neg_lo:[1,0,0] neg_hi:[1,0,0]
    v_pk_fma_f32 v[110:111], v[200:201], v[104:105], v[110:111]
    v_cvt_pk_bf16_f32 v232, v108, -v110
    v_cvt_pk_bf16_f32 v233, v109, -v111
    v_lshlrev_b32 v112, 16, v66
    v_lshlrev_b32 v113, 16, v67
    v_and_b32 v114, 0xffff0000, v66
    v_and_b32 v115, 0xffff0000, v67
    v_pk_mul_f32 v[116:117], v[170:171], v[112:113]
    v_pk_mul_f32 v[118:119], v[170:171], v[114:115]
    v_pk_fma_f32 v[116:117], v[202:203], v[114:115], v[116:117] neg_lo:[1,0,0] neg_hi:[1,0,0]
    v_pk_fma_f32 v[118:119], v[202:203], v[112:113], v[118:119]
    v_cvt_pk_bf16_f32 v234, v116, -v118
    v_cvt_pk_bf16_f32 v235, v117, -v119
    v_lshlrev_b32 v104, 16, v68
    v_lshlrev_b32 v105, 16, v69
    v_and_b32 v106, 0xffff0000, v68
    v_and_b32 v107, 0xffff0000, v69
    v_pk_mul_f32 v[108:109], v[172:173], v[104:105]
    v_pk_mul_f32 v[110:111], v[172:173], v[106:107]
    v_pk_fma_f32 v[108:109], v[204:205], v[106:107], v[108:109] neg_lo:[1,0,0] neg_hi:[1,0,0]
    v_pk_fma_f32 v[110:111], v[204:205], v[104:105], v[110:111]
    v_cvt_pk_bf16_f32 v236, v108, -v110
    v_cvt_pk_bf16_f32 v237, v109, -v111
    v_lshlrev_b32 v112, 16, v70
    v_lshlrev_b32 v113, 16, v71
    v_and_b32 v114, 0xffff0000, v70
    v_and_b32 v115, 0xffff0000, v71
    v_pk_mul_f32 v[116:117], v[174:175], v[112:113]
    v_pk_mul_f32 v[118:119], v[174:175], v[114:115]
    v_pk_fma_f32 v[116:117], v[206:207], v[114:115], v[116:117] neg_lo:[1,0,0] neg_hi:[1,0,0]
    v_pk_fma_f32 v[118:119], v[206:207], v[112:113], v[118:119]
    v_cvt_pk_bf16_f32 v238, v116, -v118
    v_cvt_pk_bf16_f32 v239, v117, -v119
    s_mul_i32 s40, s23, 8448
    buffer_load_dwordx4 v[40:43], v1, s[8:11], s40 offen offset:0 sc1
    buffer_load_dwordx4 v[44:47], v1, s[8:11], s40 offen offset:1024 sc1
    buffer_load_dwordx4 v[48:51], v1, s[8:11], s40 offen offset:2048 sc1
    buffer_load_dwordx4 v[52:55], v1, s[8:11], s40 offen offset:3072 sc1
    s_add_u32 s40, s40, 4096
    buffer_load_dwordx4 v[56:59], v1, s[8:11], s40 offen offset:0 sc1
    buffer_load_dwordx4 v[60:63], v1, s[8:11], s40 offen offset:1024 sc1
    buffer_load_dwordx4 v[64:67], v1, s[8:11], s40 offen offset:2048 sc1
    buffer_load_dwordx4 v[68:71], v1, s[8:11], s40 offen offset:3072 sc1
    ds_read_b128 v[104:107], v1 offset:8192
    ds_read_b128 v[108:111], v1 offset:9216
    ds_read_b128 v[112:115], v1 offset:10240
    ds_read_b128 v[116:119], v1 offset:11264
    ds_read_b128 v[120:123], v1 offset:12288
    ds_read_b128 v[124:127], v1 offset:13312
    ds_read_b128 v[128:131], v1 offset:14336
    ds_read_b128 v[132:135], v1 offset:15360
    s_waitcnt lgkmcnt(7)
    v_mfma_f32_32x32x16_bf16 v[144:159], v[208:211], v[104:107], 0
    ds_read_b128 v[104:107], v1 offset:24576
    s_waitcnt lgkmcnt(7)
    v_mfma_f32_32x32x16_bf16 v[144:159], v[212:215], v[108:111], v[144:159]
    ds_read_b128 v[108:111], v1 offset:25600
    s_waitcnt lgkmcnt(7)
    v_mfma_f32_32x32x16_bf16 v[144:159], v[216:219], v[112:115], v[144:159]
    ds_read_b128 v[112:115], v1 offset:26624
    s_waitcnt lgkmcnt(7)
    v_mfma_f32_32x32x16_bf16 v[144:159], v[220:223], v[116:119], v[144:159]
    ds_read_b128 v[116:119], v1 offset:27648
    s_waitcnt lgkmcnt(7)
    v_mfma_f32_32x32x16_bf16 v[144:159], v[224:227], v[120:123], v[144:159]
    ds_read_b128 v[120:123], v1 offset:28672
    s_waitcnt lgkmcnt(7)
    v_mfma_f32_32x32x16_bf16 v[144:159], v[228:231], v[124:127], v[144:159]
    ds_read_b128 v[124:127], v1 offset:29696
    s_waitcnt lgkmcnt(7)
    v_mfma_f32_32x32x16_bf16 v[144:159], v[232:235], v[128:131], v[144:159]
    ds_read_b128 v[128:131], v1 offset:30720
    s_waitcnt lgkmcnt(7)
    v_mfma_f32_32x32x16_bf16 v[144:159], v[236:239], v[132:135], v[144:159]
    ds_read_b128 v[132:135], v1 offset:31744
    s_waitcnt lgkmcnt(7)
    v_mfma_f32_32x32x16_bf16 v[176:191], v[208:211], v[104:107], 0
    ds_read_b128 v[104:107], v1 offset:16384
    s_waitcnt lgkmcnt(7)
    v_mfma_f32_32x32x16_bf16 v[176:191], v[212:215], v[108:111], v[176:191]
    ds_read_b128 v[108:111], v1 offset:17408
    s_waitcnt lgkmcnt(7)
    v_mfma_f32_32x32x16_bf16 v[176:191], v[216:219], v[112:115], v[176:191]
    ds_read_b128 v[112:115], v1 offset:18432
    s_waitcnt lgkmcnt(7)
    v_mfma_f32_32x32x16_bf16 v[176:191], v[220:223], v[116:119], v[176:191]
    ds_read_b128 v[116:119], v1 offset:19456
    s_waitcnt lgkmcnt(7)
    v_mfma_f32_32x32x16_bf16 v[176:191], v[224:227], v[120:123], v[176:191]
    ds_read_b128 v[120:123], v1 offset:20480
    s_waitcnt lgkmcnt(7)
    v_mfma_f32_32x32x16_bf16 v[176:191], v[228:231], v[124:127], v[176:191]
    ds_read_b128 v[124:127], v1 offset:21504
    s_waitcnt lgkmcnt(7)
    v_mfma_f32_32x32x16_bf16 v[176:191], v[232:235], v[128:131], v[176:191]
    ds_read_b128 v[128:131], v1 offset:22528
    s_waitcnt lgkmcnt(7)
    v_mfma_f32_32x32x16_bf16 v[176:191], v[236:239], v[132:135], v[176:191]
    ds_read_b128 v[132:135], v1 offset:23552
    s_waitcnt lgkmcnt(7)
    v_mfma_f32_32x32x16_bf16 v[160:175], v[208:211], v[104:107], 0
    ds_read_b128 v[104:107], v1 offset:32768
    s_waitcnt lgkmcnt(7)
    v_mfma_f32_32x32x16_bf16 v[160:175], v[212:215], v[108:111], v[160:175]
    ds_read_b128 v[108:111], v1 offset:33792
    s_waitcnt lgkmcnt(7)
    v_mfma_f32_32x32x16_bf16 v[160:175], v[216:219], v[112:115], v[160:175]
    ds_read_b128 v[112:115], v1 offset:34816
    s_waitcnt lgkmcnt(7)
    v_mfma_f32_32x32x16_bf16 v[160:175], v[220:223], v[116:119], v[160:175]
    ds_read_b128 v[116:119], v1 offset:35840
    s_waitcnt lgkmcnt(7)
    v_mfma_f32_32x32x16_bf16 v[160:175], v[224:227], v[120:123], v[160:175]
    ds_read_b128 v[120:123], v1 offset:36864
    s_waitcnt lgkmcnt(7)
    v_mfma_f32_32x32x16_bf16 v[160:175], v[228:231], v[124:127], v[160:175]
    ds_read_b128 v[124:127], v1 offset:37888
    s_waitcnt lgkmcnt(7)
    v_mfma_f32_32x32x16_bf16 v[160:175], v[232:235], v[128:131], v[160:175]
    ds_read_b128 v[128:131], v1 offset:38912
    s_waitcnt lgkmcnt(7)
    v_mfma_f32_32x32x16_bf16 v[160:175], v[236:239], v[132:135], v[160:175]
    ds_read_b128 v[132:135], v1 offset:39936
    s_waitcnt lgkmcnt(7)
    v_mfma_f32_32x32x16_bf16 v[192:207], v[208:211], v[104:107], 0
    s_waitcnt lgkmcnt(6)
    v_mfma_f32_32x32x16_bf16 v[192:207], v[212:215], v[108:111], v[192:207]
    s_waitcnt lgkmcnt(5)
    v_mfma_f32_32x32x16_bf16 v[192:207], v[216:219], v[112:115], v[192:207]
    s_waitcnt lgkmcnt(4)
    v_mfma_f32_32x32x16_bf16 v[192:207], v[220:223], v[116:119], v[192:207]
    s_waitcnt lgkmcnt(3)
    v_mfma_f32_32x32x16_bf16 v[192:207], v[224:227], v[120:123], v[192:207]
    s_waitcnt lgkmcnt(2)
    v_mfma_f32_32x32x16_bf16 v[192:207], v[228:231], v[124:127], v[192:207]
    s_waitcnt lgkmcnt(1)
    v_mfma_f32_32x32x16_bf16 v[192:207], v[232:235], v[128:131], v[192:207]
    s_waitcnt lgkmcnt(0)
    v_mfma_f32_32x32x16_bf16 v[192:207], v[236:239], v[132:135], v[192:207]
    ds_read_b128 v[112:115], v2 offset:16384
    ds_read_b128 v[116:119], v2 offset:17408
    ds_read_b128 v[120:123], v2 offset:18432
    ds_read_b128 v[124:127], v2 offset:19456
    s_waitcnt lgkmcnt(3)
    v_pk_mul_f32 v[104:105], v[144:145], v[112:113]
    v_pk_mul_f32 v[106:107], v[176:177], v[112:113]
    v_pk_fma_f32 v[104:105], v[176:177], v[114:115], v[104:105]
    v_pk_fma_f32 v[106:107], v[144:145], v[114:115], v[106:107] neg_lo:[1,0,0] neg_hi:[1,0,0]
    v_cvt_pk_bf16_f32 v208, v104, v106
    v_cvt_pk_bf16_f32 v209, v105, v107
    ds_read_b128 v[112:115], v2 offset:20480
    s_waitcnt lgkmcnt(3)
    v_pk_mul_f32 v[108:109], v[146:147], v[116:117]
    v_pk_mul_f32 v[110:111], v[178:179], v[116:117]
    v_pk_fma_f32 v[108:109], v[178:179], v[118:119], v[108:109]
    v_pk_fma_f32 v[110:111], v[146:147], v[118:119], v[110:111] neg_lo:[1,0,0] neg_hi:[1,0,0]
    v_cvt_pk_bf16_f32 v210, v108, v110
    v_cvt_pk_bf16_f32 v211, v109, v111
    ds_read_b128 v[116:119], v2 offset:21504
    s_waitcnt lgkmcnt(3)
    v_pk_mul_f32 v[104:105], v[148:149], v[120:121]
    v_pk_mul_f32 v[106:107], v[180:181], v[120:121]
    v_pk_fma_f32 v[104:105], v[180:181], v[122:123], v[104:105]
    v_pk_fma_f32 v[106:107], v[148:149], v[122:123], v[106:107] neg_lo:[1,0,0] neg_hi:[1,0,0]
    v_cvt_pk_bf16_f32 v212, v104, v106
    v_cvt_pk_bf16_f32 v213, v105, v107
    ds_read_b128 v[120:123], v2 offset:22528
    s_waitcnt lgkmcnt(3)
    v_pk_mul_f32 v[108:109], v[150:151], v[124:125]
    v_pk_mul_f32 v[110:111], v[182:183], v[124:125]
    v_pk_fma_f32 v[108:109], v[182:183], v[126:127], v[108:109]
    v_pk_fma_f32 v[110:111], v[150:151], v[126:127], v[110:111] neg_lo:[1,0,0] neg_hi:[1,0,0]
    v_cvt_pk_bf16_f32 v214, v108, v110
    v_cvt_pk_bf16_f32 v215, v109, v111
    ds_read_b128 v[124:127], v2 offset:23552
    s_waitcnt lgkmcnt(3)
    v_pk_mul_f32 v[104:105], v[152:153], v[112:113]
    v_pk_mul_f32 v[106:107], v[184:185], v[112:113]
    v_pk_fma_f32 v[104:105], v[184:185], v[114:115], v[104:105]
    v_pk_fma_f32 v[106:107], v[152:153], v[114:115], v[106:107] neg_lo:[1,0,0] neg_hi:[1,0,0]
    v_cvt_pk_bf16_f32 v216, v104, v106
    v_cvt_pk_bf16_f32 v217, v105, v107
    ds_read_b128 v[112:115], v2 offset:24576
    s_waitcnt lgkmcnt(3)
    v_pk_mul_f32 v[108:109], v[154:155], v[116:117]
    v_pk_mul_f32 v[110:111], v[186:187], v[116:117]
    v_pk_fma_f32 v[108:109], v[186:187], v[118:119], v[108:109]
    v_pk_fma_f32 v[110:111], v[154:155], v[118:119], v[110:111] neg_lo:[1,0,0] neg_hi:[1,0,0]
    v_cvt_pk_bf16_f32 v218, v108, v110
    v_cvt_pk_bf16_f32 v219, v109, v111
    ds_read_b128 v[116:119], v2 offset:25600
    s_waitcnt lgkmcnt(3)
    v_pk_mul_f32 v[104:105], v[156:157], v[120:121]
    v_pk_mul_f32 v[106:107], v[188:189], v[120:121]
    v_pk_fma_f32 v[104:105], v[188:189], v[122:123], v[104:105]
    v_pk_fma_f32 v[106:107], v[156:157], v[122:123], v[106:107] neg_lo:[1,0,0] neg_hi:[1,0,0]
    v_cvt_pk_bf16_f32 v220, v104, v106
    v_cvt_pk_bf16_f32 v221, v105, v107
    ds_read_b128 v[120:123], v2 offset:26624
    s_waitcnt lgkmcnt(3)
    v_pk_mul_f32 v[108:109], v[158:159], v[124:125]
    v_pk_mul_f32 v[110:111], v[190:191], v[124:125]
    v_pk_fma_f32 v[108:109], v[190:191], v[126:127], v[108:109]
    v_pk_fma_f32 v[110:111], v[158:159], v[126:127], v[110:111] neg_lo:[1,0,0] neg_hi:[1,0,0]
    v_cvt_pk_bf16_f32 v222, v108, v110
    v_cvt_pk_bf16_f32 v223, v109, v111
    ds_read_b128 v[124:127], v2 offset:27648
    s_waitcnt lgkmcnt(3)
    v_pk_mul_f32 v[104:105], v[160:161], v[112:113]
    v_pk_mul_f32 v[106:107], v[192:193], v[112:113]
    v_pk_fma_f32 v[104:105], v[192:193], v[114:115], v[104:105]
    v_pk_fma_f32 v[106:107], v[160:161], v[114:115], v[106:107] neg_lo:[1,0,0] neg_hi:[1,0,0]
    v_cvt_pk_bf16_f32 v224, v104, v106
    v_cvt_pk_bf16_f32 v225, v105, v107
    ds_read_b128 v[112:115], v2 offset:28672
    s_waitcnt lgkmcnt(3)
    v_pk_mul_f32 v[108:109], v[162:163], v[116:117]
    v_pk_mul_f32 v[110:111], v[194:195], v[116:117]
    v_pk_fma_f32 v[108:109], v[194:195], v[118:119], v[108:109]
    v_pk_fma_f32 v[110:111], v[162:163], v[118:119], v[110:111] neg_lo:[1,0,0] neg_hi:[1,0,0]
    v_cvt_pk_bf16_f32 v226, v108, v110
    v_cvt_pk_bf16_f32 v227, v109, v111
    ds_read_b128 v[116:119], v2 offset:29696
    s_waitcnt lgkmcnt(3)
    v_pk_mul_f32 v[104:105], v[164:165], v[120:121]
    v_pk_mul_f32 v[106:107], v[196:197], v[120:121]
    v_pk_fma_f32 v[104:105], v[196:197], v[122:123], v[104:105]
    v_pk_fma_f32 v[106:107], v[164:165], v[122:123], v[106:107] neg_lo:[1,0,0] neg_hi:[1,0,0]
    v_cvt_pk_bf16_f32 v228, v104, v106
    v_cvt_pk_bf16_f32 v229, v105, v107
    ds_read_b128 v[120:123], v2 offset:30720
    s_waitcnt lgkmcnt(3)
    v_pk_mul_f32 v[108:109], v[166:167], v[124:125]
    v_pk_mul_f32 v[110:111], v[198:199], v[124:125]
    v_pk_fma_f32 v[108:109], v[198:199], v[126:127], v[108:109]
    v_pk_fma_f32 v[110:111], v[166:167], v[126:127], v[110:111] neg_lo:[1,0,0] neg_hi:[1,0,0]
    v_cvt_pk_bf16_f32 v230, v108, v110
    v_cvt_pk_bf16_f32 v231, v109, v111
    ds_read_b128 v[124:127], v2 offset:31744
    s_waitcnt lgkmcnt(3)
    v_pk_mul_f32 v[104:105], v[168:169], v[112:113]
    v_pk_mul_f32 v[106:107], v[200:201], v[112:113]
    v_pk_fma_f32 v[104:105], v[200:201], v[114:115], v[104:105]
    v_pk_fma_f32 v[106:107], v[168:169], v[114:115], v[106:107] neg_lo:[1,0,0] neg_hi:[1,0,0]
    v_cvt_pk_bf16_f32 v232, v104, v106
    v_cvt_pk_bf16_f32 v233, v105, v107
    s_waitcnt lgkmcnt(2)
    v_pk_mul_f32 v[108:109], v[170:171], v[116:117]
    v_pk_mul_f32 v[110:111], v[202:203], v[116:117]
    v_pk_fma_f32 v[108:109], v[202:203], v[118:119], v[108:109]
    v_pk_fma_f32 v[110:111], v[170:171], v[118:119], v[110:111] neg_lo:[1,0,0] neg_hi:[1,0,0]
    v_cvt_pk_bf16_f32 v234, v108, v110
    v_cvt_pk_bf16_f32 v235, v109, v111
    s_waitcnt lgkmcnt(1)
    v_pk_mul_f32 v[104:105], v[172:173], v[120:121]
    v_pk_mul_f32 v[106:107], v[204:205], v[120:121]
    v_pk_fma_f32 v[104:105], v[204:205], v[122:123], v[104:105]
    v_pk_fma_f32 v[106:107], v[172:173], v[122:123], v[106:107] neg_lo:[1,0,0] neg_hi:[1,0,0]
    v_cvt_pk_bf16_f32 v236, v104, v106
    v_cvt_pk_bf16_f32 v237, v105, v107
    s_waitcnt lgkmcnt(0)
    v_pk_mul_f32 v[108:109], v[174:175], v[124:125]
    v_pk_mul_f32 v[110:111], v[206:207], v[124:125]
    v_pk_fma_f32 v[108:109], v[206:207], v[126:127], v[108:109]
    v_pk_fma_f32 v[110:111], v[174:175], v[126:127], v[110:111] neg_lo:[1,0,0] neg_hi:[1,0,0]
    v_cvt_pk_bf16_f32 v238, v108, v110
    v_cvt_pk_bf16_f32 v239, v109, v111
    v_mfma_f32_32x32x16_bf16 v[144:159], v[72:75], v[208:211], 0
    v_mfma_f32_32x32x16_bf16 v[144:159], v[76:79], v[212:215], v[144:159]
    v_mfma_f32_32x32x16_bf16 v[144:159], v[80:83], v[216:219], v[144:159]
    v_mfma_f32_32x32x16_bf16 v[144:159], v[84:87], v[220:223], v[144:159]
    v_mfma_f32_32x32x16_bf16 v[176:191], v[88:91], v[208:211], 0
    v_mfma_f32_32x32x16_bf16 v[176:191], v[92:95], v[212:215], v[176:191]
    v_mfma_f32_32x32x16_bf16 v[176:191], v[96:99], v[216:219], v[176:191]
    v_mfma_f32_32x32x16_bf16 v[176:191], v[100:103], v[220:223], v[176:191]
    v_mfma_f32_32x32x16_bf16 v[160:175], v[72:75], v[224:227], 0
    v_mfma_f32_32x32x16_bf16 v[160:175], v[76:79], v[228:231], v[160:175]
    v_mfma_f32_32x32x16_bf16 v[160:175], v[80:83], v[232:235], v[160:175]
    v_mfma_f32_32x32x16_bf16 v[160:175], v[84:87], v[236:239], v[160:175]
    v_mfma_f32_32x32x16_bf16 v[192:207], v[88:91], v[224:227], 0
    v_mfma_f32_32x32x16_bf16 v[192:207], v[92:95], v[228:231], v[192:207]
    v_mfma_f32_32x32x16_bf16 v[192:207], v[96:99], v[232:235], v[192:207]
    v_mfma_f32_32x32x16_bf16 v[192:207], v[100:103], v[236:239], v[192:207]
    s_and_b32 s40, s21, 511
    s_cmp_lg_u32 s40, 0
    s_cbranch_scc1 L_nosp_c
    s_mov_b32 s40, 0.5
    s_mov_b32 s41, 0.5
    v_pk_mul_f32 v[144:145], v[144:145], s[40:41]
    v_pk_mul_f32 v[146:147], v[146:147], s[40:41]
    v_pk_mul_f32 v[148:149], v[148:149], s[40:41]
    v_pk_mul_f32 v[150:151], v[150:151], s[40:41]
    v_pk_mul_f32 v[152:153], v[152:153], s[40:41]
    v_pk_mul_f32 v[154:155], v[154:155], s[40:41]
    v_pk_mul_f32 v[156:157], v[156:157], s[40:41]
    v_pk_mul_f32 v[158:159], v[158:159], s[40:41]
    v_pk_mul_f32 v[160:161], v[160:161], s[40:41]
    v_pk_mul_f32 v[162:163], v[162:163], s[40:41]
    v_pk_mul_f32 v[164:165], v[164:165], s[40:41]
    v_pk_mul_f32 v[166:167], v[166:167], s[40:41]
    v_pk_mul_f32 v[168:169], v[168:169], s[40:41]
    v_pk_mul_f32 v[170:171], v[170:171], s[40:41]
    v_pk_mul_f32 v[172:173], v[172:173], s[40:41]
    v_pk_mul_f32 v[174:175], v[174:175], s[40:41]
    v_pk_mul_f32 v[176:177], v[176:177], s[40:41]
    v_pk_mul_f32 v[178:179], v[178:179], s[40:41]
    v_pk_mul_f32 v[180:181], v[180:181], s[40:41]
    v_pk_mul_f32 v[182:183], v[182:183], s[40:41]
    v_pk_mul_f32 v[184:185], v[184:185], s[40:41]
    v_pk_mul_f32 v[186:187], v[186:187], s[40:41]
    v_pk_mul_f32 v[188:189], v[188:189], s[40:41]
    v_pk_mul_f32 v[190:191], v[190:191], s[40:41]
    v_pk_mul_f32 v[192:193], v[192:193], s[40:41]
    v_pk_mul_f32 v[194:195], v[194:195], s[40:41]
    v_pk_mul_f32 v[196:197], v[196:197], s[40:41]
    v_pk_mul_f32 v[198:199], v[198:199], s[40:41]
    v_pk_mul_f32 v[200:201], v[200:201], s[40:41]
    v_pk_mul_f32 v[202:203], v[202:203], s[40:41]
    v_pk_mul_f32 v[204:205], v[204:205], s[40:41]
    v_pk_mul_f32 v[206:207], v[206:207], s[40:41]
L_nosp_c:
    s_mul_i32 s40, s21, 8448
    v_cvt_pk_bf16_f32 v208, v144, v176
    v_cvt_pk_bf16_f32 v209, v145, v177
    v_cvt_pk_bf16_f32 v210, v146, v178
    v_cvt_pk_bf16_f32 v211, v147, v179
    buffer_store_dwordx4 v[208:211], v1, s[12:15], s40 offen offset:0 sc1
    v_cvt_pk_bf16_f32 v212, v148, v180
    v_cvt_pk_bf16_f32 v213, v149, v181
    v_cvt_pk_bf16_f32 v214, v150, v182
    v_cvt_pk_bf16_f32 v215, v151, v183
    buffer_store_dwordx4 v[212:215], v1, s[12:15], s40 offen offset:1024 sc1
    v_cvt_pk_bf16_f32 v216, v152, v184
    v_cvt_pk_bf16_f32 v217, v153, v185
    v_cvt_pk_bf16_f32 v218, v154, v186
    v_cvt_pk_bf16_f32 v219, v155, v187
    buffer_store_dwordx4 v[216:219], v1, s[12:15], s40 offen offset:2048 sc1
    v_cvt_pk_bf16_f32 v220, v156, v188
    v_cvt_pk_bf16_f32 v221, v157, v189
    v_cvt_pk_bf16_f32 v222, v158, v190
    v_cvt_pk_bf16_f32 v223, v159, v191
    buffer_store_dwordx4 v[220:223], v1, s[12:15], s40 offen offset:3072 sc1
    v_cvt_pk_bf16_f32 v224, v160, v192
    v_cvt_pk_bf16_f32 v225, v161, v193
    v_cvt_pk_bf16_f32 v226, v162, v194
    v_cvt_pk_bf16_f32 v227, v163, v195
    s_add_u32 s40, s40, 4096
    buffer_store_dwordx4 v[224:227], v1, s[12:15], s40 offen offset:0 sc1
    v_cvt_pk_bf16_f32 v228, v164, v196
    v_cvt_pk_bf16_f32 v229, v165, v197
    v_cvt_pk_bf16_f32 v230, v166, v198
    v_cvt_pk_bf16_f32 v231, v167, v199
    buffer_store_dwordx4 v[228:231], v1, s[12:15], s40 offen offset:1024 sc1
    v_cvt_pk_bf16_f32 v232, v168, v200
    v_cvt_pk_bf16_f32 v233, v169, v201
    v_cvt_pk_bf16_f32 v234, v170, v202
    v_cvt_pk_bf16_f32 v235, v171, v203
    buffer_store_dwordx4 v[232:235], v1, s[12:15], s40 offen offset:2048 sc1
    v_cvt_pk_bf16_f32 v236, v172, v204
    v_cvt_pk_bf16_f32 v237, v173, v205
    v_cvt_pk_bf16_f32 v238, v174, v206
    v_cvt_pk_bf16_f32 v239, v175, v207
    buffer_store_dwordx4 v[236:239], v1, s[12:15], s40 offen offset:3072 sc1
    s_add_u32 s21, s21, 256
    s_cmp_lt_u32 s21, 513
    s_cbranch_scc1 L_col_c
L_colend:
    s_branch L_g2_entry
L_g2_entry:
    s_waitcnt vmcnt(0)
    s_barrier
    s_cmp_lg_u32 s20, 0
    s_cbranch_scc1 L_nosigd
    s_add_u32 s96, s84, 0x2c30000
    s_addc_u32 s97, s85, 0
    s_and_b32 s97, s97, 0xffff
    s_mov_b32 s98, 0x3000
    s_mov_b32 s99, 0x20000
    s_lshr_b32 s40, s2, 3
    s_lshl_b32 s40, s40, 7
    s_and_b32 s41, s2, 7
    s_lshl_b32 s41, s41, 2
    s_add_u32 s40, s40, s41
    s_add_u32 s40, s40, 8192
    v_mov_b32 v2, s40
    v_mov_b32 v3, 1
    s_mov_b64 exec, 1
    buffer_store_dword v3, v2, s[96:99], 0 offen sc1
    s_mov_b64 exec, -1
L_nosigd:
    s_load_dwordx4 s[16:19], s[0:1], 40
    s_load_dwordx4 s[84:87], s[0:1], 56
    s_load_dwordx2 s[66:67], s[0:1], 0
    s_and_b32 s21, s2, 7
    s_lshr_b32 s22, s2, 3
    s_lshr_b32 s25, s21, 2
    s_and_b32 s23, s21, 3
    s_lshl_b32 s23, s23, 2
    s_and_b32 s24, s22, 3
    s_add_u32 s23, s23, s24
    s_lshr_b32 s24, s22, 2
    s_mul_i32 s26, s23, 917504
    s_mul_i32 s40, s25, 3584
    s_add_u32 s26, s26, s40
    s_mul_i32 s27, s24, 256
    s_mul_i32 s40, s25, 3670016
    s_add_u32 s27, s27, s40
    s_lshr_b32 s88, s23, 1
    s_lshl_b32 s89, s25, 4
    s_and_b32 s40, s23, 1
    s_lshl_b32 s40, s40, 3
    s_add_u32 s89, s89, s40
    s_add_u32 s89, s89, s24
    s_waitcnt lgkmcnt(0)
    s_mov_b32 s64, s86
    s_mov_b32 s65, s87
    s_add_u32 s4, s64, 0x400000
    s_addc_u32 s5, s65, 0
    s_and_b32 s5, s5, 0xffff
    s_mov_b32 s6, 0xe00000
    s_mov_b32 s7, 0x20000
    s_mov_b32 s8, s16
    s_and_b32 s9, s17, 0xffff
    s_mov_b32 s10, 0x700000
    s_mov_b32 s11, 0x20000
    s_mov_b32 s43, 32768
    s_mov_b32 s44, 0xfffe8000
    s_mov_b32 s80, s84
    s_and_b32 s81, s85, 0xffff
    s_mov_b32 s82, 0x100
    s_mov_b32 s83, 0x20000
    s_cmp_ge_u32 s20, 4
    s_cbranch_scc1 L_loader_g2
    s_mov_b32 s12, s18
    s_and_b32 s13, s19, 0xffff
    s_mov_b32 s14, 0x400000
    s_mov_b32 s15, 0x20000
    s_mov_b32 s68, s66
    s_and_b32 s69, s67, 0xffff
    s_mov_b32 s70, 0x400000
    s_mov_b32 s71, 0x20000
    s_add_u32 s72, s64, 0x2000000
    s_addc_u32 s73, s65, 0
    s_and_b32 s73, s73, 0xffff
    s_mov_b32 s74, 0x400000
    s_mov_b32 s75, 0x20000
    s_add_u32 s76, s64, 0x2400000
    s_addc_u32 s77, s65, 0
    s_and_b32 s77, s77, 0xffff
    s_mov_b32 s78, 0x800000
    s_mov_b32 s79, 0x20000
    s_and_b32 s37, s20, 1
    s_lshr_b32 s36, s20, 1
    v_lshlrev_b32 v6, 4, v0
    v_and_b32 v2, 15, v0
    s_mul_i32 s40, s23, 128
    s_mul_i32 s41, s36, 64
    s_add_u32 s40, s40, s41
    s_lshl_b32 s41, s25, 5
    s_add_u32 s40, s40, s41
    v_add_u32 v2, s40, v2
    v_lshlrev_b32 v5, 11, v2
    v_lshrrev_b32 v2, 4, v0
    v_and_b32 v3, 1, v2
    v_lshl_add_u32 v5, v3, 5, v5
    v_lshrrev_b32 v2, 5, v0
    v_lshl_add_u32 v5, v2, 4, v5
    s_mul_i32 s40, s37, 128
    s_mul_i32 s41, s24, 256
    s_add_u32 s40, s40, s41
    v_add_u32 v5, s40, v5
    v_and_b32 v1, 15, v0
    s_mul_i32 s40, s36, 64
    v_add_u32 v1, s40, v1
    v_lshrrev_b32 v2, 1, v1
    v_and_b32 v2, 7, v2
    v_lshrrev_b32 v3, 4, v0
    v_xor_b32 v2, v2, v3
    v_lshlrev_b32 v1, 7, v1
    v_xor_b32 v3, 0, v2
    v_lshl_add_u32 v7, v3, 4, v1
    v_xor_b32 v3, 4, v2
    v_lshl_add_u32 v8, v3, 4, v1
    v_lshrrev_b32 v1, 2, v0
    v_and_b32 v1, 3, v1
    v_lshrrev_b32 v3, 4, v0
    v_lshl_add_u32 v1, v3, 3, v1
    v_and_b32 v2, 3, v1
    v_lshrrev_b32 v4, 1, v1
    v_and_b32 v4, 4, v4
    v_or_b32 v2, v2, v4
    v_lshlrev_b32 v2, 1, v2
    s_mov_b32 s41, 256
    v_mul_lo_u32 v1, v1, s41
    v_and_b32 v3, 1, v0
    v_lshl_add_u32 v1, v3, 3, v1
    v_add_u32 v1, 16384, v1
    v_lshrrev_b32 v3, 1, v0
    v_and_b32 v3, 1, v3
    s_mul_i32 s40, s37, 8
    s_add_u32 s40, s40, 0
    v_add_u32 v4, s40, v3
    v_xor_b32 v4, v4, v2
    v_lshl_add_u32 v9, v4, 4, v1
    s_mul_i32 s40, s37, 8
    s_add_u32 s40, s40, 2
    v_add_u32 v4, s40, v3
    v_xor_b32 v4, v4, v2
    v_lshl_add_u32 v10, v4, 4, v1
    s_mul_i32 s40, s37, 8
    s_add_u32 s40, s40, 4
    v_add_u32 v4, s40, v3
    v_xor_b32 v4, v4, v2
    v_lshl_add_u32 v11, v4, 4, v1
    s_mul_i32 s40, s37, 8
    s_add_u32 s40, s40, 6
    v_add_u32 v4, s40, v3
    v_xor_b32 v4, v4, v2
    v_lshl_add_u32 v12, v4, 4, v1
    v_add_u32 v13, 65536, v7
    v_add_u32 v14, 65536, v8
    v_add_u32 v15, 65536, v9
    v_add_u32 v16, 65536, v10
    v_add_u32 v17, 65536, v11
    v_add_u32 v18, 65536, v12
    v_mov_b32 v20, 0
    v_mov_b32 v21, 0
    v_mov_b32 v22, 0
    v_mov_b32 v23, 0
    v_mov_b32 v24, 0
    v_mov_b32 v25, 0
    v_mov_b32 v26, 0
    v_mov_b32 v27, 0
    v_mov_b32 v28, 0
    v_mov_b32 v29, 0
    v_mov_b32 v30, 0
    v_mov_b32 v31, 0
    v_mov_b32 v32, 0
    v_mov_b32 v33, 0
    v_mov_b32 v34, 0
    v_mov_b32 v35, 0
    v_mov_b32 v36, 0
    v_mov_b32 v37, 0
    v_mov_b32 v38, 0
    v_mov_b32 v39, 0
    v_mov_b32 v40, 0
    v_mov_b32 v41, 0
    v_mov_b32 v42, 0
    v_mov_b32 v43, 0
    v_mov_b32 v44, 0
    v_mov_b32 v45, 0
    v_mov_b32 v46, 0
    v_mov_b32 v47, 0
    v_mov_b32 v48, 0
    v_mov_b32 v49, 0
    v_mov_b32 v50, 0
    v_mov_b32 v51, 0
    v_mov_b32 v52, 0
    v_mov_b32 v53, 0
    v_mov_b32 v54, 0
    v_mov_b32 v55, 0
    v_mov_b32 v56, 0
    v_mov_b32 v57, 0
    v_mov_b32 v58, 0
    v_mov_b32 v59, 0
    v_mov_b32 v60, 0
    v_mov_b32 v61, 0
    v_mov_b32 v62, 0
    v_mov_b32 v63, 0
    v_mov_b32 v64, 0
    v_mov_b32 v65, 0
    v_mov_b32 v66, 0
    v_mov_b32 v67, 0
    v_mov_b32 v68, 0
    v_mov_b32 v69, 0
    v_mov_b32 v70, 0
    v_mov_b32 v71, 0
    v_mov_b32 v72, 0
    v_mov_b32 v73, 0
    v_mov_b32 v74, 0
    v_mov_b32 v75, 0
    v_mov_b32 v76, 0
    v_mov_b32 v77, 0
    v_mov_b32 v78, 0
    v_mov_b32 v79, 0
    v_mov_b32 v80, 0
    v_mov_b32 v81, 0
    v_mov_b32 v82, 0
    v_mov_b32 v83, 0
    s_lshl_b32 s40, s88, 2
    s_add_u32 s40, s40, s20
    s_lshl_b32 s40, s40, 6
    s_lshl_b32 s41, s89, 1
    s_add_u32 s40, s40, s41
    s_lshl_b32 s90, s40, 11
    s_add_u32 s91, s90, 2048
    s_lshl_b32 s40, s20, 12
    s_add_u32 s40, s40, 131072
    v_add_u32 v196, s40, v6
    s_barrier
    s_lshl_b32 s40, s23, 3
    s_add_u32 s40, s40, s24
    s_lshl_b32 s40, s40, 3
    s_add_u32 s40, s40, s20
    s_lshl_b32 s41, s25, 2
    s_add_u32 s38, s40, s41
    s_lshl_b32 s38, s38, 13
    s_xor_b32 s39, s38, 0x8000
    v_mov_b32 v148, -1
    v_mov_b32 v149, -1
    v_mov_b32 v150, -1
    v_mov_b32 v151, -1
    s_mov_b32 s96, s38
    s_barrier
    ds_read_b128 v[116:119], v7 offset:0
    ds_read_b64_tr_b16 v[84:85], v9 offset:0
    ds_read_b64_tr_b16 v[86:87], v9 offset:1024
    ds_read_b64_tr_b16 v[88:89], v10 offset:0
    ds_read_b64_tr_b16 v[90:91], v10 offset:1024
    ds_read_b64_tr_b16 v[92:93], v11 offset:0
    ds_read_b64_tr_b16 v[94:95], v11 offset:1024
    ds_read_b64_tr_b16 v[96:97], v12 offset:0
    ds_read_b64_tr_b16 v[98:99], v12 offset:1024
    ds_read_b128 v[120:123], v7 offset:2048
    ds_read_b128 v[124:127], v7 offset:4096
    ds_read_b128 v[128:131], v7 offset:6144
    s_waitcnt lgkmcnt(0)
    s_mov_b32 s32, 0
L_cons_g2:
    s_setprio 3
    s_waitcnt lgkmcnt(9)
    v_mfma_f32_16x16x32_bf16 v[20:23], v[84:87], v[116:119], v[20:23]
    ds_read_b128 v[132:135], v8 offset:0
    s_waitcnt lgkmcnt(8)
    v_mfma_f32_16x16x32_bf16 v[24:27], v[88:91], v[116:119], v[24:27]
    ds_read_b64_tr_b16 v[100:101], v9 offset:8192
    s_waitcnt lgkmcnt(7)
    v_mfma_f32_16x16x32_bf16 v[28:31], v[92:95], v[116:119], v[28:31]
    ds_read_b64_tr_b16 v[102:103], v9 offset:9216
    s_waitcnt lgkmcnt(6)
    v_mfma_f32_16x16x32_bf16 v[32:35], v[96:99], v[116:119], v[32:35]
    ds_read_b64_tr_b16 v[104:105], v10 offset:8192
    s_waitcnt lgkmcnt(6)
    v_mfma_f32_16x16x32_bf16 v[36:39], v[84:87], v[120:123], v[36:39]
    ds_read_b64_tr_b16 v[106:107], v10 offset:9216
    v_mfma_f32_16x16x32_bf16 v[40:43], v[88:91], v[120:123], v[40:43]
    ds_read_b64_tr_b16 v[108:109], v11 offset:8192
    v_mfma_f32_16x16x32_bf16 v[44:47], v[92:95], v[120:123], v[44:47]
    ds_read_b64_tr_b16 v[110:111], v11 offset:9216
    v_mfma_f32_16x16x32_bf16 v[48:51], v[96:99], v[120:123], v[48:51]
    ds_read_b64_tr_b16 v[112:113], v12 offset:8192
    s_waitcnt lgkmcnt(9)
    v_mfma_f32_16x16x32_bf16 v[52:55], v[84:87], v[124:127], v[52:55]
    ds_read_b64_tr_b16 v[114:115], v12 offset:9216
    v_mfma_f32_16x16x32_bf16 v[56:59], v[88:91], v[124:127], v[56:59]
    ds_read_b128 v[136:139], v8 offset:2048
    v_mfma_f32_16x16x32_bf16 v[60:63], v[92:95], v[124:127], v[60:63]
    ds_read_b128 v[140:143], v8 offset:4096
    v_mfma_f32_16x16x32_bf16 v[64:67], v[96:99], v[124:127], v[64:67]
    ds_read_b128 v[144:147], v8 offset:6144
    s_waitcnt lgkmcnt(12)
    v_mfma_f32_16x16x32_bf16 v[68:71], v[84:87], v[128:131], v[68:71]
    v_mfma_f32_16x16x32_bf16 v[72:75], v[88:91], v[128:131], v[72:75]
    v_mfma_f32_16x16x32_bf16 v[76:79], v[92:95], v[128:131], v[76:79]
    v_mfma_f32_16x16x32_bf16 v[80:83], v[96:99], v[128:131], v[80:83]
    s_waitcnt lgkmcnt(9)
    v_mfma_f32_16x16x32_bf16 v[20:23], v[100:103], v[132:135], v[20:23]
    s_waitcnt lgkmcnt(7)
    v_mfma_f32_16x16x32_bf16 v[24:27], v[104:107], v[132:135], v[24:27]
    s_waitcnt lgkmcnt(5)
    v_mfma_f32_16x16x32_bf16 v[28:31], v[108:111], v[132:135], v[28:31]
    s_waitcnt lgkmcnt(3)
    v_mfma_f32_16x16x32_bf16 v[32:35], v[112:115], v[132:135], v[32:35]
    s_waitcnt lgkmcnt(2)
    v_mfma_f32_16x16x32_bf16 v[36:39], v[100:103], v[136:139], v[36:39]
    v_mfma_f32_16x16x32_bf16 v[40:43], v[104:107], v[136:139], v[40:43]
    s_waitcnt lgkmcnt(0)
    s_cmp_eq_u32 s32, 3
    s_cbranch_scc1 L_oolb12_g2
    s_barrier
L_retb12_g2:
    v_mfma_f32_16x16x32_bf16 v[44:47], v[108:111], v[136:139], v[44:47]
    ds_read_b128 v[116:119], v7 offset:32768
    ds_read_b64_tr_b16 v[84:85], v9 offset:32768
    v_mfma_f32_16x16x32_bf16 v[48:51], v[112:115], v[136:139], v[48:51]
    ds_read_b64_tr_b16 v[86:87], v9 offset:33792
    ds_read_b64_tr_b16 v[88:89], v10 offset:32768
    v_mfma_f32_16x16x32_bf16 v[52:55], v[100:103], v[140:143], v[52:55]
    ds_read_b64_tr_b16 v[90:91], v10 offset:33792
    ds_read_b64_tr_b16 v[92:93], v11 offset:32768
    v_mfma_f32_16x16x32_bf16 v[56:59], v[104:107], v[140:143], v[56:59]
    ds_read_b64_tr_b16 v[94:95], v11 offset:33792
    ds_read_b64_tr_b16 v[96:97], v12 offset:32768
    v_mfma_f32_16x16x32_bf16 v[60:63], v[108:111], v[140:143], v[60:63]
    ds_read_b64_tr_b16 v[98:99], v12 offset:33792
    ds_read_b128 v[120:123], v7 offset:34816
    v_mfma_f32_16x16x32_bf16 v[64:67], v[112:115], v[140:143], v[64:67]
    ds_read_b128 v[124:127], v7 offset:36864
    ds_read_b128 v[128:131], v7 offset:38912
    v_mfma_f32_16x16x32_bf16 v[68:71], v[100:103], v[144:147], v[68:71]
    v_mfma_f32_16x16x32_bf16 v[72:75], v[104:107], v[144:147], v[72:75]
    v_mfma_f32_16x16x32_bf16 v[76:79], v[108:111], v[144:147], v[76:79]
    v_mfma_f32_16x16x32_bf16 v[80:83], v[112:115], v[144:147], v[80:83]
    s_waitcnt lgkmcnt(9)
    v_mfma_f32_16x16x32_bf16 v[20:23], v[84:87], v[116:119], v[20:23]
    ds_read_b128 v[132:135], v8 offset:32768
    s_waitcnt lgkmcnt(8)
    v_mfma_f32_16x16x32_bf16 v[24:27], v[88:91], v[116:119], v[24:27]
    ds_read_b64_tr_b16 v[100:101], v9 offset:40960
    s_waitcnt lgkmcnt(7)
    v_mfma_f32_16x16x32_bf16 v[28:31], v[92:95], v[116:119], v[28:31]
    ds_read_b64_tr_b16 v[102:103], v9 offset:41984
    s_waitcnt lgkmcnt(6)
    v_mfma_f32_16x16x32_bf16 v[32:35], v[96:99], v[116:119], v[32:35]
    ds_read_b64_tr_b16 v[104:105], v10 offset:40960
    s_waitcnt lgkmcnt(6)
    v_mfma_f32_16x16x32_bf16 v[36:39], v[84:87], v[120:123], v[36:39]
    ds_read_b64_tr_b16 v[106:107], v10 offset:41984
    v_mfma_f32_16x16x32_bf16 v[40:43], v[88:91], v[120:123], v[40:43]
    ds_read_b64_tr_b16 v[108:109], v11 offset:40960
    v_mfma_f32_16x16x32_bf16 v[44:47], v[92:95], v[120:123], v[44:47]
    ds_read_b64_tr_b16 v[110:111], v11 offset:41984
    v_mfma_f32_16x16x32_bf16 v[48:51], v[96:99], v[120:123], v[48:51]
    ds_read_b64_tr_b16 v[112:113], v12 offset:40960
    s_waitcnt lgkmcnt(9)
    v_mfma_f32_16x16x32_bf16 v[52:55], v[84:87], v[124:127], v[52:55]
    ds_read_b64_tr_b16 v[114:115], v12 offset:41984
    v_mfma_f32_16x16x32_bf16 v[56:59], v[88:91], v[124:127], v[56:59]
    ds_read_b128 v[136:139], v8 offset:34816
    v_mfma_f32_16x16x32_bf16 v[60:63], v[92:95], v[124:127], v[60:63]
    ds_read_b128 v[140:143], v8 offset:36864
    v_mfma_f32_16x16x32_bf16 v[64:67], v[96:99], v[124:127], v[64:67]
    ds_read_b128 v[144:147], v8 offset:38912
    s_waitcnt lgkmcnt(12)
    v_mfma_f32_16x16x32_bf16 v[68:71], v[84:87], v[128:131], v[68:71]
    v_mfma_f32_16x16x32_bf16 v[72:75], v[88:91], v[128:131], v[72:75]
    v_mfma_f32_16x16x32_bf16 v[76:79], v[92:95], v[128:131], v[76:79]
    v_mfma_f32_16x16x32_bf16 v[80:83], v[96:99], v[128:131], v[80:83]
    s_waitcnt lgkmcnt(9)
    v_mfma_f32_16x16x32_bf16 v[20:23], v[100:103], v[132:135], v[20:23]
    s_waitcnt lgkmcnt(7)
    v_mfma_f32_16x16x32_bf16 v[24:27], v[104:107], v[132:135], v[24:27]
    s_waitcnt lgkmcnt(5)
    v_mfma_f32_16x16x32_bf16 v[28:31], v[108:111], v[132:135], v[28:31]
    s_waitcnt lgkmcnt(3)
    v_mfma_f32_16x16x32_bf16 v[32:35], v[112:115], v[132:135], v[32:35]
    s_waitcnt lgkmcnt(2)
    v_mfma_f32_16x16x32_bf16 v[36:39], v[100:103], v[136:139], v[36:39]
    v_mfma_f32_16x16x32_bf16 v[40:43], v[104:107], v[136:139], v[40:43]
    s_waitcnt lgkmcnt(0)
    s_barrier
    v_mfma_f32_16x16x32_bf16 v[44:47], v[108:111], v[136:139], v[44:47]
    ds_read_b128 v[116:119], v13 offset:0
    ds_read_b64_tr_b16 v[84:85], v15 offset:0
    v_mfma_f32_16x16x32_bf16 v[48:51], v[112:115], v[136:139], v[48:51]
    ds_read_b64_tr_b16 v[86:87], v15 offset:1024
    ds_read_b64_tr_b16 v[88:89], v16 offset:0
    v_mfma_f32_16x16x32_bf16 v[52:55], v[100:103], v[140:143], v[52:55]
    ds_read_b64_tr_b16 v[90:91], v16 offset:1024
    ds_read_b64_tr_b16 v[92:93], v17 offset:0
    v_mfma_f32_16x16x32_bf16 v[56:59], v[104:107], v[140:143], v[56:59]
    ds_read_b64_tr_b16 v[94:95], v17 offset:1024
    ds_read_b64_tr_b16 v[96:97], v18 offset:0
    v_mfma_f32_16x16x32_bf16 v[60:63], v[108:111], v[140:143], v[60:63]
    ds_read_b64_tr_b16 v[98:99], v18 offset:1024
    ds_read_b128 v[120:123], v13 offset:2048
    v_mfma_f32_16x16x32_bf16 v[64:67], v[112:115], v[140:143], v[64:67]
    ds_read_b128 v[124:127], v13 offset:4096
    ds_read_b128 v[128:131], v13 offset:6144
    v_mfma_f32_16x16x32_bf16 v[68:71], v[100:103], v[144:147], v[68:71]
    v_mfma_f32_16x16x32_bf16 v[72:75], v[104:107], v[144:147], v[72:75]
    v_mfma_f32_16x16x32_bf16 v[76:79], v[108:111], v[144:147], v[76:79]
    v_mfma_f32_16x16x32_bf16 v[80:83], v[112:115], v[144:147], v[80:83]
    s_waitcnt lgkmcnt(9)
    v_mfma_f32_16x16x32_bf16 v[20:23], v[84:87], v[116:119], v[20:23]
    ds_read_b128 v[132:135], v14 offset:0
    s_waitcnt lgkmcnt(8)
    v_mfma_f32_16x16x32_bf16 v[24:27], v[88:91], v[116:119], v[24:27]
    ds_read_b64_tr_b16 v[100:101], v15 offset:8192
    s_waitcnt lgkmcnt(7)
    v_mfma_f32_16x16x32_bf16 v[28:31], v[92:95], v[116:119], v[28:31]
    ds_read_b64_tr_b16 v[102:103], v15 offset:9216
    s_waitcnt lgkmcnt(6)
    v_mfma_f32_16x16x32_bf16 v[32:35], v[96:99], v[116:119], v[32:35]
    ds_read_b64_tr_b16 v[104:105], v16 offset:8192
    s_waitcnt lgkmcnt(6)
    v_mfma_f32_16x16x32_bf16 v[36:39], v[84:87], v[120:123], v[36:39]
    ds_read_b64_tr_b16 v[106:107], v16 offset:9216
    v_mfma_f32_16x16x32_bf16 v[40:43], v[88:91], v[120:123], v[40:43]
    ds_read_b64_tr_b16 v[108:109], v17 offset:8192
    v_mfma_f32_16x16x32_bf16 v[44:47], v[92:95], v[120:123], v[44:47]
    ds_read_b64_tr_b16 v[110:111], v17 offset:9216
    v_mfma_f32_16x16x32_bf16 v[48:51], v[96:99], v[120:123], v[48:51]
    ds_read_b64_tr_b16 v[112:113], v18 offset:8192
    s_waitcnt lgkmcnt(9)
    v_mfma_f32_16x16x32_bf16 v[52:55], v[84:87], v[124:127], v[52:55]
    ds_read_b64_tr_b16 v[114:115], v18 offset:9216
    v_mfma_f32_16x16x32_bf16 v[56:59], v[88:91], v[124:127], v[56:59]
    ds_read_b128 v[136:139], v14 offset:2048
    v_mfma_f32_16x16x32_bf16 v[60:63], v[92:95], v[124:127], v[60:63]
    ds_read_b128 v[140:143], v14 offset:4096
    v_mfma_f32_16x16x32_bf16 v[64:67], v[96:99], v[124:127], v[64:67]
    ds_read_b128 v[144:147], v14 offset:6144
    s_waitcnt lgkmcnt(12)
    v_mfma_f32_16x16x32_bf16 v[68:71], v[84:87], v[128:131], v[68:71]
    v_mfma_f32_16x16x32_bf16 v[72:75], v[88:91], v[128:131], v[72:75]
    v_mfma_f32_16x16x32_bf16 v[76:79], v[92:95], v[128:131], v[76:79]
    v_mfma_f32_16x16x32_bf16 v[80:83], v[96:99], v[128:131], v[80:83]
    s_waitcnt lgkmcnt(9)
    v_mfma_f32_16x16x32_bf16 v[20:23], v[100:103], v[132:135], v[20:23]
    s_waitcnt lgkmcnt(7)
    v_mfma_f32_16x16x32_bf16 v[24:27], v[104:107], v[132:135], v[24:27]
    s_waitcnt lgkmcnt(5)
    v_mfma_f32_16x16x32_bf16 v[28:31], v[108:111], v[132:135], v[28:31]
    s_waitcnt lgkmcnt(3)
    v_mfma_f32_16x16x32_bf16 v[32:35], v[112:115], v[132:135], v[32:35]
    s_waitcnt lgkmcnt(2)
    v_mfma_f32_16x16x32_bf16 v[36:39], v[100:103], v[136:139], v[36:39]
    v_mfma_f32_16x16x32_bf16 v[40:43], v[104:107], v[136:139], v[40:43]
    s_waitcnt lgkmcnt(0)
    s_cmp_eq_u32 s32, 4
    s_cbranch_scc1 L_oolb18_g2
    s_barrier
L_retb18_g2:
    v_mfma_f32_16x16x32_bf16 v[44:47], v[108:111], v[136:139], v[44:47]
    ds_read_b128 v[116:119], v13 offset:32768
    ds_read_b64_tr_b16 v[84:85], v15 offset:32768
    v_mfma_f32_16x16x32_bf16 v[48:51], v[112:115], v[136:139], v[48:51]
    ds_read_b64_tr_b16 v[86:87], v15 offset:33792
    ds_read_b64_tr_b16 v[88:89], v16 offset:32768
    v_mfma_f32_16x16x32_bf16 v[52:55], v[100:103], v[140:143], v[52:55]
    ds_read_b64_tr_b16 v[90:91], v16 offset:33792
    ds_read_b64_tr_b16 v[92:93], v17 offset:32768
    v_mfma_f32_16x16x32_bf16 v[56:59], v[104:107], v[140:143], v[56:59]
    ds_read_b64_tr_b16 v[94:95], v17 offset:33792
    ds_read_b64_tr_b16 v[96:97], v18 offset:32768
    v_mfma_f32_16x16x32_bf16 v[60:63], v[108:111], v[140:143], v[60:63]
    ds_read_b64_tr_b16 v[98:99], v18 offset:33792
    ds_read_b128 v[120:123], v13 offset:34816
    v_mfma_f32_16x16x32_bf16 v[64:67], v[112:115], v[140:143], v[64:67]
    ds_read_b128 v[124:127], v13 offset:36864
    ds_read_b128 v[128:131], v13 offset:38912
    v_mfma_f32_16x16x32_bf16 v[68:71], v[100:103], v[144:147], v[68:71]
    v_mfma_f32_16x16x32_bf16 v[72:75], v[104:107], v[144:147], v[72:75]
    v_mfma_f32_16x16x32_bf16 v[76:79], v[108:111], v[144:147], v[76:79]
    v_mfma_f32_16x16x32_bf16 v[80:83], v[112:115], v[144:147], v[80:83]
    s_waitcnt lgkmcnt(9)
    v_mfma_f32_16x16x32_bf16 v[20:23], v[84:87], v[116:119], v[20:23]
    ds_read_b128 v[132:135], v14 offset:32768
    s_waitcnt lgkmcnt(8)
    v_mfma_f32_16x16x32_bf16 v[24:27], v[88:91], v[116:119], v[24:27]
    ds_read_b64_tr_b16 v[100:101], v15 offset:40960
    s_waitcnt lgkmcnt(7)
    v_mfma_f32_16x16x32_bf16 v[28:31], v[92:95], v[116:119], v[28:31]
    ds_read_b64_tr_b16 v[102:103], v15 offset:41984
    s_waitcnt lgkmcnt(6)
    v_mfma_f32_16x16x32_bf16 v[32:35], v[96:99], v[116:119], v[32:35]
    ds_read_b64_tr_b16 v[104:105], v16 offset:40960
    s_waitcnt lgkmcnt(6)
    v_mfma_f32_16x16x32_bf16 v[36:39], v[84:87], v[120:123], v[36:39]
    ds_read_b64_tr_b16 v[106:107], v16 offset:41984
    v_mfma_f32_16x16x32_bf16 v[40:43], v[88:91], v[120:123], v[40:43]
    ds_read_b64_tr_b16 v[108:109], v17 offset:40960
    v_mfma_f32_16x16x32_bf16 v[44:47], v[92:95], v[120:123], v[44:47]
    ds_read_b64_tr_b16 v[110:111], v17 offset:41984
    v_mfma_f32_16x16x32_bf16 v[48:51], v[96:99], v[120:123], v[48:51]
    ds_read_b64_tr_b16 v[112:113], v18 offset:40960
    s_waitcnt lgkmcnt(9)
    v_mfma_f32_16x16x32_bf16 v[52:55], v[84:87], v[124:127], v[52:55]
    ds_read_b64_tr_b16 v[114:115], v18 offset:41984
    v_mfma_f32_16x16x32_bf16 v[56:59], v[88:91], v[124:127], v[56:59]
    ds_read_b128 v[136:139], v14 offset:34816
    v_mfma_f32_16x16x32_bf16 v[60:63], v[92:95], v[124:127], v[60:63]
    ds_read_b128 v[140:143], v14 offset:36864
    v_mfma_f32_16x16x32_bf16 v[64:67], v[96:99], v[124:127], v[64:67]
    ds_read_b128 v[144:147], v14 offset:38912
    s_waitcnt lgkmcnt(12)
    v_mfma_f32_16x16x32_bf16 v[68:71], v[84:87], v[128:131], v[68:71]
    v_mfma_f32_16x16x32_bf16 v[72:75], v[88:91], v[128:131], v[72:75]
    v_mfma_f32_16x16x32_bf16 v[76:79], v[92:95], v[128:131], v[76:79]
    v_mfma_f32_16x16x32_bf16 v[80:83], v[96:99], v[128:131], v[80:83]
    s_waitcnt lgkmcnt(9)
    v_mfma_f32_16x16x32_bf16 v[20:23], v[100:103], v[132:135], v[20:23]
    s_waitcnt lgkmcnt(7)
    v_mfma_f32_16x16x32_bf16 v[24:27], v[104:107], v[132:135], v[24:27]
    s_waitcnt lgkmcnt(5)
    v_mfma_f32_16x16x32_bf16 v[28:31], v[108:111], v[132:135], v[28:31]
    s_waitcnt lgkmcnt(3)
    v_mfma_f32_16x16x32_bf16 v[32:35], v[112:115], v[132:135], v[32:35]
    s_waitcnt lgkmcnt(2)
    v_mfma_f32_16x16x32_bf16 v[36:39], v[100:103], v[136:139], v[36:39]
    v_mfma_f32_16x16x32_bf16 v[40:43], v[104:107], v[136:139], v[40:43]
    s_waitcnt lgkmcnt(0)
    s_barrier
    v_mfma_f32_16x16x32_bf16 v[44:47], v[108:111], v[136:139], v[44:47]
    ds_read_b128 v[116:119], v7 offset:0
    ds_read_b64_tr_b16 v[84:85], v9 offset:0
    v_mfma_f32_16x16x32_bf16 v[48:51], v[112:115], v[136:139], v[48:51]
    ds_read_b64_tr_b16 v[86:87], v9 offset:1024
    ds_read_b64_tr_b16 v[88:89], v10 offset:0
    v_mfma_f32_16x16x32_bf16 v[52:55], v[100:103], v[140:143], v[52:55]
    ds_read_b64_tr_b16 v[90:91], v10 offset:1024
    ds_read_b64_tr_b16 v[92:93], v11 offset:0
    v_mfma_f32_16x16x32_bf16 v[56:59], v[104:107], v[140:143], v[56:59]
    ds_read_b64_tr_b16 v[94:95], v11 offset:1024
    ds_read_b64_tr_b16 v[96:97], v12 offset:0
    v_mfma_f32_16x16x32_bf16 v[60:63], v[108:111], v[140:143], v[60:63]
    ds_read_b64_tr_b16 v[98:99], v12 offset:1024
    ds_read_b128 v[120:123], v7 offset:2048
    v_mfma_f32_16x16x32_bf16 v[64:67], v[112:115], v[140:143], v[64:67]
    ds_read_b128 v[124:127], v7 offset:4096
    ds_read_b128 v[128:131], v7 offset:6144
    v_mfma_f32_16x16x32_bf16 v[68:71], v[100:103], v[144:147], v[68:71]
    v_mfma_f32_16x16x32_bf16 v[72:75], v[104:107], v[144:147], v[72:75]
    v_mfma_f32_16x16x32_bf16 v[76:79], v[108:111], v[144:147], v[76:79]
    v_mfma_f32_16x16x32_bf16 v[80:83], v[112:115], v[144:147], v[80:83]
    s_add_u32 s32, s32, 1
    s_cmp_lt_u32 s32, 6
    s_cbranch_scc1 L_cons_g2
    s_waitcnt lgkmcnt(9)
    v_mfma_f32_16x16x32_bf16 v[20:23], v[84:87], v[116:119], v[20:23]
    ds_read_b128 v[132:135], v8 offset:0
    s_waitcnt lgkmcnt(8)
    v_mfma_f32_16x16x32_bf16 v[24:27], v[88:91], v[116:119], v[24:27]
    ds_read_b64_tr_b16 v[100:101], v9 offset:8192
    s_waitcnt lgkmcnt(7)
    v_mfma_f32_16x16x32_bf16 v[28:31], v[92:95], v[116:119], v[28:31]
    ds_read_b64_tr_b16 v[102:103], v9 offset:9216
    s_waitcnt lgkmcnt(6)
    v_mfma_f32_16x16x32_bf16 v[32:35], v[96:99], v[116:119], v[32:35]
    ds_read_b64_tr_b16 v[104:105], v10 offset:8192
    s_waitcnt lgkmcnt(6)
    v_mfma_f32_16x16x32_bf16 v[36:39], v[84:87], v[120:123], v[36:39]
    ds_read_b64_tr_b16 v[106:107], v10 offset:9216
    v_mfma_f32_16x16x32_bf16 v[40:43], v[88:91], v[120:123], v[40:43]
    ds_read_b64_tr_b16 v[108:109], v11 offset:8192
    v_mfma_f32_16x16x32_bf16 v[44:47], v[92:95], v[120:123], v[44:47]
    ds_read_b64_tr_b16 v[110:111], v11 offset:9216
    v_mfma_f32_16x16x32_bf16 v[48:51], v[96:99], v[120:123], v[48:51]
    ds_read_b64_tr_b16 v[112:113], v12 offset:8192
    s_waitcnt lgkmcnt(9)
    v_mfma_f32_16x16x32_bf16 v[52:55], v[84:87], v[124:127], v[52:55]
    ds_read_b64_tr_b16 v[114:115], v12 offset:9216
    v_mfma_f32_16x16x32_bf16 v[56:59], v[88:91], v[124:127], v[56:59]
    ds_read_b128 v[136:139], v8 offset:2048
    v_mfma_f32_16x16x32_bf16 v[60:63], v[92:95], v[124:127], v[60:63]
    ds_read_b128 v[140:143], v8 offset:4096
    v_mfma_f32_16x16x32_bf16 v[64:67], v[96:99], v[124:127], v[64:67]
    ds_read_b128 v[144:147], v8 offset:6144
    s_waitcnt lgkmcnt(12)
    v_mfma_f32_16x16x32_bf16 v[68:71], v[84:87], v[128:131], v[68:71]
    v_mfma_f32_16x16x32_bf16 v[72:75], v[88:91], v[128:131], v[72:75]
    v_mfma_f32_16x16x32_bf16 v[76:79], v[92:95], v[128:131], v[76:79]
    v_mfma_f32_16x16x32_bf16 v[80:83], v[96:99], v[128:131], v[80:83]
    s_waitcnt lgkmcnt(9)
    v_mfma_f32_16x16x32_bf16 v[20:23], v[100:103], v[132:135], v[20:23]
    s_waitcnt lgkmcnt(7)
    v_mfma_f32_16x16x32_bf16 v[24:27], v[104:107], v[132:135], v[24:27]
    s_waitcnt lgkmcnt(5)
    v_mfma_f32_16x16x32_bf16 v[28:31], v[108:111], v[132:135], v[28:31]
    s_waitcnt lgkmcnt(3)
    v_mfma_f32_16x16x32_bf16 v[32:35], v[112:115], v[132:135], v[32:35]
    s_waitcnt lgkmcnt(2)
    v_mfma_f32_16x16x32_bf16 v[36:39], v[100:103], v[136:139], v[36:39]
    v_mfma_f32_16x16x32_bf16 v[40:43], v[104:107], v[136:139], v[40:43]
    s_waitcnt lgkmcnt(0)
    s_barrier
    v_mfma_f32_16x16x32_bf16 v[44:47], v[108:111], v[136:139], v[44:47]
    ds_read_b128 v[116:119], v7 offset:32768
    ds_read_b64_tr_b16 v[84:85], v9 offset:32768
    v_mfma_f32_16x16x32_bf16 v[48:51], v[112:115], v[136:139], v[48:51]
    ds_read_b64_tr_b16 v[86:87], v9 offset:33792
    ds_read_b64_tr_b16 v[88:89], v10 offset:32768
    v_mfma_f32_16x16x32_bf16 v[52:55], v[100:103], v[140:143], v[52:55]
    ds_read_b64_tr_b16 v[90:91], v10 offset:33792
    ds_read_b64_tr_b16 v[92:93], v11 offset:32768
    v_mfma_f32_16x16x32_bf16 v[56:59], v[104:107], v[140:143], v[56:59]
    ds_read_b64_tr_b16 v[94:95], v11 offset:33792
    ds_read_b64_tr_b16 v[96:97], v12 offset:32768
    v_mfma_f32_16x16x32_bf16 v[60:63], v[108:111], v[140:143], v[60:63]
    ds_read_b64_tr_b16 v[98:99], v12 offset:33792
    ds_read_b128 v[120:123], v7 offset:34816
    v_mfma_f32_16x16x32_bf16 v[64:67], v[112:115], v[140:143], v[64:67]
    ds_read_b128 v[124:127], v7 offset:36864
    ds_read_b128 v[128:131], v7 offset:38912
    v_mfma_f32_16x16x32_bf16 v[68:71], v[100:103], v[144:147], v[68:71]
    v_mfma_f32_16x16x32_bf16 v[72:75], v[104:107], v[144:147], v[72:75]
    v_mfma_f32_16x16x32_bf16 v[76:79], v[108:111], v[144:147], v[76:79]
    v_mfma_f32_16x16x32_bf16 v[80:83], v[112:115], v[144:147], v[80:83]
    s_waitcnt lgkmcnt(9)
    v_mfma_f32_16x16x32_bf16 v[20:23], v[84:87], v[116:119], v[20:23]
    ds_read_b128 v[132:135], v8 offset:32768
    s_waitcnt lgkmcnt(8)
    v_mfma_f32_16x16x32_bf16 v[24:27], v[88:91], v[116:119], v[24:27]
    ds_read_b64_tr_b16 v[100:101], v9 offset:40960
    s_waitcnt lgkmcnt(7)
    v_mfma_f32_16x16x32_bf16 v[28:31], v[92:95], v[116:119], v[28:31]
    ds_read_b64_tr_b16 v[102:103], v9 offset:41984
    s_waitcnt lgkmcnt(6)
    v_mfma_f32_16x16x32_bf16 v[32:35], v[96:99], v[116:119], v[32:35]
    ds_read_b64_tr_b16 v[104:105], v10 offset:40960
    s_waitcnt lgkmcnt(6)
    v_mfma_f32_16x16x32_bf16 v[36:39], v[84:87], v[120:123], v[36:39]
    ds_read_b64_tr_b16 v[106:107], v10 offset:41984
    v_mfma_f32_16x16x32_bf16 v[40:43], v[88:91], v[120:123], v[40:43]
    ds_read_b64_tr_b16 v[108:109], v11 offset:40960
    v_mfma_f32_16x16x32_bf16 v[44:47], v[92:95], v[120:123], v[44:47]
    ds_read_b64_tr_b16 v[110:111], v11 offset:41984
    v_mfma_f32_16x16x32_bf16 v[48:51], v[96:99], v[120:123], v[48:51]
    ds_read_b64_tr_b16 v[112:113], v12 offset:40960
    s_waitcnt lgkmcnt(9)
    v_mfma_f32_16x16x32_bf16 v[52:55], v[84:87], v[124:127], v[52:55]
    ds_read_b64_tr_b16 v[114:115], v12 offset:41984
    v_mfma_f32_16x16x32_bf16 v[56:59], v[88:91], v[124:127], v[56:59]
    ds_read_b128 v[136:139], v8 offset:34816
    v_mfma_f32_16x16x32_bf16 v[60:63], v[92:95], v[124:127], v[60:63]
    ds_read_b128 v[140:143], v8 offset:36864
    v_mfma_f32_16x16x32_bf16 v[64:67], v[96:99], v[124:127], v[64:67]
    ds_read_b128 v[144:147], v8 offset:38912
    s_waitcnt lgkmcnt(12)
    v_mfma_f32_16x16x32_bf16 v[68:71], v[84:87], v[128:131], v[68:71]
    v_mfma_f32_16x16x32_bf16 v[72:75], v[88:91], v[128:131], v[72:75]
    v_mfma_f32_16x16x32_bf16 v[76:79], v[92:95], v[128:131], v[76:79]
    v_mfma_f32_16x16x32_bf16 v[80:83], v[96:99], v[128:131], v[80:83]
    s_waitcnt lgkmcnt(9)
    v_mfma_f32_16x16x32_bf16 v[20:23], v[100:103], v[132:135], v[20:23]
    s_waitcnt lgkmcnt(7)
    v_mfma_f32_16x16x32_bf16 v[24:27], v[104:107], v[132:135], v[24:27]
    s_waitcnt lgkmcnt(5)
    v_mfma_f32_16x16x32_bf16 v[28:31], v[108:111], v[132:135], v[28:31]
    s_waitcnt lgkmcnt(3)
    v_mfma_f32_16x16x32_bf16 v[32:35], v[112:115], v[132:135], v[32:35]
    s_waitcnt lgkmcnt(2)
    v_mfma_f32_16x16x32_bf16 v[36:39], v[100:103], v[136:139], v[36:39]
    v_mfma_f32_16x16x32_bf16 v[40:43], v[104:107], v[136:139], v[40:43]
    s_waitcnt lgkmcnt(0)
    s_barrier
    v_mfma_f32_16x16x32_bf16 v[44:47], v[108:111], v[136:139], v[44:47]
    ds_read_b128 v[116:119], v13 offset:0
    ds_read_b64_tr_b16 v[84:85], v15 offset:0
    v_mfma_f32_16x16x32_bf16 v[48:51], v[112:115], v[136:139], v[48:51]
    ds_read_b64_tr_b16 v[86:87], v15 offset:1024
    ds_read_b64_tr_b16 v[88:89], v16 offset:0
    v_mfma_f32_16x16x32_bf16 v[52:55], v[100:103], v[140:143], v[52:55]
    ds_read_b64_tr_b16 v[90:91], v16 offset:1024
    ds_read_b64_tr_b16 v[92:93], v17 offset:0
    v_mfma_f32_16x16x32_bf16 v[56:59], v[104:107], v[140:143], v[56:59]
    ds_read_b64_tr_b16 v[94:95], v17 offset:1024
    ds_read_b64_tr_b16 v[96:97], v18 offset:0
    v_mfma_f32_16x16x32_bf16 v[60:63], v[108:111], v[140:143], v[60:63]
    ds_read_b64_tr_b16 v[98:99], v18 offset:1024
    ds_read_b128 v[120:123], v13 offset:2048
    v_mfma_f32_16x16x32_bf16 v[64:67], v[112:115], v[140:143], v[64:67]
    ds_read_b128 v[124:127], v13 offset:4096
    ds_read_b128 v[128:131], v13 offset:6144
    v_mfma_f32_16x16x32_bf16 v[68:71], v[100:103], v[144:147], v[68:71]
    v_mfma_f32_16x16x32_bf16 v[72:75], v[104:107], v[144:147], v[72:75]
    v_mfma_f32_16x16x32_bf16 v[76:79], v[108:111], v[144:147], v[76:79]
    v_mfma_f32_16x16x32_bf16 v[80:83], v[112:115], v[144:147], v[80:83]
    s_waitcnt lgkmcnt(9)
    v_mfma_f32_16x16x32_bf16 v[20:23], v[84:87], v[116:119], v[20:23]
    ds_read_b128 v[132:135], v14 offset:0
    s_waitcnt lgkmcnt(8)
    v_mfma_f32_16x16x32_bf16 v[24:27], v[88:91], v[116:119], v[24:27]
    ds_read_b64_tr_b16 v[100:101], v15 offset:8192
    s_waitcnt lgkmcnt(7)
    v_mfma_f32_16x16x32_bf16 v[28:31], v[92:95], v[116:119], v[28:31]
    ds_read_b64_tr_b16 v[102:103], v15 offset:9216
    s_waitcnt lgkmcnt(6)
    v_mfma_f32_16x16x32_bf16 v[32:35], v[96:99], v[116:119], v[32:35]
    ds_read_b64_tr_b16 v[104:105], v16 offset:8192
    s_waitcnt lgkmcnt(6)
    v_mfma_f32_16x16x32_bf16 v[36:39], v[84:87], v[120:123], v[36:39]
    ds_read_b64_tr_b16 v[106:107], v16 offset:9216
    v_mfma_f32_16x16x32_bf16 v[40:43], v[88:91], v[120:123], v[40:43]
    ds_read_b64_tr_b16 v[108:109], v17 offset:8192
    v_mfma_f32_16x16x32_bf16 v[44:47], v[92:95], v[120:123], v[44:47]
    ds_read_b64_tr_b16 v[110:111], v17 offset:9216
    v_mfma_f32_16x16x32_bf16 v[48:51], v[96:99], v[120:123], v[48:51]
    ds_read_b64_tr_b16 v[112:113], v18 offset:8192
    s_waitcnt lgkmcnt(9)
    v_mfma_f32_16x16x32_bf16 v[52:55], v[84:87], v[124:127], v[52:55]
    ds_read_b64_tr_b16 v[114:115], v18 offset:9216
    v_mfma_f32_16x16x32_bf16 v[56:59], v[88:91], v[124:127], v[56:59]
    ds_read_b128 v[136:139], v14 offset:2048
    v_mfma_f32_16x16x32_bf16 v[60:63], v[92:95], v[124:127], v[60:63]
    ds_read_b128 v[140:143], v14 offset:4096
    v_mfma_f32_16x16x32_bf16 v[64:67], v[96:99], v[124:127], v[64:67]
    ds_read_b128 v[144:147], v14 offset:6144
    s_waitcnt lgkmcnt(12)
    v_mfma_f32_16x16x32_bf16 v[68:71], v[84:87], v[128:131], v[68:71]
    v_mfma_f32_16x16x32_bf16 v[72:75], v[88:91], v[128:131], v[72:75]
    v_mfma_f32_16x16x32_bf16 v[76:79], v[92:95], v[128:131], v[76:79]
    v_mfma_f32_16x16x32_bf16 v[80:83], v[96:99], v[128:131], v[80:83]
    s_waitcnt lgkmcnt(9)
    v_mfma_f32_16x16x32_bf16 v[20:23], v[100:103], v[132:135], v[20:23]
    s_waitcnt lgkmcnt(7)
    v_mfma_f32_16x16x32_bf16 v[24:27], v[104:107], v[132:135], v[24:27]
    s_waitcnt lgkmcnt(5)
    v_mfma_f32_16x16x32_bf16 v[28:31], v[108:111], v[132:135], v[28:31]
    s_waitcnt lgkmcnt(3)
    v_mfma_f32_16x16x32_bf16 v[32:35], v[112:115], v[132:135], v[32:35]
    s_waitcnt lgkmcnt(2)
    v_mfma_f32_16x16x32_bf16 v[36:39], v[100:103], v[136:139], v[36:39]
    v_mfma_f32_16x16x32_bf16 v[40:43], v[104:107], v[136:139], v[40:43]
    s_waitcnt lgkmcnt(0)
    s_barrier
    v_mfma_f32_16x16x32_bf16 v[44:47], v[108:111], v[136:139], v[44:47]
    ds_read_b128 v[116:119], v13 offset:32768
    ds_read_b64_tr_b16 v[84:85], v15 offset:32768
    v_mfma_f32_16x16x32_bf16 v[48:51], v[112:115], v[136:139], v[48:51]
    ds_read_b64_tr_b16 v[86:87], v15 offset:33792
    ds_read_b64_tr_b16 v[88:89], v16 offset:32768
    v_mfma_f32_16x16x32_bf16 v[52:55], v[100:103], v[140:143], v[52:55]
    ds_read_b64_tr_b16 v[90:91], v16 offset:33792
    ds_read_b64_tr_b16 v[92:93], v17 offset:32768
    v_mfma_f32_16x16x32_bf16 v[56:59], v[104:107], v[140:143], v[56:59]
    ds_read_b64_tr_b16 v[94:95], v17 offset:33792
    ds_read_b64_tr_b16 v[96:97], v18 offset:32768
    v_mfma_f32_16x16x32_bf16 v[60:63], v[108:111], v[140:143], v[60:63]
    ds_read_b64_tr_b16 v[98:99], v18 offset:33792
    ds_read_b128 v[120:123], v13 offset:34816
    v_mfma_f32_16x16x32_bf16 v[64:67], v[112:115], v[140:143], v[64:67]
    ds_read_b128 v[124:127], v13 offset:36864
    ds_read_b128 v[128:131], v13 offset:38912
    v_mfma_f32_16x16x32_bf16 v[68:71], v[100:103], v[144:147], v[68:71]
    v_mfma_f32_16x16x32_bf16 v[72:75], v[104:107], v[144:147], v[72:75]
    v_mfma_f32_16x16x32_bf16 v[76:79], v[108:111], v[144:147], v[76:79]
    v_mfma_f32_16x16x32_bf16 v[80:83], v[112:115], v[144:147], v[80:83]
    s_mov_b32 s40, 0
    buffer_load_dwordx4 v[148:151], v5, s[68:71], s40 offen offset:0
    buffer_load_dwordx4 v[164:167], v5, s[72:75], s40 offen offset:0 sc1
    s_mov_b32 s40, 0
    buffer_load_dwordx4 v[152:155], v5, s[68:71], s40 offen offset:64
    buffer_load_dwordx4 v[168:171], v5, s[72:75], s40 offen offset:64 sc1
    s_mov_b32 s40, 32768
    buffer_load_dwordx4 v[156:159], v5, s[68:71], s40 offen offset:0
    buffer_load_dwordx4 v[172:175], v5, s[72:75], s40 offen offset:0 sc1
    s_mov_b32 s40, 32768
    buffer_load_dwordx4 v[160:163], v5, s[68:71], s40 offen offset:64
    buffer_load_dwordx4 v[176:179], v5, s[72:75], s40 offen offset:64 sc1
    s_waitcnt lgkmcnt(9)
    v_mfma_f32_16x16x32_bf16 v[20:23], v[84:87], v[116:119], v[20:23]
    ds_read_b128 v[132:135], v14 offset:32768
    s_waitcnt lgkmcnt(8)
    v_mfma_f32_16x16x32_bf16 v[24:27], v[88:91], v[116:119], v[24:27]
    ds_read_b64_tr_b16 v[100:101], v15 offset:40960
    s_waitcnt lgkmcnt(7)
    v_mfma_f32_16x16x32_bf16 v[28:31], v[92:95], v[116:119], v[28:31]
    ds_read_b64_tr_b16 v[102:103], v15 offset:41984
    s_waitcnt lgkmcnt(6)
    v_mfma_f32_16x16x32_bf16 v[32:35], v[96:99], v[116:119], v[32:35]
    ds_read_b64_tr_b16 v[104:105], v16 offset:40960
    s_waitcnt lgkmcnt(6)
    v_mfma_f32_16x16x32_bf16 v[36:39], v[84:87], v[120:123], v[36:39]
    ds_read_b64_tr_b16 v[106:107], v16 offset:41984
    v_mfma_f32_16x16x32_bf16 v[40:43], v[88:91], v[120:123], v[40:43]
    ds_read_b64_tr_b16 v[108:109], v17 offset:40960
    v_mfma_f32_16x16x32_bf16 v[44:47], v[92:95], v[120:123], v[44:47]
    ds_read_b64_tr_b16 v[110:111], v17 offset:41984
    v_mfma_f32_16x16x32_bf16 v[48:51], v[96:99], v[120:123], v[48:51]
    ds_read_b64_tr_b16 v[112:113], v18 offset:40960
    s_waitcnt lgkmcnt(9)
    v_mfma_f32_16x16x32_bf16 v[52:55], v[84:87], v[124:127], v[52:55]
    ds_read_b64_tr_b16 v[114:115], v18 offset:41984
    v_mfma_f32_16x16x32_bf16 v[56:59], v[88:91], v[124:127], v[56:59]
    ds_read_b128 v[136:139], v14 offset:34816
    v_mfma_f32_16x16x32_bf16 v[60:63], v[92:95], v[124:127], v[60:63]
    ds_read_b128 v[140:143], v14 offset:36864
    v_mfma_f32_16x16x32_bf16 v[64:67], v[96:99], v[124:127], v[64:67]
    ds_read_b128 v[144:147], v14 offset:38912
    s_waitcnt lgkmcnt(12)
    v_mfma_f32_16x16x32_bf16 v[68:71], v[84:87], v[128:131], v[68:71]
    v_mfma_f32_16x16x32_bf16 v[72:75], v[88:91], v[128:131], v[72:75]
    v_mfma_f32_16x16x32_bf16 v[76:79], v[92:95], v[128:131], v[76:79]
    v_mfma_f32_16x16x32_bf16 v[80:83], v[96:99], v[128:131], v[80:83]
    s_waitcnt lgkmcnt(9)
    v_mfma_f32_16x16x32_bf16 v[20:23], v[100:103], v[132:135], v[20:23]
    s_waitcnt lgkmcnt(7)
    v_mfma_f32_16x16x32_bf16 v[24:27], v[104:107], v[132:135], v[24:27]
    s_waitcnt lgkmcnt(5)
    v_mfma_f32_16x16x32_bf16 v[28:31], v[108:111], v[132:135], v[28:31]
    s_waitcnt lgkmcnt(3)
    v_mfma_f32_16x16x32_bf16 v[32:35], v[112:115], v[132:135], v[32:35]
    s_waitcnt lgkmcnt(2)
    v_mfma_f32_16x16x32_bf16 v[36:39], v[100:103], v[136:139], v[36:39]
    v_mfma_f32_16x16x32_bf16 v[40:43], v[104:107], v[136:139], v[40:43]
    v_mfma_f32_16x16x32_bf16 v[44:47], v[108:111], v[136:139], v[44:47]
    v_mfma_f32_16x16x32_bf16 v[48:51], v[112:115], v[136:139], v[48:51]
    s_waitcnt lgkmcnt(1)
    v_mfma_f32_16x16x32_bf16 v[52:55], v[100:103], v[140:143], v[52:55]
    v_mfma_f32_16x16x32_bf16 v[56:59], v[104:107], v[140:143], v[56:59]
    v_mfma_f32_16x16x32_bf16 v[60:63], v[108:111], v[140:143], v[60:63]
    v_mfma_f32_16x16x32_bf16 v[64:67], v[112:115], v[140:143], v[64:67]
    s_waitcnt lgkmcnt(0)
    v_mfma_f32_16x16x32_bf16 v[68:71], v[100:103], v[144:147], v[68:71]
    v_mfma_f32_16x16x32_bf16 v[72:75], v[104:107], v[144:147], v[72:75]
    v_mfma_f32_16x16x32_bf16 v[76:79], v[108:111], v[144:147], v[76:79]
    v_mfma_f32_16x16x32_bf16 v[80:83], v[112:115], v[144:147], v[80:83]
    s_add_u32 s41, s39, 4096
    buffer_store_dwordx4 v[52:55], v6, s[76:79], s39 offen offset:0 sc1
    buffer_store_dwordx4 v[56:59], v6, s[76:79], s39 offen offset:1024 sc1
    buffer_store_dwordx4 v[60:63], v6, s[76:79], s39 offen offset:2048 sc1
    buffer_store_dwordx4 v[64:67], v6, s[76:79], s39 offen offset:3072 sc1
    buffer_store_dwordx4 v[68:71], v6, s[76:79], s41 offen offset:0 sc1
    buffer_store_dwordx4 v[72:75], v6, s[76:79], s41 offen offset:1024 sc1
    buffer_store_dwordx4 v[76:79], v6, s[76:79], s41 offen offset:2048 sc1
    buffer_store_dwordx4 v[80:83], v6, s[76:79], s41 offen offset:3072 sc1
    s_mov_b32 s46, 0xbfb8aa3b
    s_mov_b32 s47, 0xbfb8aa3b
    s_mov_b32 s48, 1.0
    s_mov_b32 s49, 1.0
    s_add_u32 s80, s64, 0x2c10000
    s_addc_u32 s81, s65, 0
    s_and_b32 s81, s81, 0xffff
    s_mov_b32 s82, 0x10000
    s_mov_b32 s83, 0x20000
    s_lshr_b32 s40, s39, 7
    v_mov_b32 v116, s40
    v_mov_b32 v117, 1
    s_lshr_b32 s40, s38, 7
    v_mov_b32 v118, s40
    s_waitcnt vmcnt(0)
    s_mov_b64 exec, 1
    buffer_store_dword v117, v116, s[80:83], 0 offen sc1
    s_mov_b64 exec, -1
    s_mov_b32 s42, 0
L_xch_g2:
    buffer_load_dword v119, v118, s[80:83], 0 offen sc1
    s_add_u32 s42, s42, 1
    s_waitcnt vmcnt(0)
    v_readfirstlane_b32 s40, v119
    s_cmp_eq_u32 s40, 1
    s_cbranch_scc1 L_xok_g2
    s_cmp_lt_u32 s42, 0x8000
    s_cbranch_scc1 L_xch_g2
L_xok_g2:
    s_add_u32 s41, s38, 4096
    buffer_load_dwordx4 v[84:87], v6, s[76:79], s38 offen offset:0 sc1
    buffer_load_dwordx4 v[88:91], v6, s[76:79], s38 offen offset:1024 sc1
    buffer_load_dwordx4 v[92:95], v6, s[76:79], s38 offen offset:2048 sc1
    buffer_load_dwordx4 v[96:99], v6, s[76:79], s38 offen offset:3072 sc1
    buffer_load_dwordx4 v[100:103], v6, s[76:79], s41 offen offset:0 sc1
    buffer_load_dwordx4 v[104:107], v6, s[76:79], s41 offen offset:1024 sc1
    buffer_load_dwordx4 v[108:111], v6, s[76:79], s41 offen offset:2048 sc1
    buffer_load_dwordx4 v[112:115], v6, s[76:79], s41 offen offset:3072 sc1
    s_waitcnt vmcnt(0)
    v_pk_add_f32 v[20:21], v[20:21], v[84:85]
    v_pk_add_f32 v[22:23], v[22:23], v[86:87]
    v_pk_add_f32 v[24:25], v[24:25], v[88:89]
    v_pk_add_f32 v[26:27], v[26:27], v[90:91]
    v_pk_add_f32 v[28:29], v[28:29], v[92:93]
    v_pk_add_f32 v[30:31], v[30:31], v[94:95]
    v_pk_add_f32 v[32:33], v[32:33], v[96:97]
    v_pk_add_f32 v[34:35], v[34:35], v[98:99]
    v_pk_add_f32 v[36:37], v[36:37], v[100:101]
    v_pk_add_f32 v[38:39], v[38:39], v[102:103]
    v_pk_add_f32 v[40:41], v[40:41], v[104:105]
    v_pk_add_f32 v[42:43], v[42:43], v[106:107]
    v_pk_add_f32 v[44:45], v[44:45], v[108:109]
    v_pk_add_f32 v[46:47], v[46:47], v[110:111]
    v_pk_add_f32 v[48:49], v[48:49], v[112:113]
    v_pk_add_f32 v[50:51], v[50:51], v[114:115]
    v_permlane16_swap_b32 v148, v150
    v_permlane16_swap_b32 v149, v151
    v_permlane16_swap_b32 v164, v166
    v_permlane16_swap_b32 v165, v167
    v_pk_mul_f32 v[180:181], v[20:21], s[46:47]
    v_pk_mul_f32 v[182:183], v[22:23], s[46:47]
    v_exp_f32 v180, v180
    v_exp_f32 v181, v181
    v_exp_f32 v182, v182
    v_exp_f32 v183, v183
    v_pk_add_f32 v[180:181], v[180:181], s[48:49]
    v_pk_add_f32 v[182:183], v[182:183], s[48:49]
    v_rcp_f32 v180, v180
    v_rcp_f32 v181, v181
    v_rcp_f32 v182, v182
    v_rcp_f32 v183, v183
    v_pk_mul_f32 v[180:181], v[20:21], v[180:181]
    v_pk_mul_f32 v[182:183], v[22:23], v[182:183]
    v_lshlrev_b32 v188, 16, v164
    v_and_b32 v189, 0xffff0000, v164
    v_lshlrev_b32 v192, 16, v148
    v_and_b32 v193, 0xffff0000, v148
    v_lshlrev_b32 v190, 16, v165
    v_and_b32 v191, 0xffff0000, v165
    v_lshlrev_b32 v194, 16, v149
    v_and_b32 v195, 0xffff0000, v149
    v_pk_fma_f32 v[180:181], v[188:189], v[180:181], v[192:193]
    v_pk_fma_f32 v[182:183], v[190:191], v[182:183], v[194:195]
    v_cvt_pk_bf16_f32 v148, v180, v181
    v_cvt_pk_bf16_f32 v149, v182, v183
    v_pk_mul_f32 v[184:185], v[24:25], s[46:47]
    v_pk_mul_f32 v[186:187], v[26:27], s[46:47]
    v_exp_f32 v184, v184
    v_exp_f32 v185, v185
    v_exp_f32 v186, v186
    v_exp_f32 v187, v187
    v_pk_add_f32 v[184:185], v[184:185], s[48:49]
    v_pk_add_f32 v[186:187], v[186:187], s[48:49]
    v_rcp_f32 v184, v184
    v_rcp_f32 v185, v185
    v_rcp_f32 v186, v186
    v_rcp_f32 v187, v187
    v_pk_mul_f32 v[184:185], v[24:25], v[184:185]
    v_pk_mul_f32 v[186:187], v[26:27], v[186:187]
    v_lshlrev_b32 v188, 16, v166
    v_and_b32 v189, 0xffff0000, v166
    v_lshlrev_b32 v192, 16, v150
    v_and_b32 v193, 0xffff0000, v150
    v_lshlrev_b32 v190, 16, v167
    v_and_b32 v191, 0xffff0000, v167
    v_lshlrev_b32 v194, 16, v151
    v_and_b32 v195, 0xffff0000, v151
    v_pk_fma_f32 v[184:185], v[188:189], v[184:185], v[192:193]
    v_pk_fma_f32 v[186:187], v[190:191], v[186:187], v[194:195]
    v_cvt_pk_bf16_f32 v150, v184, v185
    v_cvt_pk_bf16_f32 v151, v186, v187
    s_nop 0
    v_permlane16_swap_b32 v148, v150
    v_permlane16_swap_b32 v149, v151
    s_mov_b32 s40, 0
    buffer_store_dwordx4 v[148:151], v5, s[12:15], s40 offen offset:0 nt
    v_permlane16_swap_b32 v152, v154
    v_permlane16_swap_b32 v153, v155
    v_permlane16_swap_b32 v168, v170
    v_permlane16_swap_b32 v169, v171
    v_pk_mul_f32 v[180:181], v[28:29], s[46:47]
    v_pk_mul_f32 v[182:183], v[30:31], s[46:47]
    v_exp_f32 v180, v180
    v_exp_f32 v181, v181
    v_exp_f32 v182, v182
    v_exp_f32 v183, v183
    v_pk_add_f32 v[180:181], v[180:181], s[48:49]
    v_pk_add_f32 v[182:183], v[182:183], s[48:49]
    v_rcp_f32 v180, v180
    v_rcp_f32 v181, v181
    v_rcp_f32 v182, v182
    v_rcp_f32 v183, v183
    v_pk_mul_f32 v[180:181], v[28:29], v[180:181]
    v_pk_mul_f32 v[182:183], v[30:31], v[182:183]
    v_lshlrev_b32 v188, 16, v168
    v_and_b32 v189, 0xffff0000, v168
    v_lshlrev_b32 v192, 16, v152
    v_and_b32 v193, 0xffff0000, v152
    v_lshlrev_b32 v190, 16, v169
    v_and_b32 v191, 0xffff0000, v169
    v_lshlrev_b32 v194, 16, v153
    v_and_b32 v195, 0xffff0000, v153
    v_pk_fma_f32 v[180:181], v[188:189], v[180:181], v[192:193]
    v_pk_fma_f32 v[182:183], v[190:191], v[182:183], v[194:195]
    v_cvt_pk_bf16_f32 v152, v180, v181
    v_cvt_pk_bf16_f32 v153, v182, v183
    v_pk_mul_f32 v[184:185], v[32:33], s[46:47]
    v_pk_mul_f32 v[186:187], v[34:35], s[46:47]
    v_exp_f32 v184, v184
    v_exp_f32 v185, v185
    v_exp_f32 v186, v186
    v_exp_f32 v187, v187
    v_pk_add_f32 v[184:185], v[184:185], s[48:49]
    v_pk_add_f32 v[186:187], v[186:187], s[48:49]
    v_rcp_f32 v184, v184
    v_rcp_f32 v185, v185
    v_rcp_f32 v186, v186
    v_rcp_f32 v187, v187
    v_pk_mul_f32 v[184:185], v[32:33], v[184:185]
    v_pk_mul_f32 v[186:187], v[34:35], v[186:187]
    v_lshlrev_b32 v188, 16, v170
    v_and_b32 v189, 0xffff0000, v170
    v_lshlrev_b32 v192, 16, v154
    v_and_b32 v193, 0xffff0000, v154
    v_lshlrev_b32 v190, 16, v171
    v_and_b32 v191, 0xffff0000, v171
    v_lshlrev_b32 v194, 16, v155
    v_and_b32 v195, 0xffff0000, v155
    v_pk_fma_f32 v[184:185], v[188:189], v[184:185], v[192:193]
    v_pk_fma_f32 v[186:187], v[190:191], v[186:187], v[194:195]
    v_cvt_pk_bf16_f32 v154, v184, v185
    v_cvt_pk_bf16_f32 v155, v186, v187
    s_nop 0
    v_permlane16_swap_b32 v152, v154
    v_permlane16_swap_b32 v153, v155
    s_mov_b32 s40, 0
    buffer_store_dwordx4 v[152:155], v5, s[12:15], s40 offen offset:64 nt
    v_permlane16_swap_b32 v156, v158
    v_permlane16_swap_b32 v157, v159
    v_permlane16_swap_b32 v172, v174
    v_permlane16_swap_b32 v173, v175
    v_pk_mul_f32 v[180:181], v[36:37], s[46:47]
    v_pk_mul_f32 v[182:183], v[38:39], s[46:47]
    v_exp_f32 v180, v180
    v_exp_f32 v181, v181
    v_exp_f32 v182, v182
    v_exp_f32 v183, v183
    v_pk_add_f32 v[180:181], v[180:181], s[48:49]
    v_pk_add_f32 v[182:183], v[182:183], s[48:49]
    v_rcp_f32 v180, v180
    v_rcp_f32 v181, v181
    v_rcp_f32 v182, v182
    v_rcp_f32 v183, v183
    v_pk_mul_f32 v[180:181], v[36:37], v[180:181]
    v_pk_mul_f32 v[182:183], v[38:39], v[182:183]
    v_lshlrev_b32 v188, 16, v172
    v_and_b32 v189, 0xffff0000, v172
    v_lshlrev_b32 v192, 16, v156
    v_and_b32 v193, 0xffff0000, v156
    v_lshlrev_b32 v190, 16, v173
    v_and_b32 v191, 0xffff0000, v173
    v_lshlrev_b32 v194, 16, v157
    v_and_b32 v195, 0xffff0000, v157
    v_pk_fma_f32 v[180:181], v[188:189], v[180:181], v[192:193]
    v_pk_fma_f32 v[182:183], v[190:191], v[182:183], v[194:195]
    v_cvt_pk_bf16_f32 v156, v180, v181
    v_cvt_pk_bf16_f32 v157, v182, v183
    v_pk_mul_f32 v[184:185], v[40:41], s[46:47]
    v_pk_mul_f32 v[186:187], v[42:43], s[46:47]
    v_exp_f32 v184, v184
    v_exp_f32 v185, v185
    v_exp_f32 v186, v186
    v_exp_f32 v187, v187
    v_pk_add_f32 v[184:185], v[184:185], s[48:49]
    v_pk_add_f32 v[186:187], v[186:187], s[48:49]
    v_rcp_f32 v184, v184
    v_rcp_f32 v185, v185
    v_rcp_f32 v186, v186
    v_rcp_f32 v187, v187
    v_pk_mul_f32 v[184:185], v[40:41], v[184:185]
    v_pk_mul_f32 v[186:187], v[42:43], v[186:187]
    v_lshlrev_b32 v188, 16, v174
    v_and_b32 v189, 0xffff0000, v174
    v_lshlrev_b32 v192, 16, v158
    v_and_b32 v193, 0xffff0000, v158
    v_lshlrev_b32 v190, 16, v175
    v_and_b32 v191, 0xffff0000, v175
    v_lshlrev_b32 v194, 16, v159
    v_and_b32 v195, 0xffff0000, v159
    v_pk_fma_f32 v[184:185], v[188:189], v[184:185], v[192:193]
    v_pk_fma_f32 v[186:187], v[190:191], v[186:187], v[194:195]
    v_cvt_pk_bf16_f32 v158, v184, v185
    v_cvt_pk_bf16_f32 v159, v186, v187
    s_nop 0
    v_permlane16_swap_b32 v156, v158
    v_permlane16_swap_b32 v157, v159
    s_mov_b32 s40, 32768
    buffer_store_dwordx4 v[156:159], v5, s[12:15], s40 offen offset:0 nt
    v_permlane16_swap_b32 v160, v162
    v_permlane16_swap_b32 v161, v163
    v_permlane16_swap_b32 v176, v178
    v_permlane16_swap_b32 v177, v179
    v_pk_mul_f32 v[180:181], v[44:45], s[46:47]
    v_pk_mul_f32 v[182:183], v[46:47], s[46:47]
    v_exp_f32 v180, v180
    v_exp_f32 v181, v181
    v_exp_f32 v182, v182
    v_exp_f32 v183, v183
    v_pk_add_f32 v[180:181], v[180:181], s[48:49]
    v_pk_add_f32 v[182:183], v[182:183], s[48:49]
    v_rcp_f32 v180, v180
    v_rcp_f32 v181, v181
    v_rcp_f32 v182, v182
    v_rcp_f32 v183, v183
    v_pk_mul_f32 v[180:181], v[44:45], v[180:181]
    v_pk_mul_f32 v[182:183], v[46:47], v[182:183]
    v_lshlrev_b32 v188, 16, v176
    v_and_b32 v189, 0xffff0000, v176
    v_lshlrev_b32 v192, 16, v160
    v_and_b32 v193, 0xffff0000, v160
    v_lshlrev_b32 v190, 16, v177
    v_and_b32 v191, 0xffff0000, v177
    v_lshlrev_b32 v194, 16, v161
    v_and_b32 v195, 0xffff0000, v161
    v_pk_fma_f32 v[180:181], v[188:189], v[180:181], v[192:193]
    v_pk_fma_f32 v[182:183], v[190:191], v[182:183], v[194:195]
    v_cvt_pk_bf16_f32 v160, v180, v181
    v_cvt_pk_bf16_f32 v161, v182, v183
    v_pk_mul_f32 v[184:185], v[48:49], s[46:47]
    v_pk_mul_f32 v[186:187], v[50:51], s[46:47]
    v_exp_f32 v184, v184
    v_exp_f32 v185, v185
    v_exp_f32 v186, v186
    v_exp_f32 v187, v187
    v_pk_add_f32 v[184:185], v[184:185], s[48:49]
    v_pk_add_f32 v[186:187], v[186:187], s[48:49]
    v_rcp_f32 v184, v184
    v_rcp_f32 v185, v185
    v_rcp_f32 v186, v186
    v_rcp_f32 v187, v187
    v_pk_mul_f32 v[184:185], v[48:49], v[184:185]
    v_pk_mul_f32 v[186:187], v[50:51], v[186:187]
    v_lshlrev_b32 v188, 16, v178
    v_and_b32 v189, 0xffff0000, v178
    v_lshlrev_b32 v192, 16, v162
    v_and_b32 v193, 0xffff0000, v162
    v_lshlrev_b32 v190, 16, v179
    v_and_b32 v191, 0xffff0000, v179
    v_lshlrev_b32 v194, 16, v163
    v_and_b32 v195, 0xffff0000, v163
    v_pk_fma_f32 v[184:185], v[188:189], v[184:185], v[192:193]
    v_pk_fma_f32 v[186:187], v[190:191], v[186:187], v[194:195]
    v_cvt_pk_bf16_f32 v162, v184, v185
    v_cvt_pk_bf16_f32 v163, v186, v187
    s_nop 0
    v_permlane16_swap_b32 v160, v162
    v_permlane16_swap_b32 v161, v163
    s_mov_b32 s40, 32768
    buffer_store_dwordx4 v[160:163], v5, s[12:15], s40 offen offset:64 nt
L_g2end_g2:
    s_endpgm
L_oolb12_g2:
    s_barrier
    ds_read_b128 v[164:167], v196 offset:0
    ds_read_b128 v[168:171], v196 offset:1024
    ds_read_b128 v[172:175], v196 offset:2048
    ds_read_b128 v[176:179], v196 offset:3072
    s_waitcnt lgkmcnt(0)
    buffer_store_dwordx4 v[164:167], v6, s[72:75], s90 offen offset:0 sc1
    buffer_store_dwordx4 v[168:171], v6, s[72:75], s90 offen offset:1024 sc1
    buffer_store_dwordx4 v[172:175], v6, s[72:75], s91 offen offset:0 sc1
    buffer_store_dwordx4 v[176:179], v6, s[72:75], s91 offen offset:1024 sc1
    s_branch L_retb12_g2
L_oolb18_g2:
    s_waitcnt vmcnt(0)
    s_barrier
    s_cmp_lg_u32 s20, 0
    s_cbranch_scc1 L_noat_g2
    s_lshl_b32 s40, s88, 5
    s_add_u32 s40, s40, 16
    v_mov_b32 v180, s40
    v_mov_b32 v181, 1
    s_mov_b64 exec, 1
    buffer_atomic_add v181, v180, s[80:83], 0 offen sc1
    s_mov_b64 exec, -1
L_noat_g2:
    s_branch L_retb18_g2
L_loader_g2:
    s_sub_u32 s35, s20, 4
    s_add_u32 s96, s64, 0x2c30000
    s_addc_u32 s97, s65, 0
    s_and_b32 s97, s97, 0xffff
    s_mov_b32 s98, 0x3000
    s_mov_b32 s99, 0x20000
    v_lshrrev_b32 v5, 3, v0
    v_add_u32 v5, 28, v5
    v_lshlrev_b32 v5, 7, v5
    v_and_b32 v6, 7, v0
    v_lshl_add_u32 v5, v6, 2, v5
    v_min_u32 v6, 6, v6
    v_lshlrev_b32 v6, 9, v6
    s_and_b32 s40, s23, 3
    s_lshl_b32 s40, s40, 7
    s_lshr_b32 s41, s23, 2
    s_lshl_b32 s42, s25, 2
    s_add_u32 s41, s41, s42
    s_lshl_b32 s41, s41, 2
    s_add_u32 s40, s40, s41
    v_add_u32 v6, s40, v6
    v_cmp_gt_u32 vcc, 32, v0
    s_nop 1
    v_cndmask_b32 v5, v6, v5, vcc
    v_add_u32 v5, 0x2000, v5
    v_and_b32 v6, 3, v0
    v_min_u32 v6, 2, v6
    v_add_u32 v6, 4, v6
    v_lshlrev_b32 v6, 9, v6
    s_add_u32 s40, s40, 0x2000
    v_add_u32 v8, s40, v6
    s_cmp_lg_u32 s35, 0
    s_cbranch_scc1 L_g2p_done
    s_mov_b32 s42, 0
L_g2poll:
    buffer_load_dword v6, v8, s[96:99], 0 offen sc1
    s_waitcnt vmcnt(0)
    v_cmp_eq_u32 vcc, 1, v6
    s_cmp_eq_u64 vcc, -1
    s_cbranch_scc1 L_g2p_done
    s_sleep 16
    s_add_u32 s42, s42, 1
    s_cmp_lt_u32 s42, 0x8000
    s_cbranch_scc1 L_g2poll
L_g2p_done:
    s_barrier
    s_lshl_b32 s92, s25, 5
    s_add_u32 s12, s64, 0x1b00000
    s_addc_u32 s13, s65, 0
    s_and_b32 s13, s13, 0xffff
    s_mov_b32 s14, 0x422100
    s_mov_b32 s15, 0x20000
    s_add_u32 s68, s64, 0x2c00000
    s_addc_u32 s69, s65, 0
    s_and_b32 s69, s69, 0xffff
    s_mov_b32 s70, 0x4000
    s_mov_b32 s71, 0x20000
    v_lshrrev_b32 v10, 1, v0
    s_mov_b32 s41, 8448
    v_mul_lo_u32 v9, v10, s41
    v_and_b32 v10, 1, v0
    v_lshl_add_u32 v9, v10, 4, v9
    v_lshlrev_b32 v10, 4, v0
    s_lshr_b32 s40, s89, 4
    s_lshl_b32 s40, s40, 2
    s_lshr_b32 s41, s88, 1
    s_add_u32 s40, s40, s41
    s_lshl_b32 s40, s40, 6
    s_and_b32 s41, s88, 1
    s_lshl_b32 s41, s41, 5
    s_add_u32 s40, s40, s41
    s_and_b32 s41, s89, 15
    s_lshl_b32 s41, s41, 1
    s_add_u32 s40, s40, s41
    s_lshl_b32 s90, s40, 4
    v_and_b32 v123, 31, v0
    v_lshrrev_b32 v124, 5, v0
    v_lshl_add_u32 v123, v124, 7, v123
    v_lshlrev_b32 v123, 5, v123
    s_lshl_b32 s40, s35, 2
    s_add_u32 s41, s40, 131072
    v_add_u32 v123, s41, v123
    v_mov_b32 v124, s40
    v_lshlrev_b32 v125, 6, v0
    v_and_b32 v125, 0x7ff, v125
    v_lshrrev_b32 v96, 5, v0
    v_lshl_add_u32 v125, v96, 5, v125
    s_lshl_b32 s40, s35, 12
    s_add_u32 s40, s40, 131072
    v_add_u32 v125, s40, v125
    v_and_b32 v96, 1, v0
    v_cvt_f32_u32 v96, v96
    v_fma_f32 v122, v96, -2.0, 1.0
    v_cmp_gt_u32 vcc, 32, v0
    s_nop 1
    v_cndmask_b32 v122, 0, v122, vcc
    v_lshlrev_b32 v126, 4, v0
    v_add_u32 v126, 147456, v126
    s_mul_i32 s40, s35, 32
    s_add_u32 s40, s40, 0
    v_lshrrev_b32 v1, 3, v0
    v_add_u32 v1, s40, v1
    v_lshrrev_b32 v2, 1, v1
    v_xor_b32 v2, v2, v0
    v_and_b32 v2, 7, v2
    v_lshlrev_b32 v2, 4, v2
    v_xor_b32 v1, s92, v1
    s_mov_b32 s41, 7168
    v_mul_lo_u32 v1, v1, s41
    v_add3_u32 v11, v1, v2, s26
    s_mul_i32 s40, s35, 32
    s_add_u32 s40, s40, 8
    v_lshrrev_b32 v1, 3, v0
    v_add_u32 v1, s40, v1
    v_lshrrev_b32 v2, 1, v1
    v_xor_b32 v2, v2, v0
    v_and_b32 v2, 7, v2
    v_lshlrev_b32 v2, 4, v2
    v_xor_b32 v1, s92, v1
    s_mov_b32 s41, 7168
    v_mul_lo_u32 v1, v1, s41
    v_add3_u32 v12, v1, v2, s26
    s_mul_i32 s40, s35, 32
    s_add_u32 s40, s40, 16
    v_lshrrev_b32 v1, 3, v0
    v_add_u32 v1, s40, v1
    v_lshrrev_b32 v2, 1, v1
    v_xor_b32 v2, v2, v0
    v_and_b32 v2, 7, v2
    v_lshlrev_b32 v2, 4, v2
    v_xor_b32 v1, s92, v1
    s_mov_b32 s41, 7168
    v_mul_lo_u32 v1, v1, s41
    v_add3_u32 v13, v1, v2, s26
    s_mul_i32 s40, s35, 32
    s_add_u32 s40, s40, 24
    v_lshrrev_b32 v1, 3, v0
    v_add_u32 v1, s40, v1
    v_lshrrev_b32 v2, 1, v1
    v_xor_b32 v2, v2, v0
    v_and_b32 v2, 7, v2
    v_lshlrev_b32 v2, 4, v2
    v_xor_b32 v1, s92, v1
    s_mov_b32 s41, 7168
    v_mul_lo_u32 v1, v1, s41
    v_add3_u32 v14, v1, v2, s26
    s_mul_i32 s40, s35, 16
    s_add_u32 s40, s40, 0
    v_lshrrev_b32 v1, 4, v0
    v_add_u32 v1, s40, v1
    v_and_b32 v2, 3, v1
    v_lshrrev_b32 v4, 1, v1
    v_and_b32 v4, 4, v4
    v_or_b32 v2, v2, v4
    v_lshlrev_b32 v2, 1, v2
    v_and_b32 v3, 15, v0
    v_xor_b32 v2, v2, v3
    v_lshlrev_b32 v2, 4, v2
    s_mov_b32 s41, 2048
    v_mul_lo_u32 v1, v1, s41
    v_add3_u32 v15, v1, v2, s27
    s_mul_i32 s40, s35, 16
    s_add_u32 s40, s40, 4
    v_lshrrev_b32 v1, 4, v0
    v_add_u32 v1, s40, v1
    v_and_b32 v2, 3, v1
    v_lshrrev_b32 v4, 1, v1
    v_and_b32 v4, 4, v4
    v_or_b32 v2, v2, v4
    v_lshlrev_b32 v2, 1, v2
    v_and_b32 v3, 15, v0
    v_xor_b32 v2, v2, v3
    v_lshlrev_b32 v2, 4, v2
    s_mov_b32 s41, 2048
    v_mul_lo_u32 v1, v1, s41
    v_add3_u32 v16, v1, v2, s27
    s_mul_i32 s40, s35, 16
    s_add_u32 s40, s40, 8
    v_lshrrev_b32 v1, 4, v0
    v_add_u32 v1, s40, v1
    v_and_b32 v2, 3, v1
    v_lshrrev_b32 v4, 1, v1
    v_and_b32 v4, 4, v4
    v_or_b32 v2, v2, v4
    v_lshlrev_b32 v2, 1, v2
    v_and_b32 v3, 15, v0
    v_xor_b32 v2, v2, v3
    v_lshlrev_b32 v2, 4, v2
    s_mov_b32 s41, 2048
    v_mul_lo_u32 v1, v1, s41
    v_add3_u32 v17, v1, v2, s27
    s_mul_i32 s40, s35, 16
    s_add_u32 s40, s40, 12
    v_lshrrev_b32 v1, 4, v0
    v_add_u32 v1, s40, v1
    v_and_b32 v2, 3, v1
    v_lshrrev_b32 v4, 1, v1
    v_and_b32 v4, 4, v4
    v_or_b32 v2, v2, v4
    v_lshlrev_b32 v2, 1, v2
    v_and_b32 v3, 15, v0
    v_xor_b32 v2, v2, v3
    v_lshlrev_b32 v2, 4, v2
    s_mov_b32 s41, 2048
    v_mul_lo_u32 v1, v1, s41
    v_add3_u32 v18, v1, v2, s27
    s_mov_b32 s28, 2048
    s_mov_b32 s29, 2097152
    s_mul_i32 s30, s35, 4096
    s_mul_i32 s31, s35, 4096
    s_add_u32 s31, s31, 16384
    s_mov_b32 s33, 0
    s_add_u32 m0, s30, 0
    s_nop 0
    buffer_load_dwordx4 v11, s[4:7], s28 offen lds
    s_add_u32 m0, s30, 1024
    s_nop 0
    buffer_load_dwordx4 v12, s[4:7], s28 offen lds
    s_add_u32 m0, s30, 2048
    s_nop 0
    buffer_load_dwordx4 v13, s[4:7], s28 offen lds
    s_add_u32 m0, s30, 3072
    s_nop 0
    buffer_load_dwordx4 v14, s[4:7], s28 offen lds
    s_add_u32 m0, s31, 0
    s_nop 0
    buffer_load_dwordx4 v15, s[8:11], s29 offen lds
    s_add_u32 m0, s31, 1024
    s_nop 0
    buffer_load_dwordx4 v16, s[8:11], s29 offen lds
    s_add_u32 m0, s31, 2048
    s_nop 0
    buffer_load_dwordx4 v17, s[8:11], s29 offen lds
    s_add_u32 m0, s31, 3072
    s_nop 0
    buffer_load_dwordx4 v18, s[8:11], s29 offen lds
    s_add_u32 s28, s28, 128
    s_add_u32 s29, s29, 131072
    s_cmp_eq_u32 s28, 3584
    s_cselect_b32 s28, 0, s28
    s_cselect_b32 s29, 0, s29
    s_add_u32 s33, s33, 1
    s_cmp_eq_u32 s33, 4
    s_cselect_b32 s42, s44, s43
    s_cselect_b32 s33, 0, s33
    s_add_u32 s30, s30, s42
    s_add_u32 s31, s31, s42
    s_add_u32 m0, s30, 0
    s_nop 0
    buffer_load_dwordx4 v11, s[4:7], s28 offen lds
    s_add_u32 m0, s30, 1024
    s_nop 0
    buffer_load_dwordx4 v12, s[4:7], s28 offen lds
    s_add_u32 m0, s30, 2048
    s_nop 0
    buffer_load_dwordx4 v13, s[4:7], s28 offen lds
    s_add_u32 m0, s30, 3072
    s_nop 0
    buffer_load_dwordx4 v14, s[4:7], s28 offen lds
    s_add_u32 m0, s31, 0
    s_nop 0
    buffer_load_dwordx4 v15, s[8:11], s29 offen lds
    s_add_u32 m0, s31, 1024
    s_nop 0
    buffer_load_dwordx4 v16, s[8:11], s29 offen lds
    s_add_u32 m0, s31, 2048
    s_nop 0
    buffer_load_dwordx4 v17, s[8:11], s29 offen lds
    s_add_u32 m0, s31, 3072
    s_nop 0
    buffer_load_dwordx4 v18, s[8:11], s29 offen lds
    s_add_u32 s28, s28, 128
    s_add_u32 s29, s29, 131072
    s_cmp_eq_u32 s28, 3584
    s_cselect_b32 s28, 0, s28
    s_cselect_b32 s29, 0, s29
    s_add_u32 s33, s33, 1
    s_cmp_eq_u32 s33, 4
    s_cselect_b32 s42, s44, s43
    s_cselect_b32 s33, 0, s33
    s_add_u32 s30, s30, s42
    s_add_u32 s31, s31, s42
    s_add_u32 m0, s30, 0
    s_nop 0
    buffer_load_dwordx4 v11, s[4:7], s28 offen lds
    s_add_u32 m0, s30, 1024
    s_nop 0
    buffer_load_dwordx4 v12, s[4:7], s28 offen lds
    s_add_u32 m0, s30, 2048
    s_nop 0
    buffer_load_dwordx4 v13, s[4:7], s28 offen lds
    s_add_u32 m0, s30, 3072
    s_nop 0
    buffer_load_dwordx4 v14, s[4:7], s28 offen lds
    s_add_u32 m0, s31, 0
    s_nop 0
    buffer_load_dwordx4 v15, s[8:11], s29 offen lds
    s_add_u32 m0, s31, 1024
    s_nop 0
    buffer_load_dwordx4 v16, s[8:11], s29 offen lds
    s_add_u32 m0, s31, 2048
    s_nop 0
    buffer_load_dwordx4 v17, s[8:11], s29 offen lds
    s_add_u32 m0, s31, 3072
    s_nop 0
    buffer_load_dwordx4 v18, s[8:11], s29 offen lds
    s_add_u32 s28, s28, 128
    s_add_u32 s29, s29, 131072
    s_cmp_eq_u32 s28, 3584
    s_cselect_b32 s28, 0, s28
    s_cselect_b32 s29, 0, s29
    s_add_u32 s33, s33, 1
    s_cmp_eq_u32 s33, 4
    s_cselect_b32 s42, s44, s43
    s_cselect_b32 s33, 0, s33
    s_add_u32 s30, s30, s42
    s_add_u32 s31, s31, s42
    s_mov_b32 s32, 0
L_load_g2:
    s_cmp_le_u32 s32, 0
    s_cbranch_scc1 L_wa_g2
    s_cmp_le_u32 s32, 3
    s_cbranch_scc1 L_wb_g2
    s_cmp_le_u32 s32, 3
    s_cbranch_scc1 L_wa_g2
    s_cmp_gt_u32 s32, 6
    s_cbranch_scc1 L_wa_g2
    s_waitcnt vmcnt(26)
    s_branch L_wd_g2
L_wb_g2:
    s_waitcnt vmcnt(17)
    s_branch L_wd_g2
L_wa_g2:
    s_waitcnt vmcnt(16)
L_wd_g2:
    s_barrier
    s_add_u32 m0, s30, 0
    s_nop 0
    buffer_load_dwordx4 v11, s[4:7], s28 offen lds
    s_add_u32 m0, s30, 1024
    s_nop 0
    buffer_load_dwordx4 v12, s[4:7], s28 offen lds
    s_add_u32 m0, s30, 2048
    s_nop 0
    buffer_load_dwordx4 v13, s[4:7], s28 offen lds
    s_add_u32 m0, s30, 3072
    s_nop 0
    buffer_load_dwordx4 v14, s[4:7], s28 offen lds
    s_add_u32 m0, s31, 0
    s_nop 0
    buffer_load_dwordx4 v15, s[8:11], s29 offen lds
    s_add_u32 m0, s31, 1024
    s_nop 0
    buffer_load_dwordx4 v16, s[8:11], s29 offen lds
    s_add_u32 m0, s31, 2048
    s_nop 0
    buffer_load_dwordx4 v17, s[8:11], s29 offen lds
    s_add_u32 m0, s31, 3072
    s_nop 0
    buffer_load_dwordx4 v18, s[8:11], s29 offen lds
    s_add_u32 s28, s28, 128
    s_add_u32 s29, s29, 131072
    s_cmp_eq_u32 s28, 3584
    s_cselect_b32 s28, 0, s28
    s_cselect_b32 s29, 0, s29
    s_add_u32 s33, s33, 1
    s_cmp_eq_u32 s33, 4
    s_cselect_b32 s42, s44, s43
    s_cselect_b32 s33, 0, s33
    s_add_u32 s30, s30, s42
    s_add_u32 s31, s31, s42
    s_cmp_gt_u32 s32, 12
    s_cbranch_scc1 L_xr_g2
    s_cmp_eq_u32 s32, 0
    s_cbranch_scc1 L_xp_g2
    s_cmp_eq_u32 s32, 3
    s_cbranch_scc1 L_xc_g2
    s_cmp_eq_u32 s32, 7
    s_cbranch_scc1 L_xs0_g2
    s_cmp_eq_u32 s32, 8
    s_cbranch_scc1 L_xs1_g2
    s_cmp_eq_u32 s32, 9
    s_cbranch_scc1 L_xs2_g2
    s_cmp_eq_u32 s32, 10
    s_cbranch_scc1 L_xs3_g2
    s_cmp_eq_u32 s32, 11
    s_cbranch_scc1 L_xs4_g2
    s_cmp_eq_u32 s32, 12
    s_cbranch_scc1 L_xs5_g2
L_xr_g2:
    s_add_u32 s32, s32, 1
    s_cmp_lt_u32 s32, 25
    s_cbranch_scc1 L_load_g2
    s_lshl_b32 s40, s88, 5
    s_add_u32 s40, s40, 16
    v_mov_b32 v1, s40
    buffer_load_dword v2, v1, s[80:83], 0 offen sc1
    s_waitcnt vmcnt(17)
    s_barrier
    s_waitcnt vmcnt(9)
    s_barrier
    s_waitcnt vmcnt(1)
    s_mov_b32 s42, 0
L_poll_g2:
    s_waitcnt vmcnt(0)
    v_readfirstlane_b32 s40, v2
    s_cmp_ge_u32 s40, 32
    s_cbranch_scc1 L_pollok_g2
    buffer_load_dword v2, v1, s[80:83], 0 offen sc1
    s_add_u32 s42, s42, 1
    s_cmp_lt_u32 s42, 0x8000
    s_cbranch_scc1 L_poll_g2
L_pollok_g2:
    s_barrier
    s_endpgm
L_xp_g2:
    buffer_load_dword v6, v5, s[96:99], 0 offen sc1
    s_branch L_xr_g2
L_xc_g2:
    s_waitcnt vmcnt(24)
    s_mov_b32 s42, 0
    s_branch L_g2pc
L_g2ps:
    s_sleep 16
    buffer_load_dword v6, v5, s[96:99], 0 offen sc1
    s_waitcnt vmcnt(0)
L_g2pc:
    v_cmp_eq_u32 vcc, 1, v6
    s_cmp_eq_u64 vcc, -1
    s_cbranch_scc1 L_g2pok
    s_add_u32 s42, s42, 1
    s_cmp_lt_u32 s42, 0x8000
    s_cbranch_scc1 L_g2ps
L_g2pok:
    s_mul_i32 s40, s35, 1081344
    s_add_u32 s40, s40, s90
    s_lshl_b32 s41, s35, 12
    s_add_u32 m0, s41, 131072
    s_nop 0
    buffer_load_dwordx4 v9, s[12:15], s40 offen lds
    s_add_u32 s40, s40, 270336
    s_add_u32 m0, s41, 132096
    s_nop 0
    buffer_load_dwordx4 v9, s[12:15], s40 offen lds
    s_add_u32 s40, s40, 270336
    s_add_u32 m0, s41, 133120
    s_nop 0
    buffer_load_dwordx4 v9, s[12:15], s40 offen lds
    s_add_u32 s40, s40, 270336
    s_add_u32 m0, s41, 134144
    s_nop 0
    buffer_load_dwordx4 v9, s[12:15], s40 offen lds
    s_add_u32 m0, s41, 147456
    s_nop 0
    buffer_load_dwordx4 v10, s[68:71], s41 offen offset:0 lds
    buffer_load_dwordx4 v10, s[68:71], s41 offen offset:1024 lds
    buffer_load_dwordx4 v10, s[68:71], s41 offen offset:2048 lds
    buffer_load_dwordx4 v10, s[68:71], s41 offen offset:3072 lds
    s_add_u32 s40, s90, 4325376
    buffer_load_dword v120, v124, s[12:15], s40 offen offset:0
    buffer_load_dword v121, v124, s[12:15], s40 offen offset:16
    s_branch L_xr_g2
L_xs0_g2:
    ds_read_b128 v[32:35], v126 offset:0
    ds_read_b128 v[36:39], v126 offset:1024
    ds_read_b128 v[40:43], v126 offset:2048
    ds_read_b128 v[44:47], v126 offset:3072
    ds_read_b32 v104, v123 offset:0
    ds_read_b32 v105, v123 offset:1024
    ds_read_b32 v106, v123 offset:2048
    ds_read_b32 v107, v123 offset:3072
    ds_read_b32 v108, v123 offset:8192
    ds_read_b32 v109, v123 offset:9216
    ds_read_b32 v110, v123 offset:10240
    ds_read_b32 v111, v123 offset:11264
    s_waitcnt lgkmcnt(8)
    ds_read_b32 v112, v123 offset:16
    ds_read_b32 v113, v123 offset:1040
    ds_read_b32 v114, v123 offset:2064
    ds_read_b32 v115, v123 offset:3088
    ds_read_b32 v116, v123 offset:8208
    ds_read_b32 v117, v123 offset:9232
    ds_read_b32 v118, v123 offset:10256
    ds_read_b32 v119, v123 offset:11280
    s_waitcnt lgkmcnt(8)
    v_mfma_f32_32x32x16_bf16 v[128:143], v[104:107], v[32:35], 0
    v_mfma_f32_32x32x16_bf16 v[128:143], v[108:111], v[36:39], v[128:143]
    v_mfma_f32_32x32x16_bf16 v[144:159], v[104:107], v[40:43], 0
    s_branch L_xr_g2
L_xs1_g2:
    v_mfma_f32_32x32x16_bf16 v[144:159], v[108:111], v[44:47], v[144:159]
    ds_read_b128 v[48:51], v126 offset:4096
    ds_read_b128 v[52:55], v126 offset:5120
    ds_read_b128 v[56:59], v126 offset:6144
    ds_read_b128 v[60:63], v126 offset:7168
    ds_read_b128 v[64:67], v126 offset:8192
    ds_read_b128 v[68:71], v126 offset:9216
    ds_read_b128 v[72:75], v126 offset:10240
    ds_read_b128 v[76:79], v126 offset:11264
    s_waitcnt lgkmcnt(8)
    v_mfma_f32_32x32x16_bf16 v[160:175], v[112:115], v[32:35], 0
    v_mfma_f32_32x32x16_bf16 v[160:175], v[116:119], v[36:39], v[160:175]
    v_mfma_f32_32x32x16_bf16 v[176:191], v[112:115], v[40:43], 0
    v_mfma_f32_32x32x16_bf16 v[176:191], v[116:119], v[44:47], v[176:191]
    s_branch L_xr_g2
L_xs2_g2:
    ds_read_b128 v[80:83], v126 offset:12288
    ds_read_b128 v[84:87], v126 offset:13312
    ds_read_b128 v[88:91], v126 offset:14336
    ds_read_b128 v[92:95], v126 offset:15360
    v_lshlrev_b32 v120, 16, v120
    v_lshlrev_b32 v121, 16, v121
    s_waitcnt lgkmcnt(4)
    v_fmac_f32 v128, v120, v122
    v_pk_mul_f32 v[96:97], v[128:129], v[48:49]
    v_pk_mul_f32 v[98:99], v[144:145], v[48:49]
    v_pk_fma_f32 v[96:97], v[144:145], v[64:65], v[96:97]
    v_pk_fma_f32 v[98:99], v[128:129], v[64:65], v[98:99] neg_lo:[1,0,0] neg_hi:[1,0,0]
    v_cvt_pk_bf16_f32 v144, v96, v98
    v_cvt_pk_bf16_f32 v145, v97, v99
    v_pk_mul_f32 v[100:101], v[130:131], v[50:51]
    v_pk_mul_f32 v[102:103], v[146:147], v[50:51]
    v_pk_fma_f32 v[100:101], v[146:147], v[66:67], v[100:101]
    v_pk_fma_f32 v[102:103], v[130:131], v[66:67], v[102:103] neg_lo:[1,0,0] neg_hi:[1,0,0]
    v_cvt_pk_bf16_f32 v146, v100, v102
    v_cvt_pk_bf16_f32 v147, v101, v103
    v_pk_mul_f32 v[96:97], v[132:133], v[52:53]
    v_pk_mul_f32 v[98:99], v[148:149], v[52:53]
    v_pk_fma_f32 v[96:97], v[148:149], v[68:69], v[96:97]
    v_pk_fma_f32 v[98:99], v[132:133], v[68:69], v[98:99] neg_lo:[1,0,0] neg_hi:[1,0,0]
    v_cvt_pk_bf16_f32 v148, v96, v98
    v_cvt_pk_bf16_f32 v149, v97, v99
    v_pk_mul_f32 v[100:101], v[134:135], v[54:55]
    v_pk_mul_f32 v[102:103], v[150:151], v[54:55]
    v_pk_fma_f32 v[100:101], v[150:151], v[70:71], v[100:101]
    v_pk_fma_f32 v[102:103], v[134:135], v[70:71], v[102:103] neg_lo:[1,0,0] neg_hi:[1,0,0]
    v_cvt_pk_bf16_f32 v150, v100, v102
    v_cvt_pk_bf16_f32 v151, v101, v103
    v_pk_mul_f32 v[96:97], v[136:137], v[56:57]
    v_pk_mul_f32 v[98:99], v[152:153], v[56:57]
    v_pk_fma_f32 v[96:97], v[152:153], v[72:73], v[96:97]
    v_pk_fma_f32 v[98:99], v[136:137], v[72:73], v[98:99] neg_lo:[1,0,0] neg_hi:[1,0,0]
    v_cvt_pk_bf16_f32 v152, v96, v98
    v_cvt_pk_bf16_f32 v153, v97, v99
    v_pk_mul_f32 v[100:101], v[138:139], v[58:59]
    v_pk_mul_f32 v[102:103], v[154:155], v[58:59]
    v_pk_fma_f32 v[100:101], v[154:155], v[74:75], v[100:101]
    v_pk_fma_f32 v[102:103], v[138:139], v[74:75], v[102:103] neg_lo:[1,0,0] neg_hi:[1,0,0]
    v_cvt_pk_bf16_f32 v154, v100, v102
    v_cvt_pk_bf16_f32 v155, v101, v103
    v_pk_mul_f32 v[96:97], v[140:141], v[60:61]
    s_branch L_xr_g2
L_xs3_g2:
    v_pk_mul_f32 v[98:99], v[156:157], v[60:61]
    v_pk_fma_f32 v[96:97], v[156:157], v[76:77], v[96:97]
    v_pk_fma_f32 v[98:99], v[140:141], v[76:77], v[98:99] neg_lo:[1,0,0] neg_hi:[1,0,0]
    v_cvt_pk_bf16_f32 v156, v96, v98
    v_cvt_pk_bf16_f32 v157, v97, v99
    v_pk_mul_f32 v[100:101], v[142:143], v[62:63]
    v_pk_mul_f32 v[102:103], v[158:159], v[62:63]
    v_pk_fma_f32 v[100:101], v[158:159], v[78:79], v[100:101]
    v_pk_fma_f32 v[102:103], v[142:143], v[78:79], v[102:103] neg_lo:[1,0,0] neg_hi:[1,0,0]
    v_cvt_pk_bf16_f32 v158, v100, v102
    v_cvt_pk_bf16_f32 v159, v101, v103
    s_waitcnt lgkmcnt(0)
    v_mfma_f32_32x32x16_bf16 v[128:143], v[144:147], v[80:83], 0
    v_mfma_f32_32x32x16_bf16 v[128:143], v[148:151], v[84:87], v[128:143]
    v_mfma_f32_32x32x16_bf16 v[128:143], v[152:155], v[88:91], v[128:143]
    v_mfma_f32_32x32x16_bf16 v[128:143], v[156:159], v[92:95], v[128:143]
    v_fmac_f32 v160, v121, v122
    v_pk_mul_f32 v[96:97], v[160:161], v[48:49]
    v_pk_mul_f32 v[98:99], v[176:177], v[48:49]
    v_pk_fma_f32 v[96:97], v[176:177], v[64:65], v[96:97]
    s_branch L_xr_g2
L_xs4_g2:
    v_pk_fma_f32 v[98:99], v[160:161], v[64:65], v[98:99] neg_lo:[1,0,0] neg_hi:[1,0,0]
    v_cvt_pk_bf16_f32 v176, v96, v98
    v_cvt_pk_bf16_f32 v177, v97, v99
    v_pk_mul_f32 v[100:101], v[162:163], v[50:51]
    v_pk_mul_f32 v[102:103], v[178:179], v[50:51]
    v_pk_fma_f32 v[100:101], v[178:179], v[66:67], v[100:101]
    v_pk_fma_f32 v[102:103], v[162:163], v[66:67], v[102:103] neg_lo:[1,0,0] neg_hi:[1,0,0]
    v_cvt_pk_bf16_f32 v178, v100, v102
    v_cvt_pk_bf16_f32 v179, v101, v103
    v_pk_mul_f32 v[96:97], v[164:165], v[52:53]
    v_pk_mul_f32 v[98:99], v[180:181], v[52:53]
    v_pk_fma_f32 v[96:97], v[180:181], v[68:69], v[96:97]
    v_pk_fma_f32 v[98:99], v[164:165], v[68:69], v[98:99] neg_lo:[1,0,0] neg_hi:[1,0,0]
    v_cvt_pk_bf16_f32 v180, v96, v98
    v_cvt_pk_bf16_f32 v181, v97, v99
    v_pk_mul_f32 v[100:101], v[166:167], v[54:55]
    v_pk_mul_f32 v[102:103], v[182:183], v[54:55]
    v_pk_fma_f32 v[100:101], v[182:183], v[70:71], v[100:101]
    v_pk_fma_f32 v[102:103], v[166:167], v[70:71], v[102:103] neg_lo:[1,0,0] neg_hi:[1,0,0]
    v_cvt_pk_bf16_f32 v182, v100, v102
    v_cvt_pk_bf16_f32 v183, v101, v103
    v_pk_mul_f32 v[96:97], v[168:169], v[56:57]
    v_pk_mul_f32 v[98:99], v[184:185], v[56:57]
    v_pk_fma_f32 v[96:97], v[184:185], v[72:73], v[96:97]
    v_pk_fma_f32 v[98:99], v[168:169], v[72:73], v[98:99] neg_lo:[1,0,0] neg_hi:[1,0,0]
    v_cvt_pk_bf16_f32 v184, v96, v98
    v_cvt_pk_bf16_f32 v185, v97, v99
    v_pk_mul_f32 v[100:101], v[170:171], v[58:59]
    v_pk_mul_f32 v[102:103], v[186:187], v[58:59]
    v_pk_fma_f32 v[100:101], v[186:187], v[74:75], v[100:101]
    v_pk_fma_f32 v[102:103], v[170:171], v[74:75], v[102:103] neg_lo:[1,0,0] neg_hi:[1,0,0]
    v_cvt_pk_bf16_f32 v186, v100, v102
    v_cvt_pk_bf16_f32 v187, v101, v103
    v_pk_mul_f32 v[96:97], v[172:173], v[60:61]
    v_pk_mul_f32 v[98:99], v[188:189], v[60:61]
    v_pk_fma_f32 v[96:97], v[188:189], v[76:77], v[96:97]
    v_pk_fma_f32 v[98:99], v[172:173], v[76:77], v[98:99] neg_lo:[1,0,0] neg_hi:[1,0,0]
    v_cvt_pk_bf16_f32 v188, v96, v98
    v_cvt_pk_bf16_f32 v189, v97, v99
    v_pk_mul_f32 v[100:101], v[174:175], v[62:63]
    v_pk_mul_f32 v[102:103], v[190:191], v[62:63]
    v_pk_fma_f32 v[100:101], v[190:191], v[78:79], v[100:101]
    v_pk_fma_f32 v[102:103], v[174:175], v[78:79], v[102:103] neg_lo:[1,0,0] neg_hi:[1,0,0]
    v_cvt_pk_bf16_f32 v190, v100, v102
    v_cvt_pk_bf16_f32 v191, v101, v103
    v_mfma_f32_32x32x16_bf16 v[160:175], v[176:179], v[80:83], 0
    s_branch L_xr_g2
L_xs5_g2:
    v_mfma_f32_32x32x16_bf16 v[160:175], v[180:183], v[84:87], v[160:175]
    v_mfma_f32_32x32x16_bf16 v[160:175], v[184:187], v[88:91], v[160:175]
    v_mfma_f32_32x32x16_bf16 v[160:175], v[188:191], v[92:95], v[160:175]
    v_cvt_pk_bf16_f32 v144, v128, v129
    v_cvt_pk_bf16_f32 v145, v130, v131
    v_cvt_pk_bf16_f32 v146, v132, v133
    v_cvt_pk_bf16_f32 v147, v134, v135
    v_cvt_pk_bf16_f32 v148, v136, v137
    v_cvt_pk_bf16_f32 v149, v138, v139
    v_cvt_pk_bf16_f32 v150, v140, v141
    v_cvt_pk_bf16_f32 v151, v142, v143
    ds_write_b128 v125, v[144:147] offset:0
    ds_write_b128 v125, v[148:151] offset:16
    s_nop 1
    v_cvt_pk_bf16_f32 v176, v160, v161
    v_cvt_pk_bf16_f32 v177, v162, v163
    v_cvt_pk_bf16_f32 v178, v164, v165
    v_cvt_pk_bf16_f32 v179, v166, v167
    v_cvt_pk_bf16_f32 v180, v168, v169
    v_cvt_pk_bf16_f32 v181, v170, v171
    v_cvt_pk_bf16_f32 v182, v172, v173
    v_cvt_pk_bf16_f32 v183, v174, v175
    ds_write_b128 v125, v[176:179] offset:2048
    ds_write_b128 v125, v[180:183] offset:2064
    s_waitcnt lgkmcnt(0)
    s_branch L_xr_g2
L_end_k:
    s_endpgm
.section .rodata,"a"
.p2align 6
.amdhsa_kernel recurrent_scan__spectral_gfnet__dense_activation_silu__prompt_kernel
  .amdhsa_next_free_vgpr 256
  .amdhsa_next_free_sgpr 102
  .amdhsa_accum_offset 256
  .amdhsa_group_segment_fixed_size 0
  .amdhsa_kernarg_size 72
  .amdhsa_user_sgpr_count 2
  .amdhsa_user_sgpr_kernarg_segment_ptr 1
  .amdhsa_system_sgpr_workgroup_id_x 1
  .amdhsa_float_denorm_mode_32 3
.end_amdhsa_kernel
```
